```python
import torch

def _softmax(x, axis=-1):
    return torch.softmax(x, dim=axis)
def _gelu(x):
    return torch.nn.functional.gelu(x, approximate="tanh")
def _silu(x):
    return torch.nn.functional.silu(x)
def _sigmoid(x):
    return torch.sigmoid(x)
def _layernorm(x, axis=-1, eps=1e-5):
    m = x.mean(dim=axis, keepdim=True)
    v = x.var(dim=axis, keepdim=True, unbiased=False)
    return (x - m) / torch.sqrt(v + eps)
def _scatter_add(tgt, idx, src, axis=0):
    return tgt.clone().index_add_(axis, idx, src)
def _segment_sum(src, seg, n):
    out = torch.zeros((n,) + src.shape[1:], dtype=src.dtype)
    return out.index_add_(0, seg, src)
def _pad(x, pw):
    flat = tuple(v for pair in reversed(pw) for v in pair)
    return torch.nn.functional.pad(x, flat)

kernel_name = 'recurrent_scan__linear_kernel_hedgehog__glu_gated_geglu__prompt'

def setup_inputs():

    _w = (lambda a: (lambda t: t.to(torch.bfloat16) if t.is_floating_point() else t)(torch.as_tensor(a)))
    def _A_setup():
        B, S, D, H = 1, 2048, 1024, 32
        Dh = D // H
        return {
            "x": _w((lambda *s: torch.randn(*s, dtype=torch.bfloat16) * 0.05)(B, S, D)),
            "wqkv": _w((lambda *s: torch.randn(*s, dtype=torch.bfloat16) * 0.8)(D, 3 * D)),
            "w_phi": _w((lambda *s: torch.randn(*s, dtype=torch.bfloat16) * 0.8)(H, Dh, Dh) * (Dh ** -0.5)),
            "wo": _w((lambda *s: torch.randn(*s, dtype=torch.bfloat16) * 0.8)(D, D)),
        }
    _A_in = _A_setup()

    def _B_setup():
        B, S, Dm, Df = 1, 2048, 1024, 3584
        return {
            "x": _w((lambda *s: torch.randn(*s, dtype=torch.bfloat16) * 0.05)(B, S, Dm)),
            "w_gate": _w((lambda *s: torch.randn(*s, dtype=torch.bfloat16) * 0.2)(Dm, Df) * (Dm ** -0.5)),
            "w_up": _w((lambda *s: torch.randn(*s, dtype=torch.bfloat16) * 0.2)(Dm, Df) * (Dm ** -0.5)),
            "w_down": _w((lambda *s: torch.randn(*s, dtype=torch.bfloat16) * 0.2)(Df, Dm) * (Df ** -0.5)),
        }
    _B_in = _B_setup()

    return {
        "A_x": _A_in["x"],
        "A_wqkv": _A_in["wqkv"],
        "A_w_phi": _A_in["w_phi"],
        "A_wo": _A_in["wo"],
        "B_x": _B_in["x"],
        "B_w_gate": _B_in["w_gate"],
        "B_w_up": _B_in["w_up"],
        "B_w_down": _B_in["w_down"],
    }

def reference(A_x, A_wqkv, A_w_phi, A_wo, B_x, B_w_gate, B_w_up, B_w_down):
    def _A_ref(x, wqkv, w_phi, wo):
        B, S, D = x.shape
        H = 32; Dh = D // H
        qkv = (lambda x, *d: x.permute(*d))((x @ wqkv).reshape(B, S, 3, H, Dh), 2, 0, 3, 1, 4)
        q, k, v = qkv[0], qkv[1], qkv[2]
        pq = torch.einsum("bhsd,hdf->bhsf", q, w_phi)
        pk = torch.einsum("bhsd,hdf->bhsf", k, w_phi)
        phi_q = torch.concatenate([_softmax(pq, axis=-1), _softmax(-pq, axis=-1)], axis=-1)
        phi_k = torch.concatenate([_softmax(pk, axis=-1), _softmax(-pk, axis=-1)], axis=-1)
        kv = torch.einsum("bhsf,bhsd->bhfd", phi_k, v)
        z  = torch.einsum("bhsf->bhf", phi_k)
        num = torch.einsum("bhqf,bhfd->bhqd", phi_q, kv)
        den = torch.einsum("bhqf,bhf->bhq", phi_q, z)[..., None] + 1e-6
        o = num / den
        return (lambda x, *d: x.permute(*d))(o, 0, 2, 1, 3).reshape(B, S, D) @ wo

    def _B_ref(x, w_gate, w_up, w_down):
        g = torch.einsum("bsd,df->bsf", x, w_gate)
        u = torch.einsum("bsd,df->bsf", x, w_up)
        h = _gelu(g) * u
        return torch.einsum("bsf,fd->bsd", h, w_down)

    x = A_x
    xn = _layernorm(x, axis=-1)
    s = _A_ref(xn, A_wqkv, A_w_phi, A_wo)
    g = _silu(_B_ref(xn, B_w_gate, B_w_up, B_w_down))
    return x + s * g
```

```asm
; @launch grid=(256,1,1) block=(256,1,1) lds=163840
.amdgcn_target "amdgcn-amd-amdhsa--gfx950"
.text
.globl recurrent_scan__linear_kernel_hedgehog__glu_gated_geglu__prompt_kernel
.p2align 8
.type recurrent_scan__linear_kernel_hedgehog__glu_gated_geglu__prompt_kernel,@function
recurrent_scan__linear_kernel_hedgehog__glu_gated_geglu__prompt_kernel:
s_cmp_ge_u32 s2, 256
s_cbranch_scc1 L_end
s_load_dwordx8 s[4:11], s[0:1], 0
s_load_dwordx2 s[14:15], s[0:1], 80
s_load_dwordx8 s[36:43], s[0:1], 40
v_lshrrev_b32 v1, 6, v0
v_and_b32 v0, 63, v0
v_readfirstlane_b32 s3, v1
v_lshlrev_b32 v10, 4, v0
s_bfe_u32 s17, s2, 0x20001
s_and_b32 s18, s2, 1
s_lshl_b32 s18, s18, 2
s_bfe_u32 s19, s2, 0x20003
s_add_u32 s18, s18, s19
s_lshr_b32 s19, s2, 5
s_lshl_b32 s13, s17, 3
s_add_u32 s13, s13, s19
s_lshl_b32 s63, s18, 5
s_add_u32 s63, s63, s13
s_lshl_b32 s63, s63, 14
s_lshl_b32 s90, s3, 12
s_add_u32 s63, s63, s90
s_mov_b32 s16, 42867776
s_and_b32 s66, s3, 1
s_and_b32 s67, s13, 1
s_waitcnt lgkmcnt(0)
s_mov_b32 s28, s6
s_mov_b32 s29, s7
s_mov_b32 s6, 4194304
s_mov_b32 s7, 0x20000
buffer_load_dwordx4 v[16:19], v10, s[4:7], s63 offen offset:0
buffer_load_dwordx4 v[20:23], v10, s[4:7], s63 offen offset:1024
buffer_load_dwordx4 v[24:27], v10, s[4:7], s63 offen offset:2048
buffer_load_dwordx4 v[28:31], v10, s[4:7], s63 offen offset:3072
s_mov_b32 s32, s8
s_mov_b32 s33, s9
s_mov_b32 s34, 65536
s_mov_b32 s35, 0x20000
s_load_dword s9, s[14:15], s16
s_mov_b32 s30, 6291456
s_mov_b32 s31, 0x20000
s_getpc_b64 s[76:77]
Lcode0:
s_mov_b32 s78, L_end-Lcode0
s_mov_b32 s79, 0x20000
v_min_u32 v2, 3, v0
v_lshlrev_b32 v2, 7, v2
s_bfe_u32 s12, s2, 0x50003
s_lshl_b32 s12, s12, 2
s_add_u32 s12, s12, s3
s_mul_i32 s12, s12, 512
buffer_load_dword a184, v2, s[76:79], s12 offen
s_cmp_lt_u32 s3, 2
s_cselect_b32 s24, s36, s38
s_cselect_b32 s25, s37, s39
s_mov_b32 s26, 7340032
s_mov_b32 s27, 0x20000
s_lshl_b32 s0, s13, 6
s_mul_i32 s1, s13, 224
v_min_u32 v77, 13, v0
v_lshlrev_b32 v77, 7, v77
v_min_u32 v78, 5, v0
v_and_b32 v74, 1, v78
v_lshrrev_b32 v78, 1, v78
v_lshlrev_b32 v78, 11, v78
v_lshl_add_u32 v78, v74, 7, v78
s_and_b32 s16, s2, 1
s_lshl_b32 s16, s16, 5
s_lshr_b32 s12, s2, 3
s_add_u32 s16, s16, s12
s_lshl_b32 s16, s16, 1
s_add_u32 s12, s16, s66
s_mul_i32 s37, s12, 7168
s_mul_i32 s12, s17, 1792
s_add_u32 s37, s37, s12
s_lshr_b32 s12, s3, 1
s_add_u32 s16, s16, s12
s_mul_i32 s36, s16, 6144
s_lshl_b32 s12, s17, 1
s_add_u32 s12, s12, s66
s_lshl_b32 s12, s12, 8
s_add_u32 s36, s36, s12
buffer_load_dword a184, v78, s[28:31], s36 offen
buffer_load_dword a184, v77, s[24:27], s37 offen
s_add_u32 s36, s36, 786432
s_add_u32 s37, s37, 917504
s_lshl_b32 s16, s3, 1
v_and_b32 v72, 7, v0
v_xor_b32 v73, s16, v72
v_lshlrev_b32 v73, 4, v73
v_lshl_add_u32 v68, v0, 7, v73
v_add_u32 v68, 124928, v68
v_xor_b32 v69, 16, v68
v_bfe_u32 v73, v0, 4, 1
v_lshrrev_b32 v67, 5, v0
v_lshl_add_u32 v73, v67, 2, v73
v_xor_b32 v70, v73, v72
v_lshlrev_b32 v70, 4, v70
v_lshl_add_u32 v70, v73, 7, v70
s_add_u32 s16, s90, 124928
v_and_b32 v73, 8, v0
v_add3_u32 v70, v70, v73, s16
v_xor_b32 v67, 0x120, v70
v_bfe_u32 v73, v0, 3, 2
v_lshlrev_b32 v73, 8, v73
v_lshl_add_u32 v71, v72, 4, v73
v_lshrrev_b32 v73, 5, v0
v_lshl_add_u32 v71, v73, 11, v71
s_lshr_b32 s63, s13, 2
s_lshl_b32 s63, s63, 12
s_and_b32 s16, s19, 2
s_lshl_b32 s16, s16, 9
s_add_u32 s63, s63, s16
s_lshl_b32 s16, s67, 7
s_add_u32 s63, s63, s16
s_lshl_b32 s16, s3, 17
s_add_u32 s63, s63, s16
s_lshl_b32 s16, s18, 19
s_add_u32 s20, s14, s16
s_addc_u32 s21, s15, 0
s_mov_b32 s22, 524288
s_mov_b32 s23, 0x20000
v_lshrrev_b32 v79, 2, v0
s_lshl_b32 s16, s3, 4
v_add_u32 v9, s16, v79
v_mul_u32_u24 v9, 6144, v9
v_bfe_u32 v12, v0, 4, 1
v_lshlrev_b32 v12, 1, v12
v_and_b32 v13, 3, v0
v_xor_b32 v12, v12, v13
v_lshl_add_u32 v9, v12, 4, v9
s_mov_b32 s52, 0
s_mov_b32 s54, s0
s_add_u32 s55, s54, 2048
s_add_u32 s56, s54, 4096
s_mul_i32 s16, s66, 229376
s_add_u32 s53, s1, s16
s_mul_i32 s59, s3, 7168
s_add_u32 s59, s59, 12288
s_lshl_b32 s60, s3, 10
s_mov_b32 s57, 0
s_mov_b32 s58, 0
s_mov_b32 s64, 40960
s_mov_b32 s61, s59
s_mov_b32 s62, s60
s_lshl_b32 s65, s66, 10
v_lshlrev_b32 v79, 6, v79
v_lshl_add_u32 v79, v12, 4, v79
v_add_u32 v79, s65, v79
s_movk_i32 s12, 6944
v_mul_u32_u24 v14, 4682, v0
v_add_u32 v15, 4096, v10
v_lshrrev_b32 v1, 16, v14
v_mad_u32_u24 v2, v1, s12, v10
v_add_u32 v14, 299648, v14
v_lshrrev_b32 v1, 16, v14
v_mad_u32_u24 v3, v1, s12, v10
v_add_u32 v14, 299648, v14
v_lshrrev_b32 v1, 16, v14
v_mad_u32_u24 v4, v1, s12, v10
v_add_u32 v14, 299648, v14
v_lshrrev_b32 v1, 16, v14
v_mad_u32_u24 v5, v1, s12, v10
v_add_u32 v14, 299648, v14
v_lshrrev_b32 v1, 16, v14
v_mad_u32_u24 v6, v1, s12, v15
v_add_u32 v14, 299648, v14
v_lshrrev_b32 v1, 16, v14
v_mad_u32_u24 v7, v1, s12, v15
v_add_u32 v14, 299648, v14
v_lshrrev_b32 v1, 16, v14
v_mad_u32_u24 v8, v1, s12, v15
s_waitcnt vmcnt(3)
v_lshlrev_b32 v32, 16, v16
v_and_b32 v33, 0xffff0000, v16
v_lshlrev_b32 v34, 16, v17
v_and_b32 v35, 0xffff0000, v17
v_lshlrev_b32 v36, 16, v18
v_and_b32 v37, 0xffff0000, v18
v_lshlrev_b32 v38, 16, v19
v_and_b32 v39, 0xffff0000, v19
v_lshlrev_b32 v40, 16, v20
v_and_b32 v41, 0xffff0000, v20
v_lshlrev_b32 v42, 16, v21
v_and_b32 v43, 0xffff0000, v21
v_lshlrev_b32 v44, 16, v22
v_and_b32 v45, 0xffff0000, v22
v_lshlrev_b32 v46, 16, v23
v_and_b32 v47, 0xffff0000, v23
v_lshlrev_b32 v48, 16, v24
v_and_b32 v49, 0xffff0000, v24
v_lshlrev_b32 v50, 16, v25
v_and_b32 v51, 0xffff0000, v25
v_lshlrev_b32 v52, 16, v26
v_and_b32 v53, 0xffff0000, v26
s_add_u32 m0, s62, 0
v_lshlrev_b32 v54, 16, v27
buffer_load_dwordx4 v9, s[28:31], s54 offen lds
v_and_b32 v55, 0xffff0000, v27
v_lshlrev_b32 v56, 16, v28
v_and_b32 v57, 0xffff0000, v28
v_lshlrev_b32 v58, 16, v29
v_and_b32 v59, 0xffff0000, v29
v_lshlrev_b32 v60, 16, v30
v_and_b32 v61, 0xffff0000, v30
v_lshlrev_b32 v62, 16, v31
v_and_b32 v63, 0xffff0000, v31
v_pk_add_f32 v[16:17], v[32:33], v[34:35]
v_pk_add_f32 v[18:19], v[36:37], v[38:39]
v_pk_add_f32 v[20:21], v[40:41], v[42:43]
v_pk_add_f32 v[22:23], v[44:45], v[46:47]
v_pk_add_f32 v[16:17], v[16:17], v[18:19]
v_pk_add_f32 v[20:21], v[20:21], v[22:23]
v_pk_add_f32 v[16:17], v[16:17], v[20:21]
v_add_f32 v64, v16, v17
v_pk_add_f32 v[24:25], v[48:49], v[50:51]
s_add_u32 m0, s62, 4096
v_pk_add_f32 v[26:27], v[52:53], v[54:55]
buffer_load_dwordx4 v9, s[28:31], s55 offen lds
v_pk_add_f32 v[28:29], v[56:57], v[58:59]
v_pk_add_f32 v[30:31], v[60:61], v[62:63]
v_pk_add_f32 v[24:25], v[24:25], v[26:27]
v_pk_add_f32 v[28:29], v[28:29], v[30:31]
v_pk_add_f32 v[24:25], v[24:25], v[28:29]
v_add_f32 v65, v24, v25
v_add_f32_dpp v64, v64, v64 row_ror:8 row_mask:0xf bank_mask:0xf
s_nop 0
v_add_f32_dpp v65, v65, v65 row_ror:8 row_mask:0xf bank_mask:0xf
v_add_f32_dpp v64, v64, v64 row_ror:4 row_mask:0xf bank_mask:0xf
s_nop 0
v_add_f32_dpp v65, v65, v65 row_ror:4 row_mask:0xf bank_mask:0xf
v_add_f32_dpp v64, v64, v64 row_ror:2 row_mask:0xf bank_mask:0xf
s_nop 0
v_add_f32_dpp v65, v65, v65 row_ror:2 row_mask:0xf bank_mask:0xf
v_add_f32_dpp v64, v64, v64 row_ror:1 row_mask:0xf bank_mask:0xf
s_nop 0
v_add_f32_dpp v65, v65, v65 row_ror:1 row_mask:0xf bank_mask:0xf
s_nop 1
v_permlane16_swap_b32 v64, v65
v_add_f32 v64, v64, v65
v_mov_b32 v65, v64
s_nop 1
v_permlane32_swap_b32 v64, v65
s_add_u32 m0, s62, 8192
v_add_f32 v64, v64, v65
buffer_load_dwordx4 v9, s[28:31], s56 offen lds
v_mul_f32 v64, 0xba800000, v64
v_cvt_pk_bf16_f32 v66, v64, v64
v_readlane_b32 s76, v64, 0
v_readlane_b32 s78, v64, 16
v_lshlrev_b32 v66, 16, v66
v_pk_add_f32 v[18:19], v[32:33], s[76:77] op_sel_hi:[1,0]
v_pk_mul_f32 v[16:17], v[18:19], v[18:19]
v_pk_add_f32 v[20:21], v[34:35], s[76:77] op_sel_hi:[1,0]
v_pk_fma_f32 v[16:17], v[20:21], v[20:21], v[16:17]
v_pk_add_f32 v[18:19], v[36:37], s[76:77] op_sel_hi:[1,0]
v_pk_fma_f32 v[16:17], v[18:19], v[18:19], v[16:17]
v_pk_add_f32 v[20:21], v[38:39], s[76:77] op_sel_hi:[1,0]
v_pk_fma_f32 v[16:17], v[20:21], v[20:21], v[16:17]
v_pk_add_f32 v[18:19], v[40:41], s[76:77] op_sel_hi:[1,0]
v_pk_fma_f32 v[16:17], v[18:19], v[18:19], v[16:17]
v_pk_add_f32 v[20:21], v[42:43], s[76:77] op_sel_hi:[1,0]
v_pk_fma_f32 v[16:17], v[20:21], v[20:21], v[16:17]
v_pk_add_f32 v[18:19], v[44:45], s[76:77] op_sel_hi:[1,0]
s_add_u32 m0, s61, 0
v_pk_fma_f32 v[16:17], v[18:19], v[18:19], v[16:17]
buffer_load_dwordx4 v2, s[24:27], s53 offen offset:0 lds
v_pk_add_f32 v[20:21], v[46:47], s[76:77] op_sel_hi:[1,0]
v_pk_fma_f32 v[16:17], v[20:21], v[20:21], v[16:17]
v_add_f32 v64, v16, v17
v_pk_add_f32 v[26:27], v[48:49], s[78:79] op_sel_hi:[1,0]
v_pk_mul_f32 v[24:25], v[26:27], v[26:27]
v_pk_add_f32 v[28:29], v[50:51], s[78:79] op_sel_hi:[1,0]
v_pk_fma_f32 v[24:25], v[28:29], v[28:29], v[24:25]
v_pk_add_f32 v[26:27], v[52:53], s[78:79] op_sel_hi:[1,0]
v_pk_fma_f32 v[24:25], v[26:27], v[26:27], v[24:25]
v_pk_add_f32 v[28:29], v[54:55], s[78:79] op_sel_hi:[1,0]
v_pk_fma_f32 v[24:25], v[28:29], v[28:29], v[24:25]
v_pk_add_f32 v[26:27], v[56:57], s[78:79] op_sel_hi:[1,0]
v_pk_fma_f32 v[24:25], v[26:27], v[26:27], v[24:25]
v_pk_add_f32 v[28:29], v[58:59], s[78:79] op_sel_hi:[1,0]
v_pk_fma_f32 v[24:25], v[28:29], v[28:29], v[24:25]
v_pk_add_f32 v[26:27], v[60:61], s[78:79] op_sel_hi:[1,0]
v_pk_fma_f32 v[24:25], v[26:27], v[26:27], v[24:25]
v_pk_add_f32 v[28:29], v[62:63], s[78:79] op_sel_hi:[1,0]
s_add_u32 m0, s61, 0
v_pk_fma_f32 v[24:25], v[28:29], v[28:29], v[24:25]
buffer_load_dwordx4 v3, s[24:27], s53 offen offset:1024 lds
v_add_f32 v65, v24, v25
v_readlane_b32 s76, v66, 0
v_readlane_b32 s78, v66, 16
v_add_f32_dpp v64, v64, v64 row_ror:8 row_mask:0xf bank_mask:0xf
v_pk_add_f32 v[32:33], v[32:33], s[76:77] op_sel_hi:[1,0]
v_cvt_pk_bf16_f32 v33, v32, v33
v_add_f32_dpp v65, v65, v65 row_ror:8 row_mask:0xf bank_mask:0xf
v_lshlrev_b32 v32, 16, v33
v_and_b32 v33, 0xffff0000, v33
v_add_f32_dpp v64, v64, v64 row_ror:4 row_mask:0xf bank_mask:0xf
v_pk_add_f32 v[34:35], v[34:35], s[76:77] op_sel_hi:[1,0]
v_cvt_pk_bf16_f32 v35, v34, v35
v_add_f32_dpp v65, v65, v65 row_ror:4 row_mask:0xf bank_mask:0xf
v_lshlrev_b32 v34, 16, v35
v_and_b32 v35, 0xffff0000, v35
v_add_f32_dpp v64, v64, v64 row_ror:2 row_mask:0xf bank_mask:0xf
v_pk_add_f32 v[36:37], v[36:37], s[76:77] op_sel_hi:[1,0]
v_cvt_pk_bf16_f32 v37, v36, v37
s_add_u32 m0, s61, 0
v_add_f32_dpp v65, v65, v65 row_ror:2 row_mask:0xf bank_mask:0xf
buffer_load_dwordx4 v4, s[24:27], s53 offen offset:2048 lds
v_lshlrev_b32 v36, 16, v37
v_and_b32 v37, 0xffff0000, v37
v_add_f32_dpp v64, v64, v64 row_ror:1 row_mask:0xf bank_mask:0xf
v_pk_add_f32 v[38:39], v[38:39], s[76:77] op_sel_hi:[1,0]
v_cvt_pk_bf16_f32 v39, v38, v39
v_add_f32_dpp v65, v65, v65 row_ror:1 row_mask:0xf bank_mask:0xf
v_lshlrev_b32 v38, 16, v39
v_and_b32 v39, 0xffff0000, v39
v_permlane16_swap_b32 v64, v65
v_pk_add_f32 v[40:41], v[40:41], s[76:77] op_sel_hi:[1,0]
v_cvt_pk_bf16_f32 v41, v40, v41
v_add_f32 v64, v64, v65
v_lshlrev_b32 v40, 16, v41
v_and_b32 v41, 0xffff0000, v41
v_mov_b32 v65, v64
v_pk_add_f32 v[42:43], v[42:43], s[76:77] op_sel_hi:[1,0]
v_cvt_pk_bf16_f32 v43, v42, v43
v_permlane32_swap_b32 v64, v65
s_add_u32 m0, s61, 0
v_lshlrev_b32 v42, 16, v43
buffer_load_dwordx4 v5, s[24:27], s53 offen offset:3072 lds
v_and_b32 v43, 0xffff0000, v43
v_add_f32 v64, v64, v65
v_pk_add_f32 v[44:45], v[44:45], s[76:77] op_sel_hi:[1,0]
v_cvt_pk_bf16_f32 v45, v44, v45
v_mul_f32 v64, 0x3a800000, v64
v_lshlrev_b32 v44, 16, v45
v_and_b32 v45, 0xffff0000, v45
v_cvt_pk_bf16_f32 v64, v64, v64
v_pk_add_f32 v[46:47], v[46:47], s[76:77] op_sel_hi:[1,0]
v_cvt_pk_bf16_f32 v47, v46, v47
v_lshlrev_b32 v64, 16, v64
v_lshlrev_b32 v46, 16, v47
v_and_b32 v47, 0xffff0000, v47
v_add_f32 v64, 0x3727c5ac, v64
v_pk_add_f32 v[48:49], v[48:49], s[78:79] op_sel_hi:[1,0]
v_cvt_pk_bf16_f32 v49, v48, v49
v_cvt_pk_bf16_f32 v64, v64, v64
v_lshlrev_b32 v48, 16, v49
s_add_u32 m0, s61, 4096
v_and_b32 v49, 0xffff0000, v49
buffer_load_dwordx4 v6, s[24:27], s53 offen offset:0 lds
v_lshlrev_b32 v64, 16, v64
v_pk_add_f32 v[50:51], v[50:51], s[78:79] op_sel_hi:[1,0]
v_cvt_pk_bf16_f32 v51, v50, v51
v_sqrt_f32 v64, v64
v_lshlrev_b32 v50, 16, v51
v_and_b32 v51, 0xffff0000, v51
v_cvt_pk_bf16_f32 v64, v64, v64
v_pk_add_f32 v[52:53], v[52:53], s[78:79] op_sel_hi:[1,0]
v_cvt_pk_bf16_f32 v53, v52, v53
v_lshlrev_b32 v64, 16, v64
v_lshlrev_b32 v52, 16, v53
v_and_b32 v53, 0xffff0000, v53
v_rcp_f32 v64, v64
v_pk_add_f32 v[54:55], v[54:55], s[78:79] op_sel_hi:[1,0]
v_cvt_pk_bf16_f32 v55, v54, v55
v_readlane_b32 s44, v64, 0
v_lshlrev_b32 v54, 16, v55
v_and_b32 v55, 0xffff0000, v55
s_add_u32 m0, s61, 4096
v_readlane_b32 s46, v64, 16
buffer_load_dwordx4 v7, s[24:27], s53 offen offset:1024 lds
v_pk_add_f32 v[56:57], v[56:57], s[78:79] op_sel_hi:[1,0]
v_cvt_pk_bf16_f32 v57, v56, v57
v_lshlrev_b32 v56, 16, v57
v_and_b32 v57, 0xffff0000, v57
v_pk_add_f32 v[58:59], v[58:59], s[78:79] op_sel_hi:[1,0]
v_cvt_pk_bf16_f32 v59, v58, v59
v_lshlrev_b32 v58, 16, v59
v_and_b32 v59, 0xffff0000, v59
v_pk_add_f32 v[60:61], v[60:61], s[78:79] op_sel_hi:[1,0]
v_cvt_pk_bf16_f32 v61, v60, v61
v_lshlrev_b32 v60, 16, v61
v_and_b32 v61, 0xffff0000, v61
v_pk_add_f32 v[62:63], v[62:63], s[78:79] op_sel_hi:[1,0]
v_cvt_pk_bf16_f32 v63, v62, v63
v_lshlrev_b32 v62, 16, v63
v_and_b32 v63, 0xffff0000, v63
v_pk_mul_f32 v[32:33], v[32:33], s[44:45] op_sel_hi:[1,0]
v_cvt_pk_bf16_f32 v16, v32, v33
s_add_u32 m0, s61, 4096
v_pk_mul_f32 v[34:35], v[34:35], s[44:45] op_sel_hi:[1,0]
buffer_load_dwordx4 v8, s[24:27], s53 offen offset:2048 lds
v_cvt_pk_bf16_f32 v17, v34, v35
v_pk_mul_f32 v[36:37], v[36:37], s[44:45] op_sel_hi:[1,0]
v_cvt_pk_bf16_f32 v18, v36, v37
v_pk_mul_f32 v[38:39], v[38:39], s[44:45] op_sel_hi:[1,0]
v_cvt_pk_bf16_f32 v19, v38, v39
v_pk_mul_f32 v[40:41], v[40:41], s[44:45] op_sel_hi:[1,0]
v_cvt_pk_bf16_f32 v20, v40, v41
v_pk_mul_f32 v[42:43], v[42:43], s[44:45] op_sel_hi:[1,0]
v_cvt_pk_bf16_f32 v21, v42, v43
v_pk_mul_f32 v[44:45], v[44:45], s[44:45] op_sel_hi:[1,0]
v_cvt_pk_bf16_f32 v22, v44, v45
v_pk_mul_f32 v[46:47], v[46:47], s[44:45] op_sel_hi:[1,0]
v_cvt_pk_bf16_f32 v23, v46, v47
ds_write_b128 v68, v[16:19] offset:0
ds_write_b128 v68, v[20:23] offset:8192
v_pk_mul_f32 v[48:49], v[48:49], s[46:47] op_sel_hi:[1,0]
v_cvt_pk_bf16_f32 v24, v48, v49
v_pk_mul_f32 v[50:51], v[50:51], s[46:47] op_sel_hi:[1,0]
v_cvt_pk_bf16_f32 v25, v50, v51
v_pk_mul_f32 v[52:53], v[52:53], s[46:47] op_sel_hi:[1,0]
v_cvt_pk_bf16_f32 v26, v52, v53
v_pk_mul_f32 v[54:55], v[54:55], s[46:47] op_sel_hi:[1,0]
v_cvt_pk_bf16_f32 v27, v54, v55
v_pk_mul_f32 v[56:57], v[56:57], s[46:47] op_sel_hi:[1,0]
v_cvt_pk_bf16_f32 v28, v56, v57
v_pk_mul_f32 v[58:59], v[58:59], s[46:47] op_sel_hi:[1,0]
v_cvt_pk_bf16_f32 v29, v58, v59
v_pk_mul_f32 v[60:61], v[60:61], s[46:47] op_sel_hi:[1,0]
v_cvt_pk_bf16_f32 v30, v60, v61
v_pk_mul_f32 v[62:63], v[62:63], s[46:47] op_sel_hi:[1,0]
v_cvt_pk_bf16_f32 v31, v62, v63
ds_write_b128 v69, v[24:27] offset:0
ds_write_b128 v69, v[28:31] offset:8192
s_waitcnt lgkmcnt(0)
s_barrier
ds_read_b64 v[16:17], v70 offset:0
ds_read_b64 v[18:19], v67 offset:0
ds_read_b64 v[20:21], v70 offset:1024
ds_read_b64 v[22:23], v67 offset:1024
ds_read_b64 v[24:25], v70 offset:2048
ds_read_b64 v[26:27], v67 offset:2048
ds_read_b64 v[28:29], v70 offset:3072
ds_read_b64 v[30:31], v67 offset:3072
s_mul_i32 s9, s9, 0x9e3779b1
s_add_u32 s9, s9, 0x7f4a7c15
s_waitcnt lgkmcnt(6)
buffer_store_dwordx4 v[16:19], v71, s[20:23], s63 offen sc1
s_add_u32 s63, s63, 32768
s_waitcnt lgkmcnt(4)
buffer_store_dwordx4 v[20:23], v71, s[20:23], s63 offen sc1
s_add_u32 s63, s63, 32768
s_waitcnt lgkmcnt(2)
buffer_store_dwordx4 v[24:27], v71, s[20:23], s63 offen sc1
s_add_u32 s63, s63, 32768
s_waitcnt lgkmcnt(0)
buffer_store_dwordx4 v[28:31], v71, s[20:23], s63 offen sc1
s_add_u32 s48, s14, 41943040
s_addc_u32 s49, s15, 0
s_mov_b32 s50, 8388608
s_mov_b32 s51, 0x20000
s_mov_b32 s0, s36
s_mov_b32 s1, s37
v_mov_b32 v64, s9
v_mov_b32 v65, s9
v_mov_b32 v66, s9
v_mov_b32 v67, s9
s_lshl_b32 s16, s18, 5
s_add_u32 s12, s16, s13
s_lshl_b32 s12, s12, 7
s_add_u32 s12, s12, 524288
s_cmp_eq_u32 s3, 0
s_cselect_b32 s45, s12, 8388608
s_lshl_b32 s12, s3, 3
s_add_u32 s16, s16, s12
s_lshl_b32 s16, s16, 7
s_add_u32 s47, s16, 524288
v_lshlrev_b32 v73, 7, v72
v_lshlrev_b32 v72, 4, v72
v_accvgpr_write_b32 a80, 0
v_accvgpr_write_b32 a81, 0
v_accvgpr_write_b32 a82, 0
v_accvgpr_write_b32 a83, 0
s_waitcnt vmcnt(0)
s_barrier
buffer_store_dwordx4 v[64:67], v72, s[48:51], s45 offen sc1
s_add_u32 m0, s65, 122880
s_lshl_b32 s12, s13, 11
buffer_load_dwordx4 v79, s[32:35], s12 offen lds
s_add_u32 s53, s53, 458752
s_add_u32 s54, s54, 393216
s_add_u32 s55, s54, 2048
s_add_u32 s56, s54, 4096
s_add_u32 s57, s57, 40960
s_cmp_eq_u32 s57, 122880
s_cselect_b32 s57, 0, s57
s_add_u32 s61, s59, s57
s_add_u32 s62, s60, s57
s_add_u32 m0, s61, 0
v_mfma_f32_32x32x16_bf16 v[16:31], a[80:83], a[80:83], 0
buffer_load_dwordx4 v2, s[24:27], s53 offen offset:0 lds
s_mov_b32 s32, s10
s_mov_b32 s33, s11
s_mov_b32 s34, 2097152
s_mov_b32 s35, 0x20000
s_mov_b32 s72, s40
s_mov_b32 s73, s41
s_mov_b32 s74, 7340032
s_mov_b32 s75, 0x20000
s_add_u32 m0, s61, 0
v_mfma_f32_32x32x16_bf16 v[32:47], a[80:83], a[80:83], 0
buffer_load_dwordx4 v3, s[24:27], s53 offen offset:1024 lds
s_mov_b32 s10, s42
s_mov_b32 s11, s43
s_lshl_b32 s16, s3, 1
s_lshr_b32 s12, s17, 1
s_add_u32 s16, s16, s12
s_lshl_b32 s16, s16, 12
v_add_u32 v10, s16, v10
v_xor_b32 v11, 4096, v10
s_add_u32 m0, s61, 0
v_mfma_f32_32x32x16_bf16 v[48:63], a[80:83], a[80:83], 0
buffer_load_dwordx4 v4, s[24:27], s53 offen offset:2048 lds
v_lshrrev_b32 v1, 2, v0
v_and_b32 v15, 3, v0
v_lshlrev_b32 v15, 3, v15
v_bfe_u32 v13, v0, 4, 1
v_lshl_add_u32 v12, v1, 6, v15
v_lshl_add_u32 v12, v13, 5, v12
v_xor_b32 v13, 32, v12
v_mul_u32_u24 v14, 224, v1
s_add_u32 m0, s61, 0
v_mfma_f32_32x32x16_bf16 a[0:15], a[80:83], a[80:83], 0
buffer_load_dwordx4 v5, s[24:27], s53 offen offset:3072 lds
v_add_u32 v14, v14, v15
v_add_u32 v14, 12288, v14
v_add_u32 v1, 122880, v12
v_add_u32 v15, 122880, v13
s_mul_i32 s95, s13, 7
s_add_u32 s95, s95, s67
s_lshl_b32 s95, s95, 13
s_mul_i32 s16, s18, 1835008
s_add_u32 m0, s61, 4096
v_mfma_f32_32x32x16_bf16 a[16:31], a[80:83], a[80:83], 0
buffer_load_dwordx4 v6, s[24:27], s53 offen offset:0 lds
s_add_u32 s95, s95, s16
s_lshr_b32 s16, s17, 1
s_lshl_b32 s16, s16, 11
s_add_u32 s95, s95, s16
s_lshl_b32 s16, s18, 2
s_add_u32 s16, s16, s17
s_lshl_b32 s16, s16, 2
s_add_u32 s16, s16, s3
s_add_u32 m0, s61, 4096
v_mfma_f32_32x32x16_bf16 v[80:95], a[80:83], a[80:83], 0
buffer_load_dwordx4 v7, s[24:27], s53 offen offset:1024 lds
s_lshl_b32 s16, s16, 3
s_add_u32 s16, s16, s19
s_lshl_b32 s98, s16, 7
s_lshl_b32 s16, s13, 2
s_add_u32 s16, s16, s3
s_lshl_b32 s16, s16, 10
s_add_u32 s99, s16, 131072
s_lshl_b32 s16, s18, 7
s_add_u32 m0, s61, 4096
v_mfma_f32_32x32x16_bf16 v[192:207], a[80:83], a[80:83], 0
buffer_load_dwordx4 v8, s[24:27], s53 offen offset:2048 lds
s_add_u32 s68, s99, s16
s_lshl_b32 s16, s18, 5
s_add_u32 s13, s13, s16
s_lshl_b32 s16, s13, 7
s_add_u32 s16, s16, 262144
s_cmp_eq_u32 s3, 0
s_cselect_b32 s70, s16, 8388608
s_add_u32 s36, s14, 4194304
s_addc_u32 s37, s15, 0
s_mov_b32 s38, 14680064
s_add_u32 m0, s62, 0
v_mfma_f32_32x32x16_bf16 v[96:111], a[80:83], a[80:83], 0
buffer_load_dwordx4 v9, s[28:31], s54 offen lds
s_mov_b32 s39, 0x20000
s_add_u32 s40, s14, 20971520
s_addc_u32 s41, s15, 0
s_mov_b32 s42, 4194304
s_mov_b32 s43, 0x20000
s_mul_i32 s96, s18, 112
s_mul_i32 s76, s17, 28
s_lshr_b32 s77, s3, 1
s_lshl_b32 s78, s19, 8
s_add_u32 m0, s62, 4096
v_mfma_f32_32x32x16_bf16 v[208:223], a[80:83], a[80:83], 0
buffer_load_dwordx4 v9, s[28:31], s55 offen lds
s_lshr_b32 s79, s19, 1
s_add_u32 s16, s79, 0
s_and_b32 s16, s16, 3
s_mul_i32 s16, s16, 7
s_add_u32 s16, s16, s76
s_add_u32 s80, s16, s96
s_lshl_b32 s80, s80, 14
s_lshl_b32 s16, s16, 16
s_add_u32 m0, s62, 8192
v_mfma_f32_32x32x16_bf16 v[112:127], a[80:83], a[80:83], 0
buffer_load_dwordx4 v9, s[28:31], s56 offen lds
s_add_u32 s84, s16, s78
s_add_u32 s16, s79, 1
s_and_b32 s16, s16, 3
s_mul_i32 s16, s16, 7
s_add_u32 s16, s16, s76
s_add_u32 s81, s16, s96
s_lshl_b32 s81, s81, 14
s_lshl_b32 s16, s16, 16
v_mfma_f32_32x32x16_bf16 v[224:239], a[80:83], a[80:83], 0
s_add_u32 s85, s16, s78
s_add_u32 s16, s79, 2
s_and_b32 s16, s16, 3
s_mul_i32 s16, s16, 7
s_add_u32 s16, s16, s76
s_add_u32 s82, s16, s96
s_lshl_b32 s82, s82, 14
s_lshl_b32 s16, s16, 16
v_mfma_f32_32x32x16_bf16 v[128:143], a[80:83], a[80:83], 0
s_add_u32 s86, s16, s78
s_add_u32 s16, s79, 3
s_and_b32 s16, s16, 3
s_mul_i32 s16, s16, 7
s_add_u32 s16, s16, s76
s_add_u32 s83, s16, s96
s_lshl_b32 s83, s83, 14
s_lshl_b32 s16, s16, 16
v_mfma_f32_32x32x16_bf16 v[240:255], a[80:83], a[80:83], 0
s_add_u32 s87, s16, s78
s_cmp_eq_u32 s77, 0
s_cselect_b32 s16, s84, s85
s_add_u32 s16, s16, 196608
s_mul_i32 s12, s66, 24576
s_sub_u32 s88, s16, s12
s_cmp_eq_u32 s77, 0
s_cselect_b32 s16, s86, s87
s_add_u32 s16, s16, 196608
s_mul_i32 s12, s66, 24576
v_mfma_f32_32x32x16_bf16 v[144:159], a[80:83], a[80:83], 0
s_sub_u32 s89, s16, s12
s_mul_i32 s16, s77, 229376
s_add_u32 s85, s85, s16
s_add_u32 s86, s86, s16
s_add_u32 s87, s87, s16
s_xor_b32 s16, s77, s67
s_mul_i32 s16, s16, 229376
s_add_u32 s84, s84, s16
v_mfma_f32_32x32x16_bf16 a[32:47], a[80:83], a[80:83], 0
s_lshl_b32 s91, s3, 11
s_and_b32 s16, s17, 1
s_lshl_b32 s16, s16, 7
s_add_u32 s92, s78, s16
s_mul_i32 s79, s18, 0
s_add_u32 s79, s79, s19
s_mul_i32 s79, s79, 8
s_and_b32 s79, s79, 15
v_mfma_f32_32x32x16_bf16 v[160:175], a[80:83], a[80:83], 0
s_lshl_b32 s93, s79, 17
s_lshl_b32 s94, s79, 15
s_mul_i32 s96, s3, 12288
s_lshl_b32 s16, s18, 2
s_add_u32 s16, s16, s17
s_lshl_b32 s16, s16, 2
s_add_u32 s16, s16, s3
s_lshl_b32 s97, s16, 10
v_mfma_f32_32x32x16_bf16 a[48:63], a[80:83], a[80:83], 0
s_lshl_b32 s16, s18, 2
s_add_u32 s16, s16, s3
s_lshl_b32 s16, s16, 10
s_add_u32 s69, s16, 262144
s_lshl_b32 s16, s18, 3
s_add_u32 s16, s16, s19
s_lshl_b32 s16, s16, 2
s_add_u32 s16, s16, s3
v_mfma_f32_32x32x16_bf16 v[176:191], a[80:83], a[80:83], 0
s_lshl_b32 s16, s16, 9
s_add_u32 s71, s16, 393216
v_mfma_f32_32x32x16_bf16 a[64:79], a[80:83], a[80:83], 0
buffer_load_dword v75, v73, s[48:51], s47 offen sc1
s_mov_b64 exec, 0
s_cmp_eq_u32 s3, 0
s_cbranch_scc1 L_pad0
s_cmp_eq_u32 s3, 1
s_cbranch_scc1 L_pad1
s_cmp_eq_u32 s3, 2
s_cbranch_scc1 L_pad2
s_branch L_pad3
L_hopret0:
s_mov_b64 exec, -1
s_waitcnt vmcnt(0)
v_cmp_ne_u32 vcc, s9, v75
s_nop 1
s_cbranch_vccz L_pl_ok
s_mov_b32 s65, 0
L_pl:
buffer_load_dword v75, v73, s[48:51], s47 offen sc1
s_waitcnt vmcnt(0)
v_cmp_ne_u32 vcc, s9, v75
s_add_u32 s65, s65, 1
s_nop 0
s_cbranch_vccz L_pl_ok
s_cmp_lt_u32 s65, 0x100000
s_cbranch_scc1 L_pl
L_pl_ok:
buffer_load_dwordx4 a[112:115], v10, s[20:23], s52 offen offset:0 sc1
buffer_load_dwordx4 a[116:119], v10, s[20:23], s52 offen offset:1024 sc1
buffer_load_dwordx4 a[120:123], v11, s[20:23], s52 offen offset:0 sc1
buffer_load_dwordx4 a[124:127], v11, s[20:23], s52 offen offset:1024 sc1
buffer_load_dwordx4 a[128:131], v10, s[20:23], s52 offen offset:2048 sc1
buffer_load_dwordx4 a[132:135], v10, s[20:23], s52 offen offset:3072 sc1
buffer_load_dwordx4 a[136:139], v11, s[20:23], s52 offen offset:2048 sc1
buffer_load_dwordx4 a[140:143], v11, s[20:23], s52 offen offset:3072 sc1
s_add_u32 s52, s52, 32768
s_nop 0
s_barrier
ds_read_b64_tr_b16 a[176:177], v1 offset:0
ds_read_b64_tr_b16 a[178:179], v1 offset:1024
ds_read_b64_tr_b16 a[180:181], v15 offset:0
ds_read_b64_tr_b16 a[182:183], v15 offset:1024
v_mov_b32 v1, v77
v_mov_b32 v15, v78
v_mfma_f32_32x32x16_bf16 v[64:79], a[80:83], a[80:83], 0
ds_read_b64_tr_b16 a[80:81], v12 offset:4096
ds_read_b64_tr_b16 a[82:83], v12 offset:5120
ds_read_b64_tr_b16 a[84:85], v12 offset:6144
ds_read_b64_tr_b16 a[86:87], v12 offset:7168
ds_read_b64_tr_b16 a[88:89], v13 offset:4096
ds_read_b64_tr_b16 a[90:91], v13 offset:5120
ds_read_b64_tr_b16 a[92:93], v13 offset:6144
ds_read_b64_tr_b16 a[94:95], v13 offset:7168
s_add_u32 s53, s53, 458752
s_add_u32 s54, s54, 393216
s_add_u32 s55, s54, 2048
s_add_u32 s56, s54, 4096
s_add_u32 s57, s57, 40960
s_cmp_eq_u32 s57, 122880
s_cselect_b32 s57, 0, s57
s_add_u32 s61, s59, s57
s_add_u32 s62, s60, s57
buffer_load_dword a184, v15, s[28:31], s0 offen
buffer_load_dword a184, v1, s[24:27], s1 offen
s_and_b32 s16, s13, 31
s_lshl_b32 s16, s16, 2
s_add_u32 s16, s16, s3
s_mul_i32 s16, s16, 9216
s_add_u32 s16, s16, 25165824
s_add_u32 s44, s14, s16
s_addc_u32 s45, s15, 0
s_mov_b32 s46, 9216
s_mov_b32 s47, 0x20000
s_lshr_b32 s8, s2, 3
s_lshl_b32 s8, s8, 15
s_and_b32 s16, s2, 3
s_lshl_b32 s16, s16, 10
s_add_u32 s8, s8, s16
s_sub_u32 s8, s8, 0x100000
s_mov_b32 s65, 7
s_waitcnt vmcnt(2)
s_branch L_loop
.p2align 12
L_page0:
L_pad0:
s_cbranch_execz L_pad4
L_loop:
s_waitcnt vmcnt(13) lgkmcnt(4)
v_mfma_f32_16x16x32_bf16 v[16:19], a[80:83], a[112:115], v[16:19]
ds_read_b64_tr_b16 a[96:97], v12 offset:8192
v_mfma_f32_16x16x32_bf16 v[16:19], a[84:87], a[128:131], v[16:19]
v_mfma_f32_16x16x32_bf16 v[20:23], a[84:87], a[132:135], v[20:23]
ds_read_b64_tr_b16 a[98:99], v12 offset:9216
v_mfma_f32_16x16x32_bf16 v[20:23], a[80:83], a[116:119], v[20:23]
buffer_load_dwordx4 a[144:147], v10, s[20:23], s52 offen offset:0 sc1
v_mfma_f32_16x16x32_bf16 v[24:27], a[80:83], a[120:123], v[24:27]
ds_read_b64_tr_b16 a[100:101], v12 offset:10240
v_mfma_f32_16x16x32_bf16 v[24:27], a[84:87], a[136:139], v[24:27]
s_add_u32 s8, s8, 1048576
v_mfma_f32_16x16x32_bf16 v[28:31], a[84:87], a[140:143], v[28:31]
ds_read_b64_tr_b16 a[102:103], v12 offset:11264
v_mfma_f32_16x16x32_bf16 v[28:31], a[80:83], a[124:127], v[28:31]
s_waitcnt lgkmcnt(4)
v_mfma_f32_16x16x32_bf16 v[44:47], a[88:91], a[124:127], v[44:47]
ds_read_b64_tr_b16 a[104:105], v13 offset:8192
v_mfma_f32_16x16x32_bf16 v[44:47], a[92:95], a[140:143], v[44:47]
v_mfma_f32_16x16x32_bf16 v[40:43], a[92:95], a[136:139], v[40:43]
ds_read_b64_tr_b16 a[106:107], v13 offset:9216
v_mfma_f32_16x16x32_bf16 v[40:43], a[88:91], a[120:123], v[40:43]
buffer_load_dwordx4 a[148:151], v10, s[20:23], s52 offen offset:1024 sc1
v_mfma_f32_16x16x32_bf16 v[36:39], a[88:91], a[116:119], v[36:39]
ds_read_b64_tr_b16 a[108:109], v13 offset:10240
v_mfma_f32_16x16x32_bf16 v[36:39], a[92:95], a[132:135], v[36:39]
s_add_u32 s0, s0, 786432
s_add_u32 s1, s1, 917504
v_mfma_f32_16x16x32_bf16 v[32:35], a[92:95], a[128:131], v[32:35]
ds_read_b64_tr_b16 a[110:111], v13 offset:11264
v_mfma_f32_16x16x32_bf16 v[32:35], a[88:91], a[112:115], v[32:35]
s_waitcnt lgkmcnt(4)
v_mfma_f32_16x16x32_bf16 v[48:51], a[96:99], a[112:115], v[48:51]
ds_read_b64_tr_b16 a[80:81], v12 offset:0
v_mfma_f32_16x16x32_bf16 v[48:51], a[100:103], a[128:131], v[48:51]
v_mfma_f32_16x16x32_bf16 v[52:55], a[100:103], a[132:135], v[52:55]
ds_read_b64_tr_b16 a[82:83], v12 offset:1024
v_mfma_f32_16x16x32_bf16 v[52:55], a[96:99], a[116:119], v[52:55]
buffer_load_dwordx4 a[152:155], v11, s[20:23], s52 offen offset:0 sc1
v_mfma_f32_16x16x32_bf16 v[56:59], a[96:99], a[120:123], v[56:59]
ds_read_b64_tr_b16 a[84:85], v12 offset:2048
v_mfma_f32_16x16x32_bf16 v[56:59], a[100:103], a[136:139], v[56:59]
v_mfma_f32_16x16x32_bf16 v[60:63], a[100:103], a[140:143], v[60:63]
ds_read_b64_tr_b16 a[86:87], v12 offset:3072
v_mfma_f32_16x16x32_bf16 v[60:63], a[96:99], a[124:127], v[60:63]
s_waitcnt lgkmcnt(4)
v_mfma_f32_16x16x32_bf16 v[76:79], a[104:107], a[124:127], v[76:79]
ds_read_b64_tr_b16 a[88:89], v13 offset:0
v_mfma_f32_16x16x32_bf16 v[76:79], a[108:111], a[140:143], v[76:79]
v_mfma_f32_16x16x32_bf16 v[72:75], a[108:111], a[136:139], v[72:75]
ds_read_b64_tr_b16 a[90:91], v13 offset:1024
v_mfma_f32_16x16x32_bf16 v[72:75], a[104:107], a[120:123], v[72:75]
buffer_load_dwordx4 a[156:159], v11, s[20:23], s52 offen offset:1024 sc1
v_mfma_f32_16x16x32_bf16 v[68:71], a[104:107], a[116:119], v[68:71]
ds_read_b64_tr_b16 a[92:93], v13 offset:2048
v_mfma_f32_16x16x32_bf16 v[68:71], a[108:111], a[132:135], v[68:71]
v_mfma_f32_16x16x32_bf16 v[64:67], a[108:111], a[128:131], v[64:67]
ds_read_b64_tr_b16 a[94:95], v13 offset:3072
v_mfma_f32_16x16x32_bf16 v[64:67], a[104:107], a[112:115], v[64:67]
s_waitcnt lgkmcnt(4)
v_mfma_f32_16x16x32_bf16 a[0:3], a[80:83], a[112:115], a[0:3]
ds_read_b64_tr_b16 a[96:97], v14 offset:0
v_mfma_f32_16x16x32_bf16 a[0:3], a[84:87], a[128:131], a[0:3]
v_mfma_f32_16x16x32_bf16 a[4:7], a[84:87], a[132:135], a[4:7]
ds_read_b64_tr_b16 a[98:99], v14 offset:3584
v_mfma_f32_16x16x32_bf16 a[4:7], a[80:83], a[116:119], a[4:7]
buffer_load_dwordx4 a[160:163], v10, s[20:23], s52 offen offset:2048 sc1
v_mfma_f32_16x16x32_bf16 a[8:11], a[80:83], a[120:123], a[8:11]
ds_read_b64_tr_b16 a[100:101], v14 offset:7168
v_mfma_f32_16x16x32_bf16 a[8:11], a[84:87], a[136:139], a[8:11]
v_mfma_f32_16x16x32_bf16 a[12:15], a[84:87], a[140:143], a[12:15]
ds_read_b64_tr_b16 a[102:103], v14 offset:10752
v_mfma_f32_16x16x32_bf16 a[12:15], a[80:83], a[124:127], a[12:15]
s_waitcnt lgkmcnt(4)
v_mfma_f32_16x16x32_bf16 a[28:31], a[88:91], a[124:127], a[28:31]
ds_read_b64_tr_b16 a[104:105], v14 offset:14336
v_mfma_f32_16x16x32_bf16 a[28:31], a[92:95], a[140:143], a[28:31]
v_mfma_f32_16x16x32_bf16 a[24:27], a[92:95], a[136:139], a[24:27]
ds_read_b64_tr_b16 a[106:107], v14 offset:17920
v_mfma_f32_16x16x32_bf16 a[24:27], a[88:91], a[120:123], a[24:27]
buffer_load_dwordx4 a[164:167], v10, s[20:23], s52 offen offset:3072 sc1
v_mfma_f32_16x16x32_bf16 a[20:23], a[88:91], a[116:119], a[20:23]
ds_read_b64_tr_b16 a[108:109], v14 offset:21504
v_mfma_f32_16x16x32_bf16 a[20:23], a[92:95], a[132:135], a[20:23]
v_mfma_f32_16x16x32_bf16 a[16:19], a[92:95], a[128:131], a[16:19]
ds_read_b64_tr_b16 a[110:111], v14 offset:25088
v_mfma_f32_16x16x32_bf16 a[16:19], a[88:91], a[112:115], a[16:19]
s_waitcnt lgkmcnt(4)
v_mfma_f32_16x16x32_bf16 v[80:83], a[96:99], a[112:115], v[80:83]
ds_read_b64_tr_b16 a[80:81], v14 offset:32
v_mfma_f32_16x16x32_bf16 v[80:83], a[100:103], a[128:131], v[80:83]
v_mfma_f32_16x16x32_bf16 v[84:87], a[100:103], a[132:135], v[84:87]
ds_read_b64_tr_b16 a[82:83], v14 offset:3616
v_mfma_f32_16x16x32_bf16 v[84:87], a[96:99], a[116:119], v[84:87]
buffer_load_dwordx4 a[168:171], v11, s[20:23], s52 offen offset:2048 sc1
v_mfma_f32_16x16x32_bf16 v[88:91], a[96:99], a[120:123], v[88:91]
ds_read_b64_tr_b16 a[84:85], v14 offset:7200
v_mfma_f32_16x16x32_bf16 v[88:91], a[100:103], a[136:139], v[88:91]
v_mfma_f32_16x16x32_bf16 v[92:95], a[100:103], a[140:143], v[92:95]
ds_read_b64_tr_b16 a[86:87], v14 offset:10784
v_mfma_f32_16x16x32_bf16 v[92:95], a[96:99], a[124:127], v[92:95]
s_waitcnt lgkmcnt(4)
v_mfma_f32_16x16x32_bf16 v[204:207], a[104:107], a[124:127], v[204:207]
ds_read_b64_tr_b16 a[88:89], v14 offset:14368
v_mfma_f32_16x16x32_bf16 v[204:207], a[108:111], a[140:143], v[204:207]
v_mfma_f32_16x16x32_bf16 v[200:203], a[108:111], a[136:139], v[200:203]
ds_read_b64_tr_b16 a[90:91], v14 offset:17952
v_mfma_f32_16x16x32_bf16 v[200:203], a[104:107], a[120:123], v[200:203]
buffer_load_dwordx4 a[172:175], v11, s[20:23], s52 offen offset:3072 sc1
v_mfma_f32_16x16x32_bf16 v[196:199], a[104:107], a[116:119], v[196:199]
ds_read_b64_tr_b16 a[92:93], v14 offset:21536
v_mfma_f32_16x16x32_bf16 v[196:199], a[108:111], a[132:135], v[196:199]
v_mfma_f32_16x16x32_bf16 v[192:195], a[108:111], a[128:131], v[192:195]
ds_read_b64_tr_b16 a[94:95], v14 offset:25120
v_mfma_f32_16x16x32_bf16 v[192:195], a[104:107], a[112:115], v[192:195]
s_waitcnt lgkmcnt(4)
v_mfma_f32_16x16x32_bf16 v[96:99], a[80:83], a[112:115], v[96:99]
ds_read_b64_tr_b16 a[96:97], v14 offset:64
v_mfma_f32_16x16x32_bf16 v[96:99], a[84:87], a[128:131], v[96:99]
s_add_u32 m0, s61, 0
v_mfma_f32_16x16x32_bf16 v[100:103], a[84:87], a[132:135], v[100:103]
ds_read_b64_tr_b16 a[98:99], v14 offset:3648
v_mfma_f32_16x16x32_bf16 v[100:103], a[80:83], a[116:119], v[100:103]
buffer_load_dwordx4 v2, s[24:27], s53 offen offset:0 lds
v_mfma_f32_16x16x32_bf16 v[104:107], a[80:83], a[120:123], v[104:107]
ds_read_b64_tr_b16 a[100:101], v14 offset:7232
v_mfma_f32_16x16x32_bf16 v[104:107], a[84:87], a[136:139], v[104:107]
v_mfma_f32_16x16x32_bf16 v[108:111], a[84:87], a[140:143], v[108:111]
ds_read_b64_tr_b16 a[102:103], v14 offset:10816
v_mfma_f32_16x16x32_bf16 v[108:111], a[80:83], a[124:127], v[108:111]
s_waitcnt lgkmcnt(4)
v_mfma_f32_16x16x32_bf16 v[220:223], a[88:91], a[124:127], v[220:223]
ds_read_b64_tr_b16 a[104:105], v14 offset:14400
v_mfma_f32_16x16x32_bf16 v[220:223], a[92:95], a[140:143], v[220:223]
v_mfma_f32_16x16x32_bf16 v[216:219], a[92:95], a[136:139], v[216:219]
ds_read_b64_tr_b16 a[106:107], v14 offset:17984
v_mfma_f32_16x16x32_bf16 v[216:219], a[88:91], a[120:123], v[216:219]
buffer_load_dwordx4 v3, s[24:27], s53 offen offset:1024 lds
v_mfma_f32_16x16x32_bf16 v[212:215], a[88:91], a[116:119], v[212:215]
ds_read_b64_tr_b16 a[108:109], v14 offset:21568
v_mfma_f32_16x16x32_bf16 v[212:215], a[92:95], a[132:135], v[212:215]
v_mfma_f32_16x16x32_bf16 v[208:211], a[92:95], a[128:131], v[208:211]
ds_read_b64_tr_b16 a[110:111], v14 offset:25152
v_mfma_f32_16x16x32_bf16 v[208:211], a[88:91], a[112:115], v[208:211]
s_waitcnt lgkmcnt(4)
v_mfma_f32_16x16x32_bf16 v[112:115], a[96:99], a[112:115], v[112:115]
ds_read_b64_tr_b16 a[80:81], v14 offset:96
v_mfma_f32_16x16x32_bf16 v[112:115], a[100:103], a[128:131], v[112:115]
v_mfma_f32_16x16x32_bf16 v[116:119], a[100:103], a[132:135], v[116:119]
ds_read_b64_tr_b16 a[82:83], v14 offset:3680
v_mfma_f32_16x16x32_bf16 v[116:119], a[96:99], a[116:119], v[116:119]
buffer_load_dwordx4 v4, s[24:27], s53 offen offset:2048 lds
v_mfma_f32_16x16x32_bf16 v[120:123], a[96:99], a[120:123], v[120:123]
ds_read_b64_tr_b16 a[84:85], v14 offset:7264
v_mfma_f32_16x16x32_bf16 v[120:123], a[100:103], a[136:139], v[120:123]
v_mfma_f32_16x16x32_bf16 v[124:127], a[100:103], a[140:143], v[124:127]
ds_read_b64_tr_b16 a[86:87], v14 offset:10848
v_mfma_f32_16x16x32_bf16 v[124:127], a[96:99], a[124:127], v[124:127]
s_waitcnt lgkmcnt(4)
v_mfma_f32_16x16x32_bf16 v[236:239], a[104:107], a[124:127], v[236:239]
ds_read_b64_tr_b16 a[88:89], v14 offset:14432
v_mfma_f32_16x16x32_bf16 v[236:239], a[108:111], a[140:143], v[236:239]
v_mfma_f32_16x16x32_bf16 v[232:235], a[108:111], a[136:139], v[232:235]
ds_read_b64_tr_b16 a[90:91], v14 offset:18016
v_mfma_f32_16x16x32_bf16 v[232:235], a[104:107], a[120:123], v[232:235]
buffer_load_dwordx4 v5, s[24:27], s53 offen offset:3072 lds
v_mfma_f32_16x16x32_bf16 v[228:231], a[104:107], a[116:119], v[228:231]
ds_read_b64_tr_b16 a[92:93], v14 offset:21600
v_mfma_f32_16x16x32_bf16 v[228:231], a[108:111], a[132:135], v[228:231]
s_add_u32 s52, s52, 32768
v_mfma_f32_16x16x32_bf16 v[224:227], a[108:111], a[128:131], v[224:227]
ds_read_b64_tr_b16 a[94:95], v14 offset:25184
v_mfma_f32_16x16x32_bf16 v[224:227], a[104:107], a[112:115], v[224:227]
s_waitcnt lgkmcnt(4)
v_mfma_f32_16x16x32_bf16 v[128:131], a[80:83], a[112:115], v[128:131]
ds_read_b64_tr_b16 a[96:97], v14 offset:128
v_mfma_f32_16x16x32_bf16 v[128:131], a[84:87], a[128:131], v[128:131]
s_add_u32 m0, s61, 4096
v_mfma_f32_16x16x32_bf16 v[132:135], a[84:87], a[132:135], v[132:135]
ds_read_b64_tr_b16 a[98:99], v14 offset:3712
v_mfma_f32_16x16x32_bf16 v[132:135], a[80:83], a[116:119], v[132:135]
buffer_load_dwordx4 v6, s[24:27], s53 offen offset:0 lds
v_mfma_f32_16x16x32_bf16 v[136:139], a[80:83], a[120:123], v[136:139]
ds_read_b64_tr_b16 a[100:101], v14 offset:7296
v_mfma_f32_16x16x32_bf16 v[136:139], a[84:87], a[136:139], v[136:139]
v_mfma_f32_16x16x32_bf16 v[140:143], a[84:87], a[140:143], v[140:143]
ds_read_b64_tr_b16 a[102:103], v14 offset:10880
v_mfma_f32_16x16x32_bf16 v[140:143], a[80:83], a[124:127], v[140:143]
s_waitcnt lgkmcnt(4)
v_mfma_f32_16x16x32_bf16 v[252:255], a[88:91], a[124:127], v[252:255]
ds_read_b64_tr_b16 a[104:105], v14 offset:14464
v_mfma_f32_16x16x32_bf16 v[252:255], a[92:95], a[140:143], v[252:255]
v_mfma_f32_16x16x32_bf16 v[248:251], a[92:95], a[136:139], v[248:251]
ds_read_b64_tr_b16 a[106:107], v14 offset:18048
v_mfma_f32_16x16x32_bf16 v[248:251], a[88:91], a[120:123], v[248:251]
buffer_load_dwordx4 v7, s[24:27], s53 offen offset:1024 lds
v_mfma_f32_16x16x32_bf16 v[244:247], a[88:91], a[116:119], v[244:247]
ds_read_b64_tr_b16 a[108:109], v14 offset:21632
v_mfma_f32_16x16x32_bf16 v[244:247], a[92:95], a[132:135], v[244:247]
v_mfma_f32_16x16x32_bf16 v[240:243], a[92:95], a[128:131], v[240:243]
ds_read_b64_tr_b16 a[110:111], v14 offset:25216
v_mfma_f32_16x16x32_bf16 v[240:243], a[88:91], a[112:115], v[240:243]
s_waitcnt lgkmcnt(4)
v_mfma_f32_16x16x32_bf16 v[144:147], a[96:99], a[112:115], v[144:147]
ds_read_b64_tr_b16 a[80:81], v14 offset:160
v_mfma_f32_16x16x32_bf16 v[144:147], a[100:103], a[128:131], v[144:147]
v_mfma_f32_16x16x32_bf16 v[148:151], a[100:103], a[132:135], v[148:151]
ds_read_b64_tr_b16 a[82:83], v14 offset:3744
v_mfma_f32_16x16x32_bf16 v[148:151], a[96:99], a[116:119], v[148:151]
buffer_load_dwordx4 v8, s[24:27], s53 offen offset:2048 lds
v_mfma_f32_16x16x32_bf16 v[152:155], a[96:99], a[120:123], v[152:155]
ds_read_b64_tr_b16 a[84:85], v14 offset:7328
v_mfma_f32_16x16x32_bf16 v[152:155], a[100:103], a[136:139], v[152:155]
v_mfma_f32_16x16x32_bf16 v[156:159], a[100:103], a[140:143], v[156:159]
ds_read_b64_tr_b16 a[86:87], v14 offset:10912
v_mfma_f32_16x16x32_bf16 v[156:159], a[96:99], a[124:127], v[156:159]
s_waitcnt lgkmcnt(4)
v_mfma_f32_16x16x32_bf16 a[44:47], a[104:107], a[124:127], a[44:47]
ds_read_b64_tr_b16 a[88:89], v14 offset:14496
v_mfma_f32_16x16x32_bf16 a[44:47], a[108:111], a[140:143], a[44:47]
s_add_u32 m0, s62, 0
v_mfma_f32_16x16x32_bf16 a[40:43], a[108:111], a[136:139], a[40:43]
ds_read_b64_tr_b16 a[90:91], v14 offset:18080
v_mfma_f32_16x16x32_bf16 a[40:43], a[104:107], a[120:123], a[40:43]
buffer_load_dwordx4 v9, s[28:31], s54 offen lds
v_mfma_f32_16x16x32_bf16 a[36:39], a[104:107], a[116:119], a[36:39]
ds_read_b64_tr_b16 a[92:93], v14 offset:21664
v_mfma_f32_16x16x32_bf16 a[36:39], a[108:111], a[132:135], a[36:39]
v_mfma_f32_16x16x32_bf16 a[32:35], a[108:111], a[128:131], a[32:35]
ds_read_b64_tr_b16 a[94:95], v14 offset:25248
v_mfma_f32_16x16x32_bf16 a[32:35], a[104:107], a[112:115], a[32:35]
s_waitcnt lgkmcnt(4)
v_mfma_f32_16x16x32_bf16 v[160:163], a[80:83], a[112:115], v[160:163]
ds_read_b64_tr_b16 a[96:97], v14 offset:192
v_mfma_f32_16x16x32_bf16 v[160:163], a[84:87], a[128:131], v[160:163]
s_add_u32 m0, s62, 4096
v_mfma_f32_16x16x32_bf16 v[164:167], a[84:87], a[132:135], v[164:167]
ds_read_b64_tr_b16 a[98:99], v14 offset:3776
v_mfma_f32_16x16x32_bf16 v[164:167], a[80:83], a[116:119], v[164:167]
buffer_load_dwordx4 v9, s[28:31], s55 offen lds
v_mfma_f32_16x16x32_bf16 v[168:171], a[80:83], a[120:123], v[168:171]
ds_read_b64_tr_b16 a[100:101], v14 offset:7360
v_mfma_f32_16x16x32_bf16 v[168:171], a[84:87], a[136:139], v[168:171]
v_mfma_f32_16x16x32_bf16 v[172:175], a[84:87], a[140:143], v[172:175]
ds_read_b64_tr_b16 a[102:103], v14 offset:10944
v_mfma_f32_16x16x32_bf16 v[172:175], a[80:83], a[124:127], v[172:175]
s_waitcnt lgkmcnt(4)
v_mfma_f32_16x16x32_bf16 a[60:63], a[88:91], a[124:127], a[60:63]
ds_read_b64_tr_b16 a[104:105], v14 offset:14528
v_mfma_f32_16x16x32_bf16 a[60:63], a[92:95], a[140:143], a[60:63]
s_add_u32 m0, s62, 8192
v_mfma_f32_16x16x32_bf16 a[56:59], a[92:95], a[136:139], a[56:59]
ds_read_b64_tr_b16 a[106:107], v14 offset:18112
v_mfma_f32_16x16x32_bf16 a[56:59], a[88:91], a[120:123], a[56:59]
buffer_load_dwordx4 v9, s[28:31], s56 offen lds
v_mfma_f32_16x16x32_bf16 a[52:55], a[88:91], a[116:119], a[52:55]
ds_read_b64_tr_b16 a[108:109], v14 offset:21696
v_mfma_f32_16x16x32_bf16 a[52:55], a[92:95], a[132:135], a[52:55]
v_mfma_f32_16x16x32_bf16 a[48:51], a[92:95], a[128:131], a[48:51]
ds_read_b64_tr_b16 a[110:111], v14 offset:25280
buffer_load_dword a184, v1, s[24:27], s1 offen
v_mfma_f32_16x16x32_bf16 a[48:51], a[88:91], a[112:115], a[48:51]
s_waitcnt lgkmcnt(4)
v_mfma_f32_16x16x32_bf16 v[176:179], a[96:99], a[112:115], v[176:179]
s_add_u32 s58, s58, 40960
s_cmp_eq_u32 s58, 122880
s_cselect_b32 s58, 0, s58
v_mfma_f32_16x16x32_bf16 v[176:179], a[100:103], a[128:131], v[176:179]
s_cselect_b32 s63, 4294885376, s64
v_add_u32 v12, s63, v12
v_add_u32 v13, s63, v13
v_mfma_f32_16x16x32_bf16 v[180:183], a[100:103], a[132:135], v[180:183]
v_add_u32 v14, s63, v14
v_mfma_f32_16x16x32_bf16 v[180:183], a[96:99], a[116:119], v[180:183]
s_waitcnt vmcnt(19) lgkmcnt(0)
s_barrier
v_mfma_f32_16x16x32_bf16 v[184:187], a[96:99], a[120:123], v[184:187]
ds_read_b64_tr_b16 a[80:81], v12 offset:4096
v_mfma_f32_16x16x32_bf16 v[184:187], a[100:103], a[136:139], v[184:187]
ds_read_b64_tr_b16 a[82:83], v12 offset:5120
v_mfma_f32_16x16x32_bf16 v[188:191], a[100:103], a[140:143], v[188:191]
ds_read_b64_tr_b16 a[84:85], v12 offset:6144
v_mfma_f32_16x16x32_bf16 v[188:191], a[96:99], a[124:127], v[188:191]
ds_read_b64_tr_b16 a[86:87], v12 offset:7168
v_mfma_f32_16x16x32_bf16 a[76:79], a[104:107], a[124:127], a[76:79]
s_add_u32 s53, s53, 458752
ds_read_b64_tr_b16 a[88:89], v13 offset:4096
v_mfma_f32_16x16x32_bf16 a[76:79], a[108:111], a[140:143], a[76:79]
s_add_u32 s54, s54, 393216
s_add_u32 s55, s54, 2048
s_add_u32 s56, s54, 4096
v_mfma_f32_16x16x32_bf16 a[72:75], a[108:111], a[136:139], a[72:75]
s_add_u32 s57, s57, 40960
ds_read_b64_tr_b16 a[90:91], v13 offset:5120
v_mfma_f32_16x16x32_bf16 a[72:75], a[104:107], a[120:123], a[72:75]
s_cmp_eq_u32 s57, 122880
s_cselect_b32 s57, 0, s57
s_add_u32 s61, s59, s57
v_mfma_f32_16x16x32_bf16 a[68:71], a[104:107], a[116:119], a[68:71]
s_add_u32 s62, s60, s57
ds_read_b64_tr_b16 a[92:93], v13 offset:6144
v_mfma_f32_16x16x32_bf16 a[68:71], a[108:111], a[132:135], a[68:71]
v_mfma_f32_16x16x32_bf16 a[64:67], a[108:111], a[128:131], a[64:67]
ds_read_b64_tr_b16 a[94:95], v13 offset:7168
v_mfma_f32_16x16x32_bf16 a[64:67], a[104:107], a[112:115], a[64:67]
s_waitcnt vmcnt(11) lgkmcnt(4)
v_mfma_f32_16x16x32_bf16 v[16:19], a[80:83], a[144:147], v[16:19]
ds_read_b64_tr_b16 a[96:97], v12 offset:8192
v_mfma_f32_16x16x32_bf16 v[16:19], a[84:87], a[160:163], v[16:19]
v_mfma_f32_16x16x32_bf16 v[20:23], a[84:87], a[164:167], v[20:23]
ds_read_b64_tr_b16 a[98:99], v12 offset:9216
v_mfma_f32_16x16x32_bf16 v[20:23], a[80:83], a[148:151], v[20:23]
buffer_load_dwordx4 a[112:115], v10, s[20:23], s52 offen offset:0 sc1
v_mfma_f32_16x16x32_bf16 v[24:27], a[80:83], a[152:155], v[24:27]
ds_read_b64_tr_b16 a[100:101], v12 offset:10240
v_mfma_f32_16x16x32_bf16 v[24:27], a[84:87], a[168:171], v[24:27]
v_mfma_f32_16x16x32_bf16 v[28:31], a[84:87], a[172:175], v[28:31]
ds_read_b64_tr_b16 a[102:103], v12 offset:11264
v_mfma_f32_16x16x32_bf16 v[28:31], a[80:83], a[156:159], v[28:31]
s_waitcnt lgkmcnt(4)
v_mfma_f32_16x16x32_bf16 v[44:47], a[88:91], a[156:159], v[44:47]
ds_read_b64_tr_b16 a[104:105], v13 offset:8192
v_mfma_f32_16x16x32_bf16 v[44:47], a[92:95], a[172:175], v[44:47]
v_mfma_f32_16x16x32_bf16 v[40:43], a[92:95], a[168:171], v[40:43]
ds_read_b64_tr_b16 a[106:107], v13 offset:9216
v_mfma_f32_16x16x32_bf16 v[40:43], a[88:91], a[152:155], v[40:43]
buffer_load_dwordx4 a[116:119], v10, s[20:23], s52 offen offset:1024 sc1
v_mfma_f32_16x16x32_bf16 v[36:39], a[88:91], a[148:151], v[36:39]
ds_read_b64_tr_b16 a[108:109], v13 offset:10240
v_mfma_f32_16x16x32_bf16 v[36:39], a[92:95], a[164:167], v[36:39]
v_mfma_f32_16x16x32_bf16 v[32:35], a[92:95], a[160:163], v[32:35]
ds_read_b64_tr_b16 a[110:111], v13 offset:11264
v_mfma_f32_16x16x32_bf16 v[32:35], a[88:91], a[144:147], v[32:35]
s_waitcnt lgkmcnt(4)
v_mfma_f32_16x16x32_bf16 v[48:51], a[96:99], a[144:147], v[48:51]
ds_read_b64_tr_b16 a[80:81], v12 offset:0
v_mfma_f32_16x16x32_bf16 v[48:51], a[100:103], a[160:163], v[48:51]
v_mfma_f32_16x16x32_bf16 v[52:55], a[100:103], a[164:167], v[52:55]
ds_read_b64_tr_b16 a[82:83], v12 offset:1024
v_mfma_f32_16x16x32_bf16 v[52:55], a[96:99], a[148:151], v[52:55]
buffer_load_dwordx4 a[120:123], v11, s[20:23], s52 offen offset:0 sc1
v_mfma_f32_16x16x32_bf16 v[56:59], a[96:99], a[152:155], v[56:59]
ds_read_b64_tr_b16 a[84:85], v12 offset:2048
v_mfma_f32_16x16x32_bf16 v[56:59], a[100:103], a[168:171], v[56:59]
v_mfma_f32_16x16x32_bf16 v[60:63], a[100:103], a[172:175], v[60:63]
ds_read_b64_tr_b16 a[86:87], v12 offset:3072
v_mfma_f32_16x16x32_bf16 v[60:63], a[96:99], a[156:159], v[60:63]
s_waitcnt lgkmcnt(4)
v_mfma_f32_16x16x32_bf16 v[76:79], a[104:107], a[156:159], v[76:79]
ds_read_b64_tr_b16 a[88:89], v13 offset:0
v_mfma_f32_16x16x32_bf16 v[76:79], a[108:111], a[172:175], v[76:79]
v_mfma_f32_16x16x32_bf16 v[72:75], a[108:111], a[168:171], v[72:75]
ds_read_b64_tr_b16 a[90:91], v13 offset:1024
v_mfma_f32_16x16x32_bf16 v[72:75], a[104:107], a[152:155], v[72:75]
buffer_load_dwordx4 a[124:127], v11, s[20:23], s52 offen offset:1024 sc1
v_mfma_f32_16x16x32_bf16 v[68:71], a[104:107], a[148:151], v[68:71]
ds_read_b64_tr_b16 a[92:93], v13 offset:2048
v_mfma_f32_16x16x32_bf16 v[68:71], a[108:111], a[164:167], v[68:71]
v_mfma_f32_16x16x32_bf16 v[64:67], a[108:111], a[160:163], v[64:67]
ds_read_b64_tr_b16 a[94:95], v13 offset:3072
v_mfma_f32_16x16x32_bf16 v[64:67], a[104:107], a[144:147], v[64:67]
s_waitcnt lgkmcnt(4)
v_mfma_f32_16x16x32_bf16 a[0:3], a[80:83], a[144:147], a[0:3]
ds_read_b64_tr_b16 a[96:97], v14 offset:0
v_mfma_f32_16x16x32_bf16 a[0:3], a[84:87], a[160:163], a[0:3]
v_mfma_f32_16x16x32_bf16 a[4:7], a[84:87], a[164:167], a[4:7]
ds_read_b64_tr_b16 a[98:99], v14 offset:3584
v_mfma_f32_16x16x32_bf16 a[4:7], a[80:83], a[148:151], a[4:7]
buffer_load_dwordx4 a[128:131], v10, s[20:23], s52 offen offset:2048 sc1
v_mfma_f32_16x16x32_bf16 a[8:11], a[80:83], a[152:155], a[8:11]
ds_read_b64_tr_b16 a[100:101], v14 offset:7168
v_mfma_f32_16x16x32_bf16 a[8:11], a[84:87], a[168:171], a[8:11]
v_mfma_f32_16x16x32_bf16 a[12:15], a[84:87], a[172:175], a[12:15]
ds_read_b64_tr_b16 a[102:103], v14 offset:10752
v_mfma_f32_16x16x32_bf16 a[12:15], a[80:83], a[156:159], a[12:15]
s_waitcnt lgkmcnt(4)
v_mfma_f32_16x16x32_bf16 a[28:31], a[88:91], a[156:159], a[28:31]
ds_read_b64_tr_b16 a[104:105], v14 offset:14336
v_mfma_f32_16x16x32_bf16 a[28:31], a[92:95], a[172:175], a[28:31]
v_mfma_f32_16x16x32_bf16 a[24:27], a[92:95], a[168:171], a[24:27]
ds_read_b64_tr_b16 a[106:107], v14 offset:17920
v_mfma_f32_16x16x32_bf16 a[24:27], a[88:91], a[152:155], a[24:27]
buffer_load_dwordx4 a[132:135], v10, s[20:23], s52 offen offset:3072 sc1
v_mfma_f32_16x16x32_bf16 a[20:23], a[88:91], a[148:151], a[20:23]
ds_read_b64_tr_b16 a[108:109], v14 offset:21504
v_mfma_f32_16x16x32_bf16 a[20:23], a[92:95], a[164:167], a[20:23]
v_mfma_f32_16x16x32_bf16 a[16:19], a[92:95], a[160:163], a[16:19]
ds_read_b64_tr_b16 a[110:111], v14 offset:25088
v_mfma_f32_16x16x32_bf16 a[16:19], a[88:91], a[144:147], a[16:19]
s_waitcnt lgkmcnt(4)
v_mfma_f32_16x16x32_bf16 v[80:83], a[96:99], a[144:147], v[80:83]
ds_read_b64_tr_b16 a[80:81], v14 offset:32
v_mfma_f32_16x16x32_bf16 v[80:83], a[100:103], a[160:163], v[80:83]
v_mfma_f32_16x16x32_bf16 v[84:87], a[100:103], a[164:167], v[84:87]
ds_read_b64_tr_b16 a[82:83], v14 offset:3616
v_mfma_f32_16x16x32_bf16 v[84:87], a[96:99], a[148:151], v[84:87]
buffer_load_dwordx4 a[136:139], v11, s[20:23], s52 offen offset:2048 sc1
v_mfma_f32_16x16x32_bf16 v[88:91], a[96:99], a[152:155], v[88:91]
ds_read_b64_tr_b16 a[84:85], v14 offset:7200
v_mfma_f32_16x16x32_bf16 v[88:91], a[100:103], a[168:171], v[88:91]
v_mfma_f32_16x16x32_bf16 v[92:95], a[100:103], a[172:175], v[92:95]
ds_read_b64_tr_b16 a[86:87], v14 offset:10784
v_mfma_f32_16x16x32_bf16 v[92:95], a[96:99], a[156:159], v[92:95]
s_waitcnt lgkmcnt(4)
v_mfma_f32_16x16x32_bf16 v[204:207], a[104:107], a[156:159], v[204:207]
ds_read_b64_tr_b16 a[88:89], v14 offset:14368
v_mfma_f32_16x16x32_bf16 v[204:207], a[108:111], a[172:175], v[204:207]
v_mfma_f32_16x16x32_bf16 v[200:203], a[108:111], a[168:171], v[200:203]
ds_read_b64_tr_b16 a[90:91], v14 offset:17952
v_mfma_f32_16x16x32_bf16 v[200:203], a[104:107], a[152:155], v[200:203]
buffer_load_dwordx4 a[140:143], v11, s[20:23], s52 offen offset:3072 sc1
v_mfma_f32_16x16x32_bf16 v[196:199], a[104:107], a[148:151], v[196:199]
ds_read_b64_tr_b16 a[92:93], v14 offset:21536
v_mfma_f32_16x16x32_bf16 v[196:199], a[108:111], a[164:167], v[196:199]
v_mfma_f32_16x16x32_bf16 v[192:195], a[108:111], a[160:163], v[192:195]
ds_read_b64_tr_b16 a[94:95], v14 offset:25120
v_mfma_f32_16x16x32_bf16 v[192:195], a[104:107], a[144:147], v[192:195]
s_waitcnt lgkmcnt(4)
v_mfma_f32_16x16x32_bf16 v[96:99], a[80:83], a[144:147], v[96:99]
ds_read_b64_tr_b16 a[96:97], v14 offset:64
v_mfma_f32_16x16x32_bf16 v[96:99], a[84:87], a[160:163], v[96:99]
s_add_u32 m0, s61, 0
v_mfma_f32_16x16x32_bf16 v[100:103], a[84:87], a[164:167], v[100:103]
ds_read_b64_tr_b16 a[98:99], v14 offset:3648
v_mfma_f32_16x16x32_bf16 v[100:103], a[80:83], a[148:151], v[100:103]
buffer_load_dwordx4 v2, s[24:27], s53 offen offset:0 lds
v_mfma_f32_16x16x32_bf16 v[104:107], a[80:83], a[152:155], v[104:107]
ds_read_b64_tr_b16 a[100:101], v14 offset:7232
v_mfma_f32_16x16x32_bf16 v[104:107], a[84:87], a[168:171], v[104:107]
v_mfma_f32_16x16x32_bf16 v[108:111], a[84:87], a[172:175], v[108:111]
ds_read_b64_tr_b16 a[102:103], v14 offset:10816
v_mfma_f32_16x16x32_bf16 v[108:111], a[80:83], a[156:159], v[108:111]
s_waitcnt lgkmcnt(4)
v_mfma_f32_16x16x32_bf16 v[220:223], a[88:91], a[156:159], v[220:223]
ds_read_b64_tr_b16 a[104:105], v14 offset:14400
v_mfma_f32_16x16x32_bf16 v[220:223], a[92:95], a[172:175], v[220:223]
v_mfma_f32_16x16x32_bf16 v[216:219], a[92:95], a[168:171], v[216:219]
ds_read_b64_tr_b16 a[106:107], v14 offset:17984
v_mfma_f32_16x16x32_bf16 v[216:219], a[88:91], a[152:155], v[216:219]
buffer_load_dwordx4 v3, s[24:27], s53 offen offset:1024 lds
v_mfma_f32_16x16x32_bf16 v[212:215], a[88:91], a[148:151], v[212:215]
ds_read_b64_tr_b16 a[108:109], v14 offset:21568
v_mfma_f32_16x16x32_bf16 v[212:215], a[92:95], a[164:167], v[212:215]
v_mfma_f32_16x16x32_bf16 v[208:211], a[92:95], a[160:163], v[208:211]
ds_read_b64_tr_b16 a[110:111], v14 offset:25152
v_mfma_f32_16x16x32_bf16 v[208:211], a[88:91], a[144:147], v[208:211]
s_waitcnt lgkmcnt(4)
v_mfma_f32_16x16x32_bf16 v[112:115], a[96:99], a[144:147], v[112:115]
ds_read_b64_tr_b16 a[80:81], v14 offset:96
v_mfma_f32_16x16x32_bf16 v[112:115], a[100:103], a[160:163], v[112:115]
v_mfma_f32_16x16x32_bf16 v[116:119], a[100:103], a[164:167], v[116:119]
ds_read_b64_tr_b16 a[82:83], v14 offset:3680
v_mfma_f32_16x16x32_bf16 v[116:119], a[96:99], a[148:151], v[116:119]
buffer_load_dwordx4 v4, s[24:27], s53 offen offset:2048 lds
v_mfma_f32_16x16x32_bf16 v[120:123], a[96:99], a[152:155], v[120:123]
ds_read_b64_tr_b16 a[84:85], v14 offset:7264
v_mfma_f32_16x16x32_bf16 v[120:123], a[100:103], a[168:171], v[120:123]
v_mfma_f32_16x16x32_bf16 v[124:127], a[100:103], a[172:175], v[124:127]
ds_read_b64_tr_b16 a[86:87], v14 offset:10848
v_mfma_f32_16x16x32_bf16 v[124:127], a[96:99], a[156:159], v[124:127]
s_waitcnt lgkmcnt(4)
v_mfma_f32_16x16x32_bf16 v[236:239], a[104:107], a[156:159], v[236:239]
ds_read_b64_tr_b16 a[88:89], v14 offset:14432
v_mfma_f32_16x16x32_bf16 v[236:239], a[108:111], a[172:175], v[236:239]
v_mfma_f32_16x16x32_bf16 v[232:235], a[108:111], a[168:171], v[232:235]
ds_read_b64_tr_b16 a[90:91], v14 offset:18016
v_mfma_f32_16x16x32_bf16 v[232:235], a[104:107], a[152:155], v[232:235]
buffer_load_dwordx4 v5, s[24:27], s53 offen offset:3072 lds
v_mfma_f32_16x16x32_bf16 v[228:231], a[104:107], a[148:151], v[228:231]
ds_read_b64_tr_b16 a[92:93], v14 offset:21600
v_mfma_f32_16x16x32_bf16 v[228:231], a[108:111], a[164:167], v[228:231]
s_add_u32 s52, s52, 32768
v_mfma_f32_16x16x32_bf16 v[224:227], a[108:111], a[160:163], v[224:227]
ds_read_b64_tr_b16 a[94:95], v14 offset:25184
v_mfma_f32_16x16x32_bf16 v[224:227], a[104:107], a[144:147], v[224:227]
s_waitcnt lgkmcnt(4)
v_mfma_f32_16x16x32_bf16 v[128:131], a[80:83], a[144:147], v[128:131]
ds_read_b64_tr_b16 a[96:97], v14 offset:128
v_mfma_f32_16x16x32_bf16 v[128:131], a[84:87], a[160:163], v[128:131]
s_add_u32 m0, s61, 4096
v_mfma_f32_16x16x32_bf16 v[132:135], a[84:87], a[164:167], v[132:135]
ds_read_b64_tr_b16 a[98:99], v14 offset:3712
v_mfma_f32_16x16x32_bf16 v[132:135], a[80:83], a[148:151], v[132:135]
buffer_load_dwordx4 v6, s[24:27], s53 offen offset:0 lds
v_mfma_f32_16x16x32_bf16 v[136:139], a[80:83], a[152:155], v[136:139]
ds_read_b64_tr_b16 a[100:101], v14 offset:7296
v_mfma_f32_16x16x32_bf16 v[136:139], a[84:87], a[168:171], v[136:139]
v_mfma_f32_16x16x32_bf16 v[140:143], a[84:87], a[172:175], v[140:143]
ds_read_b64_tr_b16 a[102:103], v14 offset:10880
v_mfma_f32_16x16x32_bf16 v[140:143], a[80:83], a[156:159], v[140:143]
s_waitcnt lgkmcnt(4)
v_mfma_f32_16x16x32_bf16 v[252:255], a[88:91], a[156:159], v[252:255]
ds_read_b64_tr_b16 a[104:105], v14 offset:14464
v_mfma_f32_16x16x32_bf16 v[252:255], a[92:95], a[172:175], v[252:255]
v_mfma_f32_16x16x32_bf16 v[248:251], a[92:95], a[168:171], v[248:251]
ds_read_b64_tr_b16 a[106:107], v14 offset:18048
v_mfma_f32_16x16x32_bf16 v[248:251], a[88:91], a[152:155], v[248:251]
buffer_load_dwordx4 v7, s[24:27], s53 offen offset:1024 lds
v_mfma_f32_16x16x32_bf16 v[244:247], a[88:91], a[148:151], v[244:247]
ds_read_b64_tr_b16 a[108:109], v14 offset:21632
v_mfma_f32_16x16x32_bf16 v[244:247], a[92:95], a[164:167], v[244:247]
v_mfma_f32_16x16x32_bf16 v[240:243], a[92:95], a[160:163], v[240:243]
ds_read_b64_tr_b16 a[110:111], v14 offset:25216
v_mfma_f32_16x16x32_bf16 v[240:243], a[88:91], a[144:147], v[240:243]
s_waitcnt lgkmcnt(4)
v_mfma_f32_16x16x32_bf16 v[144:147], a[96:99], a[144:147], v[144:147]
ds_read_b64_tr_b16 a[80:81], v14 offset:160
v_mfma_f32_16x16x32_bf16 v[144:147], a[100:103], a[160:163], v[144:147]
v_mfma_f32_16x16x32_bf16 v[148:151], a[100:103], a[164:167], v[148:151]
ds_read_b64_tr_b16 a[82:83], v14 offset:3744
v_mfma_f32_16x16x32_bf16 v[148:151], a[96:99], a[148:151], v[148:151]
buffer_load_dwordx4 v8, s[24:27], s53 offen offset:2048 lds
v_mfma_f32_16x16x32_bf16 v[152:155], a[96:99], a[152:155], v[152:155]
ds_read_b64_tr_b16 a[84:85], v14 offset:7328
v_mfma_f32_16x16x32_bf16 v[152:155], a[100:103], a[168:171], v[152:155]
v_mfma_f32_16x16x32_bf16 v[156:159], a[100:103], a[172:175], v[156:159]
ds_read_b64_tr_b16 a[86:87], v14 offset:10912
v_mfma_f32_16x16x32_bf16 v[156:159], a[96:99], a[156:159], v[156:159]
s_waitcnt lgkmcnt(4)
v_mfma_f32_16x16x32_bf16 a[44:47], a[104:107], a[156:159], a[44:47]
ds_read_b64_tr_b16 a[88:89], v14 offset:14496
v_mfma_f32_16x16x32_bf16 a[44:47], a[108:111], a[172:175], a[44:47]
s_add_u32 m0, s62, 0
v_mfma_f32_16x16x32_bf16 a[40:43], a[108:111], a[168:171], a[40:43]
ds_read_b64_tr_b16 a[90:91], v14 offset:18080
v_mfma_f32_16x16x32_bf16 a[40:43], a[104:107], a[152:155], a[40:43]
buffer_load_dwordx4 v9, s[28:31], s54 offen lds
v_mfma_f32_16x16x32_bf16 a[36:39], a[104:107], a[148:151], a[36:39]
ds_read_b64_tr_b16 a[92:93], v14 offset:21664
v_mfma_f32_16x16x32_bf16 a[36:39], a[108:111], a[164:167], a[36:39]
v_mfma_f32_16x16x32_bf16 a[32:35], a[108:111], a[160:163], a[32:35]
ds_read_b64_tr_b16 a[94:95], v14 offset:25248
v_mfma_f32_16x16x32_bf16 a[32:35], a[104:107], a[144:147], a[32:35]
s_waitcnt lgkmcnt(4)
v_mfma_f32_16x16x32_bf16 v[160:163], a[80:83], a[144:147], v[160:163]
ds_read_b64_tr_b16 a[96:97], v14 offset:192
L_pad1:
s_cbranch_execz L_pad5
v_mfma_f32_16x16x32_bf16 v[160:163], a[84:87], a[160:163], v[160:163]
s_add_u32 m0, s62, 4096
v_mfma_f32_16x16x32_bf16 v[164:167], a[84:87], a[164:167], v[164:167]
ds_read_b64_tr_b16 a[98:99], v14 offset:3776
v_mfma_f32_16x16x32_bf16 v[164:167], a[80:83], a[148:151], v[164:167]
buffer_load_dwordx4 v9, s[28:31], s55 offen lds
v_mfma_f32_16x16x32_bf16 v[168:171], a[80:83], a[152:155], v[168:171]
ds_read_b64_tr_b16 a[100:101], v14 offset:7360
v_mfma_f32_16x16x32_bf16 v[168:171], a[84:87], a[168:171], v[168:171]
v_mfma_f32_16x16x32_bf16 v[172:175], a[84:87], a[172:175], v[172:175]
ds_read_b64_tr_b16 a[102:103], v14 offset:10944
v_mfma_f32_16x16x32_bf16 v[172:175], a[80:83], a[156:159], v[172:175]
s_waitcnt lgkmcnt(4)
v_mfma_f32_16x16x32_bf16 a[60:63], a[88:91], a[156:159], a[60:63]
ds_read_b64_tr_b16 a[104:105], v14 offset:14528
v_mfma_f32_16x16x32_bf16 a[60:63], a[92:95], a[172:175], a[60:63]
s_add_u32 m0, s62, 8192
v_mfma_f32_16x16x32_bf16 a[56:59], a[92:95], a[168:171], a[56:59]
ds_read_b64_tr_b16 a[106:107], v14 offset:18112
v_mfma_f32_16x16x32_bf16 a[56:59], a[88:91], a[152:155], a[56:59]
buffer_load_dwordx4 v9, s[28:31], s56 offen lds
v_mfma_f32_16x16x32_bf16 a[52:55], a[88:91], a[148:151], a[52:55]
ds_read_b64_tr_b16 a[108:109], v14 offset:21696
v_mfma_f32_16x16x32_bf16 a[52:55], a[92:95], a[164:167], a[52:55]
buffer_load_dword a184, v15, s[28:31], s0 offen
v_mfma_f32_16x16x32_bf16 a[48:51], a[92:95], a[160:163], a[48:51]
ds_read_b64_tr_b16 a[110:111], v14 offset:25280
buffer_load_dword a184, v10, s[72:75], s8 offen
v_mfma_f32_16x16x32_bf16 a[48:51], a[88:91], a[144:147], a[48:51]
buffer_load_dword a184, v10, s[32:35], s8 offen
s_waitcnt lgkmcnt(4)
v_mfma_f32_16x16x32_bf16 v[176:179], a[96:99], a[144:147], v[176:179]
s_add_u32 s58, s58, 40960
s_cmp_eq_u32 s58, 122880
s_cselect_b32 s58, 0, s58
v_mfma_f32_16x16x32_bf16 v[176:179], a[100:103], a[160:163], v[176:179]
s_cselect_b32 s63, 4294885376, s64
v_add_u32 v12, s63, v12
v_add_u32 v13, s63, v13
v_mfma_f32_16x16x32_bf16 v[180:183], a[100:103], a[164:167], v[180:183]
v_add_u32 v14, s63, v14
v_mfma_f32_16x16x32_bf16 v[180:183], a[96:99], a[148:151], v[180:183]
s_waitcnt vmcnt(21) lgkmcnt(0)
s_barrier
v_mfma_f32_16x16x32_bf16 v[184:187], a[96:99], a[152:155], v[184:187]
ds_read_b64_tr_b16 a[80:81], v12 offset:4096
v_mfma_f32_16x16x32_bf16 v[184:187], a[100:103], a[168:171], v[184:187]
ds_read_b64_tr_b16 a[82:83], v12 offset:5120
v_mfma_f32_16x16x32_bf16 v[188:191], a[100:103], a[172:175], v[188:191]
ds_read_b64_tr_b16 a[84:85], v12 offset:6144
v_mfma_f32_16x16x32_bf16 v[188:191], a[96:99], a[156:159], v[188:191]
ds_read_b64_tr_b16 a[86:87], v12 offset:7168
v_mfma_f32_16x16x32_bf16 a[76:79], a[104:107], a[156:159], a[76:79]
s_add_u32 s53, s53, 458752
ds_read_b64_tr_b16 a[88:89], v13 offset:4096
v_mfma_f32_16x16x32_bf16 a[76:79], a[108:111], a[172:175], a[76:79]
s_add_u32 s54, s54, 393216
s_add_u32 s55, s54, 2048
s_add_u32 s56, s54, 4096
v_mfma_f32_16x16x32_bf16 a[72:75], a[108:111], a[168:171], a[72:75]
s_add_u32 s57, s57, 40960
ds_read_b64_tr_b16 a[90:91], v13 offset:5120
v_mfma_f32_16x16x32_bf16 a[72:75], a[104:107], a[152:155], a[72:75]
s_cmp_eq_u32 s57, 122880
s_cselect_b32 s57, 0, s57
s_add_u32 s61, s59, s57
v_mfma_f32_16x16x32_bf16 a[68:71], a[104:107], a[148:151], a[68:71]
s_add_u32 s62, s60, s57
ds_read_b64_tr_b16 a[92:93], v13 offset:6144
v_mfma_f32_16x16x32_bf16 a[68:71], a[108:111], a[164:167], a[68:71]
v_mfma_f32_16x16x32_bf16 a[64:67], a[108:111], a[160:163], a[64:67]
ds_read_b64_tr_b16 a[94:95], v13 offset:7168
v_mfma_f32_16x16x32_bf16 a[64:67], a[104:107], a[144:147], a[64:67]
s_sub_u32 s65, s65, 1
s_cmp_lg_u32 s65, 0
s_cbranch_scc1 L_loop
s_waitcnt vmcnt(13) lgkmcnt(4)
v_mfma_f32_16x16x32_bf16 v[16:19], a[80:83], a[112:115], v[16:19]
ds_read_b64_tr_b16 a[96:97], v12 offset:8192
v_lshrrev_b32 v1, 4, v0
v_mfma_f32_16x16x32_bf16 v[16:19], a[84:87], a[128:131], v[16:19]
v_bfe_u32 v8, v0, 1, 3
v_xor_b32 v8, v8, v1
v_mfma_f32_16x16x32_bf16 v[20:23], a[84:87], a[132:135], v[20:23]
ds_read_b64_tr_b16 a[98:99], v12 offset:9216
v_lshlrev_b32 v8, 5, v8
v_mfma_f32_16x16x32_bf16 v[20:23], a[80:83], a[116:119], v[20:23]
buffer_load_dwordx4 a[144:147], v10, s[20:23], s52 offen offset:0 sc1
v_and_b32 v9, 1, v0
v_mfma_f32_16x16x32_bf16 v[24:27], a[80:83], a[120:123], v[24:27]
ds_read_b64_tr_b16 a[100:101], v12 offset:10240
v_lshl_add_u32 v8, v9, 4, v8
v_mfma_f32_16x16x32_bf16 v[24:27], a[84:87], a[136:139], v[24:27]
s_lshl_b32 s16, s66, 15
v_lshl_add_u32 v2, v1, 11, v8
v_add_u32 v2, s16, v2
v_mfma_f32_16x16x32_bf16 v[28:31], a[84:87], a[140:143], v[28:31]
ds_read_b64_tr_b16 a[102:103], v12 offset:11264
v_xor_b32 v3, 128, v2
v_mfma_f32_16x16x32_bf16 v[28:31], a[80:83], a[124:127], v[28:31]
s_waitcnt lgkmcnt(4)
v_add_u32 v3, 8192, v3
v_add_u32 v4, 16384, v2
v_mfma_f32_16x16x32_bf16 v[44:47], a[88:91], a[124:127], v[44:47]
ds_read_b64_tr_b16 a[104:105], v13 offset:8192
v_add_u32 v5, 16384, v3
v_mfma_f32_16x16x32_bf16 v[44:47], a[92:95], a[140:143], v[44:47]
v_bfe_u32 v8, v0, 1, 2
v_xor_b32 v8, v8, v1
v_mfma_f32_16x16x32_bf16 v[40:43], a[92:95], a[136:139], v[40:43]
ds_read_b64_tr_b16 a[106:107], v13 offset:9216
v_lshlrev_b32 v8, 5, v8
v_mfma_f32_16x16x32_bf16 v[40:43], a[88:91], a[120:123], v[40:43]
buffer_load_dwordx4 a[148:151], v10, s[20:23], s52 offen offset:1024 sc1
v_lshl_add_u32 v8, v9, 4, v8
v_mfma_f32_16x16x32_bf16 v[36:39], a[88:91], a[116:119], v[36:39]
ds_read_b64_tr_b16 a[108:109], v13 offset:10240
v_lshrrev_b32 v1, 3, v0
v_mfma_f32_16x16x32_bf16 v[36:39], a[92:95], a[132:135], v[36:39]
s_lshl_b32 s16, s3, 15
s_add_u32 s16, s16, s92
v_lshl_add_u32 v6, v1, 11, v8
v_mfma_f32_16x16x32_bf16 v[32:35], a[92:95], a[128:131], v[32:35]
ds_read_b64_tr_b16 a[110:111], v13 offset:11264
v_add_u32 v6, s16, v6
v_mfma_f32_16x16x32_bf16 v[32:35], a[88:91], a[112:115], v[32:35]
s_waitcnt lgkmcnt(4)
v_add_u32 v7, 16384, v6
v_min_u32 v15, 63, v0
v_mfma_f32_16x16x32_bf16 v[48:51], a[96:99], a[112:115], v[48:51]
ds_read_b64_tr_b16 a[80:81], v12 offset:0
v_lshlrev_b32 v15, 7, v15
v_mfma_f32_16x16x32_bf16 v[48:51], a[100:103], a[128:131], v[48:51]
s_getpc_b64 s[76:77]
Lcode_here:
v_mfma_f32_16x16x32_bf16 v[52:55], a[100:103], a[132:135], v[52:55]
s_mov_b32 s78, L_end-Lcode_here
ds_read_b64_tr_b16 a[82:83], v12 offset:1024
s_mov_b32 s79, 0x20000
v_mfma_f32_16x16x32_bf16 v[52:55], a[96:99], a[116:119], v[52:55]
s_bfe_u32 s16, s2, 0x10003
buffer_load_dwordx4 a[152:155], v11, s[20:23], s52 offen offset:0 sc1
s_lshl_b32 s16, s16, 2
v_mfma_f32_16x16x32_bf16 v[56:59], a[96:99], a[120:123], v[56:59]
s_add_u32 s16, s16, s3
ds_read_b64_tr_b16 a[84:85], v12 offset:2048
s_lshl_b32 s60, s16, 13
v_mfma_f32_16x16x32_bf16 v[56:59], a[100:103], a[136:139], v[56:59]
v_lshlrev_b32 v8, 7, v0
v_and_b32 v8, 0x380, v8
v_mfma_f32_16x16x32_bf16 v[60:63], a[100:103], a[140:143], v[60:63]
ds_read_b64_tr_b16 a[86:87], v12 offset:3072
v_add_u32 v9, s69, v8
v_mfma_f32_16x16x32_bf16 v[60:63], a[96:99], a[124:127], v[60:63]
s_waitcnt lgkmcnt(4)
v_add_u32 v1, s97, v8
v_cmp_le_u32 vcc, 8, v0
v_mfma_f32_16x16x32_bf16 v[76:79], a[104:107], a[124:127], v[76:79]
ds_read_b64_tr_b16 a[88:89], v13 offset:0
v_cndmask_b32 v9, v9, v1, vcc
v_mfma_f32_16x16x32_bf16 v[76:79], a[108:111], a[140:143], v[76:79]
v_add_u32 v1, s99, v8
v_cmp_le_u32 vcc, 16, v0
v_mfma_f32_16x16x32_bf16 v[72:75], a[108:111], a[136:139], v[72:75]
ds_read_b64_tr_b16 a[90:91], v13 offset:1024
v_and_b32 v8, 0x180, v8
v_mfma_f32_16x16x32_bf16 v[72:75], a[104:107], a[120:123], v[72:75]
buffer_load_dwordx4 a[156:159], v11, s[20:23], s52 offen offset:1024 sc1
v_cndmask_b32 v9, v9, v1, vcc
v_mfma_f32_16x16x32_bf16 v[68:71], a[104:107], a[116:119], v[68:71]
ds_read_b64_tr_b16 a[92:93], v13 offset:2048
v_add_u32 v1, s71, v8
v_mfma_f32_16x16x32_bf16 v[68:71], a[108:111], a[132:135], v[68:71]
v_cmp_le_u32 vcc, 24, v0
v_mfma_f32_16x16x32_bf16 v[64:67], a[108:111], a[128:131], v[64:67]
ds_read_b64_tr_b16 a[94:95], v13 offset:3072
v_cndmask_b32 v9, v9, v1, vcc
v_mfma_f32_16x16x32_bf16 v[64:67], a[104:107], a[112:115], v[64:67]
s_waitcnt lgkmcnt(4)
v_and_b32 v8, 15, v0
s_lshl_b32 s16, s18, 2
v_mfma_f32_16x16x32_bf16 a[0:3], a[80:83], a[112:115], a[0:3]
s_add_u32 s16, s16, s3
ds_read_b64_tr_b16 a[96:97], v14 offset:0
s_lshl_b32 s16, s16, 1
v_mfma_f32_16x16x32_bf16 a[0:3], a[84:87], a[128:131], a[0:3]
s_lshr_b32 s12, s17, 1
s_add_u32 s16, s16, s12
s_lshl_b32 s16, s16, 5
v_mfma_f32_16x16x32_bf16 a[4:7], a[84:87], a[132:135], a[4:7]
ds_read_b64_tr_b16 a[98:99], v14 offset:3584
v_add_u32 v8, s16, v8
v_mfma_f32_16x16x32_bf16 a[4:7], a[80:83], a[116:119], a[4:7]
buffer_load_dwordx4 a[160:163], v10, s[20:23], s52 offen offset:2048 sc1
v_lshlrev_b32 v8, 11, v8
v_mfma_f32_16x16x32_bf16 a[8:11], a[80:83], a[120:123], a[8:11]
ds_read_b64_tr_b16 a[100:101], v14 offset:7168
v_bfe_u32 v1, v0, 4, 1
v_mfma_f32_16x16x32_bf16 a[8:11], a[84:87], a[136:139], a[8:11]
v_lshl_add_u32 v8, v1, 5, v8
v_lshrrev_b32 v1, 5, v0
v_mfma_f32_16x16x32_bf16 a[12:15], a[84:87], a[140:143], a[12:15]
ds_read_b64_tr_b16 a[102:103], v14 offset:10752
v_lshl_add_u32 v8, v1, 4, v8
v_mfma_f32_16x16x32_bf16 a[12:15], a[80:83], a[124:127], a[12:15]
s_waitcnt lgkmcnt(4)
s_add_u32 s65, s92, 32768
s_xor_b32 s8, s67, 1
v_mfma_f32_16x16x32_bf16 a[28:31], a[88:91], a[124:127], a[28:31]
s_lshl_b32 s8, s8, 16
ds_read_b64_tr_b16 a[104:105], v14 offset:14336
s_add_u32 s8, s8, s80
v_mfma_f32_16x16x32_bf16 a[28:31], a[92:95], a[140:143], a[28:31]
s_mov_b32 s24, 0xbdd2d3e8
s_mov_b32 s25, 0xc0135761
s_mov_b32 s26, 0xbfb8aa3b
v_mfma_f32_16x16x32_bf16 a[24:27], a[92:95], a[136:139], a[24:27]
s_mov_b32 s28, 0x3fb8aa3b
ds_read_b64_tr_b16 a[106:107], v14 offset:17920
v_mfma_f32_16x16x32_bf16 a[24:27], a[88:91], a[120:123], a[24:27]
buffer_load_dwordx4 a[164:167], v10, s[20:23], s52 offen offset:3072 sc1
v_mfma_f32_16x16x32_bf16 a[20:23], a[88:91], a[116:119], a[20:23]
ds_read_b64_tr_b16 a[108:109], v14 offset:21504
v_mfma_f32_16x16x32_bf16 a[20:23], a[92:95], a[132:135], a[20:23]
v_mfma_f32_16x16x32_bf16 a[16:19], a[92:95], a[128:131], a[16:19]
ds_read_b64_tr_b16 a[110:111], v14 offset:25088
v_mfma_f32_16x16x32_bf16 a[16:19], a[88:91], a[112:115], a[16:19]
s_waitcnt lgkmcnt(4)
v_mfma_f32_16x16x32_bf16 v[80:83], a[96:99], a[112:115], v[80:83]
ds_read_b64_tr_b16 a[80:81], v14 offset:32
v_mfma_f32_16x16x32_bf16 v[80:83], a[100:103], a[128:131], v[80:83]
v_mfma_f32_16x16x32_bf16 v[84:87], a[100:103], a[132:135], v[84:87]
ds_read_b64_tr_b16 a[82:83], v14 offset:3616
v_mfma_f32_16x16x32_bf16 v[84:87], a[96:99], a[116:119], v[84:87]
buffer_load_dwordx4 a[168:171], v11, s[20:23], s52 offen offset:2048 sc1
v_mfma_f32_16x16x32_bf16 v[88:91], a[96:99], a[120:123], v[88:91]
ds_read_b64_tr_b16 a[84:85], v14 offset:7200
v_mfma_f32_16x16x32_bf16 v[88:91], a[100:103], a[136:139], v[88:91]
v_mfma_f32_16x16x32_bf16 v[92:95], a[100:103], a[140:143], v[92:95]
ds_read_b64_tr_b16 a[86:87], v14 offset:10784
v_mfma_f32_16x16x32_bf16 v[92:95], a[96:99], a[124:127], v[92:95]
s_waitcnt lgkmcnt(4)
v_mfma_f32_16x16x32_bf16 v[204:207], a[104:107], a[124:127], v[204:207]
ds_read_b64_tr_b16 a[88:89], v14 offset:14368
v_mfma_f32_16x16x32_bf16 v[204:207], a[108:111], a[140:143], v[204:207]
v_mfma_f32_16x16x32_bf16 v[200:203], a[108:111], a[136:139], v[200:203]
ds_read_b64_tr_b16 a[90:91], v14 offset:17952
v_mfma_f32_16x16x32_bf16 v[200:203], a[104:107], a[120:123], v[200:203]
buffer_load_dwordx4 a[172:175], v11, s[20:23], s52 offen offset:3072 sc1
v_mfma_f32_16x16x32_bf16 v[196:199], a[104:107], a[116:119], v[196:199]
ds_read_b64_tr_b16 a[92:93], v14 offset:21536
v_mfma_f32_16x16x32_bf16 v[196:199], a[108:111], a[132:135], v[196:199]
v_mfma_f32_16x16x32_bf16 v[192:195], a[108:111], a[128:131], v[192:195]
ds_read_b64_tr_b16 a[94:95], v14 offset:25120
v_mfma_f32_16x16x32_bf16 v[192:195], a[104:107], a[112:115], v[192:195]
s_waitcnt lgkmcnt(4)
v_mfma_f32_16x16x32_bf16 v[96:99], a[80:83], a[112:115], v[96:99]
ds_read_b64_tr_b16 a[96:97], v14 offset:64
v_mfma_f32_16x16x32_bf16 v[96:99], a[84:87], a[128:131], v[96:99]
v_mfma_f32_16x16x32_bf16 v[100:103], a[84:87], a[132:135], v[100:103]
ds_read_b64_tr_b16 a[98:99], v14 offset:3648
v_mfma_f32_16x16x32_bf16 v[100:103], a[80:83], a[116:119], v[100:103]
buffer_load_dword a184, v15, s[76:79], s60 offen
v_mfma_f32_16x16x32_bf16 v[104:107], a[80:83], a[120:123], v[104:107]
ds_read_b64_tr_b16 a[100:101], v14 offset:7232
v_mfma_f32_16x16x32_bf16 v[104:107], a[84:87], a[136:139], v[104:107]
buffer_load_dword a184, v9, s[48:51], 0 offen sc1
v_mfma_f32_16x16x32_bf16 v[108:111], a[84:87], a[140:143], v[108:111]
ds_read_b64_tr_b16 a[102:103], v14 offset:10816
v_mfma_f32_16x16x32_bf16 v[108:111], a[80:83], a[124:127], v[108:111]
s_waitcnt lgkmcnt(4)
v_mfma_f32_16x16x32_bf16 v[220:223], a[88:91], a[124:127], v[220:223]
ds_read_b64_tr_b16 a[104:105], v14 offset:14400
v_mfma_f32_16x16x32_bf16 v[220:223], a[92:95], a[140:143], v[220:223]
s_add_u32 m0, s90, 49152
s_add_u32 s54, s84, 0
v_mfma_f32_16x16x32_bf16 v[216:219], a[92:95], a[136:139], v[216:219]
ds_read_b64_tr_b16 a[106:107], v14 offset:17984
v_mfma_f32_16x16x32_bf16 v[216:219], a[88:91], a[120:123], v[216:219]
buffer_load_dwordx4 v2, s[72:75], s54 offen lds
v_mfma_f32_16x16x32_bf16 v[212:215], a[88:91], a[116:119], v[212:215]
ds_read_b64_tr_b16 a[108:109], v14 offset:21568
v_mfma_f32_16x16x32_bf16 v[212:215], a[92:95], a[132:135], v[212:215]
v_mfma_f32_16x16x32_bf16 v[208:211], a[92:95], a[128:131], v[208:211]
ds_read_b64_tr_b16 a[110:111], v14 offset:25152
v_mfma_f32_16x16x32_bf16 v[208:211], a[88:91], a[112:115], v[208:211]
s_waitcnt lgkmcnt(4)
v_mfma_f32_16x16x32_bf16 v[112:115], a[96:99], a[112:115], v[112:115]
ds_read_b64_tr_b16 a[80:81], v14 offset:96
v_mfma_f32_16x16x32_bf16 v[112:115], a[100:103], a[128:131], v[112:115]
s_add_u32 m0, s90, 50176
v_mfma_f32_16x16x32_bf16 v[116:119], a[100:103], a[132:135], v[116:119]
ds_read_b64_tr_b16 a[82:83], v14 offset:3680
v_mfma_f32_16x16x32_bf16 v[116:119], a[96:99], a[116:119], v[116:119]
buffer_load_dwordx4 v3, s[72:75], s54 offen lds
v_mfma_f32_16x16x32_bf16 v[120:123], a[96:99], a[120:123], v[120:123]
ds_read_b64_tr_b16 a[84:85], v14 offset:7264
v_mfma_f32_16x16x32_bf16 v[120:123], a[100:103], a[136:139], v[120:123]
v_mfma_f32_16x16x32_bf16 v[124:127], a[100:103], a[140:143], v[124:127]
ds_read_b64_tr_b16 a[86:87], v14 offset:10848
v_mfma_f32_16x16x32_bf16 v[124:127], a[96:99], a[124:127], v[124:127]
s_waitcnt lgkmcnt(4)
v_mfma_f32_16x16x32_bf16 v[236:239], a[104:107], a[124:127], v[236:239]
ds_read_b64_tr_b16 a[88:89], v14 offset:14432
v_mfma_f32_16x16x32_bf16 v[236:239], a[108:111], a[140:143], v[236:239]
s_add_u32 m0, s90, 51200
v_mfma_f32_16x16x32_bf16 v[232:235], a[108:111], a[136:139], v[232:235]
ds_read_b64_tr_b16 a[90:91], v14 offset:18016
v_mfma_f32_16x16x32_bf16 v[232:235], a[104:107], a[120:123], v[232:235]
buffer_load_dwordx4 v4, s[72:75], s54 offen lds
v_mfma_f32_16x16x32_bf16 v[228:231], a[104:107], a[116:119], v[228:231]
ds_read_b64_tr_b16 a[92:93], v14 offset:21600
v_mfma_f32_16x16x32_bf16 v[228:231], a[108:111], a[132:135], v[228:231]
v_mfma_f32_16x16x32_bf16 v[224:227], a[108:111], a[128:131], v[224:227]
ds_read_b64_tr_b16 a[94:95], v14 offset:25184
v_mfma_f32_16x16x32_bf16 v[224:227], a[104:107], a[112:115], v[224:227]
s_waitcnt lgkmcnt(4)
v_mfma_f32_16x16x32_bf16 v[128:131], a[80:83], a[112:115], v[128:131]
ds_read_b64_tr_b16 a[96:97], v14 offset:128
v_mfma_f32_16x16x32_bf16 v[128:131], a[84:87], a[128:131], v[128:131]
s_add_u32 m0, s90, 52224
v_mfma_f32_16x16x32_bf16 v[132:135], a[84:87], a[132:135], v[132:135]
ds_read_b64_tr_b16 a[98:99], v14 offset:3712
v_mfma_f32_16x16x32_bf16 v[132:135], a[80:83], a[116:119], v[132:135]
buffer_load_dwordx4 v5, s[72:75], s54 offen lds
v_mfma_f32_16x16x32_bf16 v[136:139], a[80:83], a[120:123], v[136:139]
ds_read_b64_tr_b16 a[100:101], v14 offset:7296
v_mfma_f32_16x16x32_bf16 v[136:139], a[84:87], a[136:139], v[136:139]
v_mfma_f32_16x16x32_bf16 v[140:143], a[84:87], a[140:143], v[140:143]
ds_read_b64_tr_b16 a[102:103], v14 offset:10880
v_mfma_f32_16x16x32_bf16 v[140:143], a[80:83], a[124:127], v[140:143]
s_waitcnt lgkmcnt(4)
v_mfma_f32_16x16x32_bf16 v[252:255], a[88:91], a[124:127], v[252:255]
ds_read_b64_tr_b16 a[104:105], v14 offset:14464
v_mfma_f32_16x16x32_bf16 v[252:255], a[92:95], a[140:143], v[252:255]
s_add_u32 m0, s90, 65536
s_add_u32 s54, s85, 0
v_mfma_f32_16x16x32_bf16 v[248:251], a[92:95], a[136:139], v[248:251]
ds_read_b64_tr_b16 a[106:107], v14 offset:18048
v_mfma_f32_16x16x32_bf16 v[248:251], a[88:91], a[120:123], v[248:251]
buffer_load_dwordx4 v2, s[72:75], s54 offen lds
v_mfma_f32_16x16x32_bf16 v[244:247], a[88:91], a[116:119], v[244:247]
ds_read_b64_tr_b16 a[108:109], v14 offset:21632
v_mfma_f32_16x16x32_bf16 v[244:247], a[92:95], a[132:135], v[244:247]
v_mfma_f32_16x16x32_bf16 v[240:243], a[92:95], a[128:131], v[240:243]
ds_read_b64_tr_b16 a[110:111], v14 offset:25216
v_mfma_f32_16x16x32_bf16 v[240:243], a[88:91], a[112:115], v[240:243]
s_waitcnt lgkmcnt(4)
v_mfma_f32_16x16x32_bf16 v[144:147], a[96:99], a[112:115], v[144:147]
ds_read_b64_tr_b16 a[80:81], v14 offset:160
v_mfma_f32_16x16x32_bf16 v[144:147], a[100:103], a[128:131], v[144:147]
s_add_u32 m0, s90, 66560
v_mfma_f32_16x16x32_bf16 v[148:151], a[100:103], a[132:135], v[148:151]
ds_read_b64_tr_b16 a[82:83], v14 offset:3744
v_mfma_f32_16x16x32_bf16 v[148:151], a[96:99], a[116:119], v[148:151]
buffer_load_dwordx4 v3, s[72:75], s54 offen lds
v_mfma_f32_16x16x32_bf16 v[152:155], a[96:99], a[120:123], v[152:155]
ds_read_b64_tr_b16 a[84:85], v14 offset:7328
v_mfma_f32_16x16x32_bf16 v[152:155], a[100:103], a[136:139], v[152:155]
v_mfma_f32_16x16x32_bf16 v[156:159], a[100:103], a[140:143], v[156:159]
ds_read_b64_tr_b16 a[86:87], v14 offset:10912
v_mfma_f32_16x16x32_bf16 v[156:159], a[96:99], a[124:127], v[156:159]
s_waitcnt lgkmcnt(4)
v_mfma_f32_16x16x32_bf16 a[44:47], a[104:107], a[124:127], a[44:47]
ds_read_b64_tr_b16 a[88:89], v14 offset:14496
v_mfma_f32_16x16x32_bf16 a[44:47], a[108:111], a[140:143], a[44:47]
s_add_u32 m0, s90, 67584
v_mfma_f32_16x16x32_bf16 a[40:43], a[108:111], a[136:139], a[40:43]
ds_read_b64_tr_b16 a[90:91], v14 offset:18080
v_mfma_f32_16x16x32_bf16 a[40:43], a[104:107], a[120:123], a[40:43]
buffer_load_dwordx4 v4, s[72:75], s54 offen lds
v_mfma_f32_16x16x32_bf16 a[36:39], a[104:107], a[116:119], a[36:39]
ds_read_b64_tr_b16 a[92:93], v14 offset:21664
v_mfma_f32_16x16x32_bf16 a[36:39], a[108:111], a[132:135], a[36:39]
v_mfma_f32_16x16x32_bf16 a[32:35], a[108:111], a[128:131], a[32:35]
ds_read_b64_tr_b16 a[94:95], v14 offset:25248
v_mfma_f32_16x16x32_bf16 a[32:35], a[104:107], a[112:115], a[32:35]
s_waitcnt lgkmcnt(4)
v_mfma_f32_16x16x32_bf16 v[160:163], a[80:83], a[112:115], v[160:163]
ds_read_b64_tr_b16 a[96:97], v14 offset:192
v_mfma_f32_16x16x32_bf16 v[160:163], a[84:87], a[128:131], v[160:163]
s_add_u32 m0, s90, 68608
v_mfma_f32_16x16x32_bf16 v[164:167], a[84:87], a[132:135], v[164:167]
ds_read_b64_tr_b16 a[98:99], v14 offset:3776
v_mfma_f32_16x16x32_bf16 v[164:167], a[80:83], a[116:119], v[164:167]
buffer_load_dwordx4 v5, s[72:75], s54 offen lds
v_mfma_f32_16x16x32_bf16 v[168:171], a[80:83], a[120:123], v[168:171]
ds_read_b64_tr_b16 a[100:101], v14 offset:7360
v_mfma_f32_16x16x32_bf16 v[168:171], a[84:87], a[136:139], v[168:171]
v_mfma_f32_16x16x32_bf16 v[172:175], a[84:87], a[140:143], v[172:175]
ds_read_b64_tr_b16 a[102:103], v14 offset:10944
v_mfma_f32_16x16x32_bf16 v[172:175], a[80:83], a[124:127], v[172:175]
s_waitcnt lgkmcnt(4)
v_mfma_f32_16x16x32_bf16 a[60:63], a[88:91], a[124:127], a[60:63]
ds_read_b64_tr_b16 a[104:105], v14 offset:14528
v_mfma_f32_16x16x32_bf16 a[60:63], a[92:95], a[140:143], a[60:63]
s_add_u32 m0, s91, 131072
s_add_u32 s55, s93, 0
s_and_b32 s55, s55, 0x1fffff
v_mfma_f32_16x16x32_bf16 a[56:59], a[92:95], a[136:139], a[56:59]
ds_read_b64_tr_b16 a[106:107], v14 offset:18112
v_mfma_f32_16x16x32_bf16 a[56:59], a[88:91], a[120:123], a[56:59]
buffer_load_dwordx4 v6, s[32:35], s55 offen lds
v_mfma_f32_16x16x32_bf16 a[52:55], a[88:91], a[116:119], a[52:55]
ds_read_b64_tr_b16 a[108:109], v14 offset:21696
v_mfma_f32_16x16x32_bf16 a[52:55], a[92:95], a[132:135], a[52:55]
v_mfma_f32_16x16x32_bf16 a[48:51], a[92:95], a[128:131], a[48:51]
ds_read_b64_tr_b16 a[110:111], v14 offset:25280
v_mfma_f32_16x16x32_bf16 a[48:51], a[88:91], a[112:115], a[48:51]
s_waitcnt lgkmcnt(4)
v_mfma_f32_16x16x32_bf16 v[176:179], a[96:99], a[112:115], v[176:179]
s_add_u32 s58, s58, 40960
s_cmp_eq_u32 s58, 122880
s_cselect_b32 s58, 0, s58
v_mfma_f32_16x16x32_bf16 v[176:179], a[100:103], a[128:131], v[176:179]
s_cselect_b32 s63, 4294885376, s64
v_add_u32 v12, s63, v12
v_add_u32 v13, s63, v13
v_mfma_f32_16x16x32_bf16 v[180:183], a[100:103], a[132:135], v[180:183]
v_add_u32 v14, s63, v14
buffer_load_dwordx4 a[252:255], v8, s[4:7], s92 offen offset:0
v_mfma_f32_16x16x32_bf16 v[180:183], a[96:99], a[116:119], v[180:183]
s_waitcnt vmcnt(20) lgkmcnt(0)
s_barrier
v_mfma_f32_16x16x32_bf16 v[184:187], a[96:99], a[120:123], v[184:187]
ds_read_b64_tr_b16 a[80:81], v12 offset:4096
v_mfma_f32_16x16x32_bf16 v[184:187], a[100:103], a[136:139], v[184:187]
ds_read_b64_tr_b16 a[82:83], v12 offset:5120
v_mfma_f32_16x16x32_bf16 v[188:191], a[100:103], a[140:143], v[188:191]
ds_read_b64_tr_b16 a[84:85], v12 offset:6144
v_mfma_f32_16x16x32_bf16 v[188:191], a[96:99], a[124:127], v[188:191]
ds_read_b64_tr_b16 a[86:87], v12 offset:7168
v_mfma_f32_16x16x32_bf16 a[76:79], a[104:107], a[124:127], a[76:79]
ds_read_b64_tr_b16 a[88:89], v13 offset:4096
v_mfma_f32_16x16x32_bf16 a[76:79], a[108:111], a[140:143], a[76:79]
v_mfma_f32_16x16x32_bf16 a[72:75], a[108:111], a[136:139], a[72:75]
ds_read_b64_tr_b16 a[90:91], v13 offset:5120
v_mfma_f32_16x16x32_bf16 a[72:75], a[104:107], a[120:123], a[72:75]
v_mfma_f32_16x16x32_bf16 a[68:71], a[104:107], a[116:119], a[68:71]
ds_read_b64_tr_b16 a[92:93], v13 offset:6144
v_mfma_f32_16x16x32_bf16 a[68:71], a[108:111], a[132:135], a[68:71]
v_mfma_f32_16x16x32_bf16 a[64:67], a[108:111], a[128:131], a[64:67]
ds_read_b64_tr_b16 a[94:95], v13 offset:7168
buffer_load_dwordx4 a[248:251], v8, s[4:7], s92 offen offset:64
v_mfma_f32_16x16x32_bf16 a[64:67], a[104:107], a[112:115], a[64:67]
s_waitcnt vmcnt(13) lgkmcnt(4)
v_mfma_f32_16x16x32_bf16 v[16:19], a[80:83], a[144:147], v[16:19]
ds_read_b64_tr_b16 a[96:97], v12 offset:8192
v_and_b32 v10, 15, v0
v_mfma_f32_16x16x32_bf16 v[16:19], a[84:87], a[160:163], v[16:19]
s_add_u32 m0, s91, 132096
v_lshrrev_b32 v9, 4, v0
v_lshrrev_b32 v11, 2, v10
v_mfma_f32_16x16x32_bf16 v[20:23], a[84:87], a[164:167], v[20:23]
ds_read_b64_tr_b16 a[98:99], v12 offset:9216
v_xor_b32 v11, v11, v9
v_mfma_f32_16x16x32_bf16 v[20:23], a[80:83], a[148:151], v[20:23]
v_lshlrev_b32 v11, 3, v11
v_lshl_add_u32 v11, v10, 5, v11
v_mfma_f32_16x16x32_bf16 v[24:27], a[80:83], a[152:155], v[24:27]
s_add_u32 s16, s91, 114688
ds_read_b64_tr_b16 a[100:101], v12 offset:10240
buffer_load_dwordx4 v7, s[32:35], s55 offen lds
v_mfma_f32_16x16x32_bf16 v[24:27], a[84:87], a[168:171], v[24:27]
v_add_u32 v11, s16, v11
v_lshlrev_b32 v10, 4, v0
v_mfma_f32_16x16x32_bf16 v[28:31], a[84:87], a[172:175], v[28:31]
ds_read_b64_tr_b16 a[102:103], v12 offset:11264
v_add_u32 v10, s90, v10
v_mfma_f32_16x16x32_bf16 v[28:31], a[80:83], a[156:159], v[28:31]
s_waitcnt lgkmcnt(4)
s_lshl_b32 s16, s18, 3
s_add_u32 s16, s16, s19
v_mfma_f32_16x16x32_bf16 v[44:47], a[88:91], a[156:159], v[44:47]
s_mul_i32 s16, s16, 196608
ds_read_b64_tr_b16 a[104:105], v13 offset:8192
s_add_u32 s16, s16, 29360128
v_mfma_f32_16x16x32_bf16 v[44:47], a[92:95], a[172:175], v[44:47]
s_add_u32 m0, s90, 81920
s_add_u32 s20, s14, s16
s_addc_u32 s21, s15, 0
s_mov_b32 s22, 196608
v_mfma_f32_16x16x32_bf16 v[40:43], a[92:95], a[168:171], v[40:43]
s_add_u32 s54, s86, 0
ds_read_b64_tr_b16 a[106:107], v13 offset:9216
v_mfma_f32_16x16x32_bf16 v[40:43], a[88:91], a[152:155], v[40:43]
v_mfma_f32_16x16x32_bf16 v[36:39], a[88:91], a[148:151], v[36:39]
ds_read_b64_tr_b16 a[108:109], v13 offset:10240
buffer_load_dwordx4 v2, s[72:75], s54 offen lds
v_mfma_f32_16x16x32_bf16 v[36:39], a[92:95], a[164:167], v[36:39]
v_mfma_f32_16x16x32_bf16 v[32:35], a[92:95], a[160:163], v[32:35]
ds_read_b64_tr_b16 a[110:111], v13 offset:11264
v_mfma_f32_16x16x32_bf16 v[32:35], a[88:91], a[144:147], v[32:35]
s_waitcnt lgkmcnt(4)
v_mfma_f32_16x16x32_bf16 v[48:51], a[96:99], a[144:147], v[48:51]
ds_read_b64_tr_b16 a[80:81], v12 offset:0
v_cvt_pk_bf16_f32 v16, v16, v17
v_mfma_f32_16x16x32_bf16 v[48:51], a[100:103], a[160:163], v[48:51]
s_add_u32 m0, s90, 82944
v_cvt_pk_bf16_f32 v17, v18, v19
v_mfma_f32_16x16x32_bf16 v[52:55], a[100:103], a[164:167], v[52:55]
ds_read_b64_tr_b16 a[82:83], v12 offset:1024
v_cvt_pk_bf16_f32 v18, v32, v33
v_mfma_f32_16x16x32_bf16 v[52:55], a[96:99], a[148:151], v[52:55]
v_cvt_pk_bf16_f32 v19, v34, v35
v_cvt_pk_bf16_f32 v20, v20, v21
v_mfma_f32_16x16x32_bf16 v[56:59], a[96:99], a[152:155], v[56:59]
ds_read_b64_tr_b16 a[84:85], v12 offset:2048
buffer_load_dwordx4 v3, s[72:75], s54 offen lds
v_mfma_f32_16x16x32_bf16 v[56:59], a[100:103], a[168:171], v[56:59]
v_cvt_pk_bf16_f32 v21, v22, v23
v_cvt_pk_bf16_f32 v22, v36, v37
v_mfma_f32_16x16x32_bf16 v[60:63], a[100:103], a[172:175], v[60:63]
ds_read_b64_tr_b16 a[86:87], v12 offset:3072
v_cvt_pk_bf16_f32 v23, v38, v39
v_mfma_f32_16x16x32_bf16 v[60:63], a[96:99], a[156:159], v[60:63]
s_waitcnt lgkmcnt(4)
v_cvt_pk_bf16_f32 v24, v24, v25
v_cvt_pk_bf16_f32 v25, v26, v27
v_mfma_f32_16x16x32_bf16 v[76:79], a[104:107], a[156:159], v[76:79]
ds_read_b64_tr_b16 a[88:89], v13 offset:0
v_cvt_pk_bf16_f32 v26, v40, v41
v_mfma_f32_16x16x32_bf16 v[76:79], a[108:111], a[172:175], v[76:79]
s_add_u32 m0, s90, 83968
v_cvt_pk_bf16_f32 v27, v42, v43
v_cvt_pk_bf16_f32 v28, v28, v29
v_mfma_f32_16x16x32_bf16 v[72:75], a[108:111], a[168:171], v[72:75]
ds_read_b64_tr_b16 a[90:91], v13 offset:1024
v_cvt_pk_bf16_f32 v29, v30, v31
v_mfma_f32_16x16x32_bf16 v[72:75], a[104:107], a[152:155], v[72:75]
v_cvt_pk_bf16_f32 v30, v44, v45
v_cvt_pk_bf16_f32 v31, v46, v47
v_mfma_f32_16x16x32_bf16 v[68:71], a[104:107], a[148:151], v[68:71]
ds_read_b64_tr_b16 a[92:93], v13 offset:2048
buffer_load_dwordx4 v4, s[72:75], s54 offen lds
v_mfma_f32_16x16x32_bf16 v[68:71], a[108:111], a[164:167], v[68:71]
v_mfma_f32_16x16x32_bf16 v[64:67], a[108:111], a[160:163], v[64:67]
ds_read_b64_tr_b16 a[94:95], v13 offset:3072
v_mfma_f32_16x16x32_bf16 v[64:67], a[104:107], a[144:147], v[64:67]
s_waitcnt lgkmcnt(4)
v_mfma_f32_16x16x32_bf16 a[0:3], a[80:83], a[144:147], a[0:3]
ds_read_b64_tr_b16 a[96:97], v14 offset:0
v_cvt_pk_bf16_f32 v48, v48, v49
v_mfma_f32_16x16x32_bf16 a[0:3], a[84:87], a[160:163], a[0:3]
s_add_u32 m0, s90, 84992
v_cvt_pk_bf16_f32 v49, v50, v51
v_mfma_f32_16x16x32_bf16 a[4:7], a[84:87], a[164:167], a[4:7]
ds_read_b64_tr_b16 a[98:99], v14 offset:3584
v_cvt_pk_bf16_f32 v50, v64, v65
v_mfma_f32_16x16x32_bf16 a[4:7], a[80:83], a[148:151], a[4:7]
v_cvt_pk_bf16_f32 v51, v66, v67
v_mfma_f32_16x16x32_bf16 a[8:11], a[80:83], a[152:155], a[8:11]
ds_read_b64_tr_b16 a[100:101], v14 offset:7168
buffer_load_dwordx4 v5, s[72:75], s54 offen lds
v_mfma_f32_16x16x32_bf16 a[8:11], a[84:87], a[168:171], a[8:11]
ds_write_b64 v11, v[48:49] offset:0
ds_write_b64 v11, v[50:51] offset:8192
v_mfma_f32_16x16x32_bf16 a[12:15], a[84:87], a[172:175], a[12:15]
ds_read_b64_tr_b16 a[102:103], v14 offset:10752
v_cvt_pk_bf16_f32 v52, v52, v53
v_mfma_f32_16x16x32_bf16 a[12:15], a[80:83], a[156:159], a[12:15]
s_waitcnt lgkmcnt(6)
v_cvt_pk_bf16_f32 v53, v54, v55
v_cvt_pk_bf16_f32 v54, v68, v69
L_pad2:
s_cbranch_execz L_pad6
v_mfma_f32_16x16x32_bf16 a[28:31], a[88:91], a[156:159], a[28:31]
ds_read_b64_tr_b16 a[104:105], v14 offset:14336
v_cvt_pk_bf16_f32 v55, v70, v71
v_mfma_f32_16x16x32_bf16 a[28:31], a[92:95], a[172:175], a[28:31]
s_add_u32 m0, s90, 98304
ds_write_b64 v11, v[52:53] offset:512
ds_write_b64 v11, v[54:55] offset:8704
v_mfma_f32_16x16x32_bf16 a[24:27], a[92:95], a[168:171], a[24:27]
s_add_u32 s54, s87, 0
ds_read_b64_tr_b16 a[106:107], v14 offset:17920
v_cvt_pk_bf16_f32 v56, v56, v57
v_mfma_f32_16x16x32_bf16 a[24:27], a[88:91], a[152:155], a[24:27]
v_cvt_pk_bf16_f32 v57, v58, v59
v_cvt_pk_bf16_f32 v58, v72, v73
v_mfma_f32_16x16x32_bf16 a[20:23], a[88:91], a[148:151], a[20:23]
ds_read_b64_tr_b16 a[108:109], v14 offset:21504
buffer_load_dwordx4 v2, s[72:75], s54 offen lds
v_mfma_f32_16x16x32_bf16 a[20:23], a[92:95], a[164:167], a[20:23]
v_cvt_pk_bf16_f32 v59, v74, v75
v_mfma_f32_16x16x32_bf16 a[16:19], a[92:95], a[160:163], a[16:19]
ds_read_b64_tr_b16 a[110:111], v14 offset:25088
ds_write_b64 v11, v[56:57] offset:1024
v_mfma_f32_16x16x32_bf16 a[16:19], a[88:91], a[144:147], a[16:19]
s_waitcnt lgkmcnt(7)
ds_write_b64 v11, v[58:59] offset:9216
v_cvt_pk_bf16_f32 v60, v60, v61
v_mfma_f32_16x16x32_bf16 v[80:83], a[96:99], a[144:147], v[80:83]
ds_read_b64_tr_b16 a[80:81], v14 offset:32
v_cvt_pk_bf16_f32 v61, v62, v63
v_mfma_f32_16x16x32_bf16 v[80:83], a[100:103], a[160:163], v[80:83]
s_add_u32 m0, s90, 99328
v_cvt_pk_bf16_f32 v62, v76, v77
v_cvt_pk_bf16_f32 v63, v78, v79
v_mfma_f32_16x16x32_bf16 v[84:87], a[100:103], a[164:167], v[84:87]
ds_read_b64_tr_b16 a[82:83], v14 offset:3616
ds_write_b64 v11, v[60:61] offset:1536
v_mfma_f32_16x16x32_bf16 v[84:87], a[96:99], a[148:151], v[84:87]
ds_write_b64 v11, v[62:63] offset:9728
v_mfma_f32_16x16x32_bf16 v[32:35], a[176:179], v[16:19], 0
v_mfma_f32_16x16x32_bf16 v[64:67], a[180:183], v[16:19], 0
v_mfma_f32_16x16x32_bf16 v[36:39], a[176:179], v[20:23], 0
v_mfma_f32_16x16x32_bf16 v[68:71], a[180:183], v[20:23], 0
v_mfma_f32_16x16x32_bf16 v[40:43], a[176:179], v[24:27], 0
v_mfma_f32_16x16x32_bf16 v[72:75], a[180:183], v[24:27], 0
v_mfma_f32_16x16x32_bf16 v[44:47], a[176:179], v[28:31], 0
v_mfma_f32_16x16x32_bf16 v[76:79], a[180:183], v[28:31], 0
s_waitcnt lgkmcnt(0)
v_cvt_pk_bf16_f32 v33, v32, v33
v_lshlrev_b32 v32, 16, v33
v_mfma_f32_16x16x32_bf16 v[88:91], a[96:99], a[152:155], v[88:91]
ds_read_b64_tr_b16 a[84:85], v14 offset:7200
buffer_load_dwordx4 v3, s[72:75], s54 offen lds
v_mfma_f32_16x16x32_bf16 v[88:91], a[100:103], a[168:171], v[88:91]
v_and_b32 v33, 0xffff0000, v33
v_cvt_pk_bf16_f32 v35, v34, v35
v_mfma_f32_16x16x32_bf16 v[92:95], a[100:103], a[172:175], v[92:95]
ds_read_b64_tr_b16 a[86:87], v14 offset:10784
v_lshlrev_b32 v34, 16, v35
v_mfma_f32_16x16x32_bf16 v[92:95], a[96:99], a[156:159], v[92:95]
v_and_b32 v35, 0xffff0000, v35
v_cvt_pk_bf16_f32 v65, v64, v65
v_mfma_f32_16x16x32_bf16 v[204:207], a[104:107], a[156:159], v[204:207]
ds_read_b64_tr_b16 a[88:89], v14 offset:14368
v_lshlrev_b32 v64, 16, v65
v_mfma_f32_16x16x32_bf16 v[204:207], a[108:111], a[172:175], v[204:207]
s_add_u32 m0, s90, 100352
v_and_b32 v65, 0xffff0000, v65
v_cvt_pk_bf16_f32 v67, v66, v67
v_mfma_f32_16x16x32_bf16 v[200:203], a[108:111], a[168:171], v[200:203]
ds_read_b64_tr_b16 a[90:91], v14 offset:17952
v_lshlrev_b32 v66, 16, v67
v_mfma_f32_16x16x32_bf16 v[200:203], a[104:107], a[152:155], v[200:203]
v_and_b32 v67, 0xffff0000, v67
v_max3_f32 v28, v32, v33, v34
v_mfma_f32_16x16x32_bf16 v[196:199], a[104:107], a[148:151], v[196:199]
ds_read_b64_tr_b16 a[92:93], v14 offset:21536
buffer_load_dwordx4 v4, s[72:75], s54 offen lds
v_mfma_f32_16x16x32_bf16 v[196:199], a[108:111], a[164:167], v[196:199]
v_max3_f32 v28, v28, v35, v64
v_max3_f32 v28, v28, v65, v66
v_mfma_f32_16x16x32_bf16 v[192:195], a[108:111], a[160:163], v[192:195]
ds_read_b64_tr_b16 a[94:95], v14 offset:25120
v_max_f32 v28, v28, v67
v_mfma_f32_16x16x32_bf16 v[192:195], a[104:107], a[144:147], v[192:195]
s_waitcnt lgkmcnt(4)
v_min3_f32 v60, v32, v33, v34
v_min3_f32 v60, v60, v35, v64
v_mfma_f32_16x16x32_bf16 v[96:99], a[80:83], a[144:147], v[96:99]
ds_read_b64_tr_b16 a[96:97], v14 offset:64
v_min3_f32 v60, v60, v65, v66
v_mfma_f32_16x16x32_bf16 v[96:99], a[84:87], a[160:163], v[96:99]
s_add_u32 m0, s90, 101376
v_min_f32 v60, v60, v67
v_cvt_pk_bf16_f32 v37, v36, v37
v_mfma_f32_16x16x32_bf16 v[100:103], a[84:87], a[164:167], v[100:103]
ds_read_b64_tr_b16 a[98:99], v14 offset:3648
v_lshlrev_b32 v36, 16, v37
v_mfma_f32_16x16x32_bf16 v[100:103], a[80:83], a[148:151], v[100:103]
v_and_b32 v37, 0xffff0000, v37
v_cvt_pk_bf16_f32 v39, v38, v39
v_mfma_f32_16x16x32_bf16 v[104:107], a[80:83], a[152:155], v[104:107]
ds_read_b64_tr_b16 a[100:101], v14 offset:7232
buffer_load_dwordx4 v5, s[72:75], s54 offen lds
v_mfma_f32_16x16x32_bf16 v[104:107], a[84:87], a[168:171], v[104:107]
v_lshlrev_b32 v38, 16, v39
v_and_b32 v39, 0xffff0000, v39
v_mfma_f32_16x16x32_bf16 v[108:111], a[84:87], a[172:175], v[108:111]
ds_read_b64_tr_b16 a[102:103], v14 offset:10816
v_cvt_pk_bf16_f32 v69, v68, v69
v_mfma_f32_16x16x32_bf16 v[108:111], a[80:83], a[156:159], v[108:111]
s_waitcnt lgkmcnt(4)
v_lshlrev_b32 v68, 16, v69
v_and_b32 v69, 0xffff0000, v69
v_mfma_f32_16x16x32_bf16 v[220:223], a[88:91], a[156:159], v[220:223]
ds_read_b64_tr_b16 a[104:105], v14 offset:14400
v_cvt_pk_bf16_f32 v71, v70, v71
v_mfma_f32_16x16x32_bf16 v[220:223], a[92:95], a[172:175], v[220:223]
s_add_u32 m0, s91, 139264
v_lshlrev_b32 v70, 16, v71
v_and_b32 v71, 0xffff0000, v71
v_mfma_f32_16x16x32_bf16 v[216:219], a[92:95], a[168:171], v[216:219]
s_add_u32 s55, s93, 131072
ds_read_b64_tr_b16 a[106:107], v14 offset:17984
v_max3_f32 v29, v36, v37, v38
v_mfma_f32_16x16x32_bf16 v[216:219], a[88:91], a[152:155], v[216:219]
s_and_b32 s55, s55, 0x1fffff
v_max3_f32 v29, v29, v39, v68
v_max3_f32 v29, v29, v69, v70
v_mfma_f32_16x16x32_bf16 v[212:215], a[88:91], a[148:151], v[212:215]
ds_read_b64_tr_b16 a[108:109], v14 offset:21568
buffer_load_dwordx4 v6, s[32:35], s55 offen lds
v_mfma_f32_16x16x32_bf16 v[212:215], a[92:95], a[164:167], v[212:215]
v_max_f32 v29, v29, v71
v_min3_f32 v61, v36, v37, v38
v_mfma_f32_16x16x32_bf16 v[208:211], a[92:95], a[160:163], v[208:211]
ds_read_b64_tr_b16 a[110:111], v14 offset:25152
v_min3_f32 v61, v61, v39, v68
v_mfma_f32_16x16x32_bf16 v[208:211], a[88:91], a[144:147], v[208:211]
s_waitcnt lgkmcnt(4)
v_min3_f32 v61, v61, v69, v70
v_min_f32 v61, v61, v71
v_mfma_f32_16x16x32_bf16 v[112:115], a[96:99], a[144:147], v[112:115]
ds_read_b64_tr_b16 a[80:81], v14 offset:96
v_cvt_pk_bf16_f32 v41, v40, v41
v_mfma_f32_16x16x32_bf16 v[112:115], a[100:103], a[160:163], v[112:115]
s_add_u32 m0, s91, 140288
v_lshlrev_b32 v40, 16, v41
v_and_b32 v41, 0xffff0000, v41
v_mfma_f32_16x16x32_bf16 v[116:119], a[100:103], a[164:167], v[116:119]
ds_read_b64_tr_b16 a[82:83], v14 offset:3680
v_cvt_pk_bf16_f32 v43, v42, v43
v_mfma_f32_16x16x32_bf16 v[116:119], a[96:99], a[148:151], v[116:119]
v_lshlrev_b32 v42, 16, v43
v_and_b32 v43, 0xffff0000, v43
v_mfma_f32_16x16x32_bf16 v[120:123], a[96:99], a[152:155], v[120:123]
ds_read_b64_tr_b16 a[84:85], v14 offset:7264
buffer_load_dwordx4 v7, s[32:35], s55 offen lds
v_mfma_f32_16x16x32_bf16 v[120:123], a[100:103], a[168:171], v[120:123]
v_cvt_pk_bf16_f32 v73, v72, v73
v_lshlrev_b32 v72, 16, v73
v_mfma_f32_16x16x32_bf16 v[124:127], a[100:103], a[172:175], v[124:127]
ds_read_b64_tr_b16 a[86:87], v14 offset:10848
v_and_b32 v73, 0xffff0000, v73
v_mfma_f32_16x16x32_bf16 v[124:127], a[96:99], a[156:159], v[124:127]
s_waitcnt lgkmcnt(4)
v_cvt_pk_bf16_f32 v75, v74, v75
v_lshlrev_b32 v74, 16, v75
v_mfma_f32_16x16x32_bf16 v[236:239], a[104:107], a[156:159], v[236:239]
ds_read_b64_tr_b16 a[88:89], v14 offset:14432
v_and_b32 v75, 0xffff0000, v75
v_mfma_f32_16x16x32_bf16 v[236:239], a[108:111], a[172:175], v[236:239]
s_add_u32 m0, s91, 147456
v_max3_f32 v30, v40, v41, v42
v_max3_f32 v30, v30, v43, v72
v_mfma_f32_16x16x32_bf16 v[232:235], a[108:111], a[168:171], v[232:235]
s_add_u32 s55, s93, 262144
ds_read_b64_tr_b16 a[90:91], v14 offset:18016
v_max3_f32 v30, v30, v73, v74
v_mfma_f32_16x16x32_bf16 v[232:235], a[104:107], a[152:155], v[232:235]
s_and_b32 s55, s55, 0x1fffff
v_max_f32 v30, v30, v75
v_min3_f32 v62, v40, v41, v42
v_mfma_f32_16x16x32_bf16 v[228:231], a[104:107], a[148:151], v[228:231]
ds_read_b64_tr_b16 a[92:93], v14 offset:21600
buffer_load_dwordx4 v6, s[32:35], s55 offen lds
v_mfma_f32_16x16x32_bf16 v[228:231], a[108:111], a[164:167], v[228:231]
v_min3_f32 v62, v62, v43, v72
v_min3_f32 v62, v62, v73, v74
v_mfma_f32_16x16x32_bf16 v[224:227], a[108:111], a[160:163], v[224:227]
ds_read_b64_tr_b16 a[94:95], v14 offset:25184
v_min_f32 v62, v62, v75
v_mfma_f32_16x16x32_bf16 v[224:227], a[104:107], a[144:147], v[224:227]
s_waitcnt lgkmcnt(4)
v_cvt_pk_bf16_f32 v45, v44, v45
v_lshlrev_b32 v44, 16, v45
v_mfma_f32_16x16x32_bf16 v[128:131], a[80:83], a[144:147], v[128:131]
ds_read_b64_tr_b16 a[96:97], v14 offset:128
ds_read_b64_tr_b16 a[98:99], v14 offset:3712
v_mfma_f32_16x16x32_bf16 v[128:131], a[84:87], a[160:163], v[128:131]
s_add_u32 m0, s91, 148480
v_and_b32 v45, 0xffff0000, v45
v_cvt_pk_bf16_f32 v47, v46, v47
v_mfma_f32_16x16x32_bf16 v[132:135], a[84:87], a[164:167], v[132:135]
ds_read_b64_tr_b16 a[100:101], v14 offset:7296
v_lshlrev_b32 v46, 16, v47
v_mfma_f32_16x16x32_bf16 v[132:135], a[80:83], a[148:151], v[132:135]
v_and_b32 v47, 0xffff0000, v47
v_cvt_pk_bf16_f32 v77, v76, v77
v_mfma_f32_16x16x32_bf16 v[136:139], a[80:83], a[152:155], v[136:139]
ds_read_b64_tr_b16 a[102:103], v14 offset:10880
buffer_load_dwordx4 v7, s[32:35], s55 offen lds
v_mfma_f32_16x16x32_bf16 v[136:139], a[84:87], a[168:171], v[136:139]
v_lshlrev_b32 v76, 16, v77
v_and_b32 v77, 0xffff0000, v77
v_mfma_f32_16x16x32_bf16 v[140:143], a[84:87], a[172:175], v[140:143]
v_cvt_pk_bf16_f32 v79, v78, v79
v_lshlrev_b32 v78, 16, v79
v_mfma_f32_16x16x32_bf16 v[140:143], a[80:83], a[156:159], v[140:143]
s_waitcnt lgkmcnt(4)
v_and_b32 v79, 0xffff0000, v79
v_max3_f32 v31, v44, v45, v46
v_mfma_f32_16x16x32_bf16 v[252:255], a[88:91], a[156:159], v[252:255]
ds_read_b64_tr_b16 a[104:105], v14 offset:14464
ds_read_b64_tr_b16 a[106:107], v14 offset:18048
v_mfma_f32_16x16x32_bf16 v[252:255], a[92:95], a[172:175], v[252:255]
s_add_u32 m0, s91, 155648
v_max3_f32 v31, v31, v47, v76
v_max3_f32 v31, v31, v77, v78
v_mfma_f32_16x16x32_bf16 v[248:251], a[92:95], a[168:171], v[248:251]
s_add_u32 s55, s93, 393216
ds_read_b64_tr_b16 a[108:109], v14 offset:21632
v_max_f32 v31, v31, v79
v_mfma_f32_16x16x32_bf16 v[248:251], a[88:91], a[152:155], v[248:251]
s_and_b32 s55, s55, 0x1fffff
v_min3_f32 v63, v44, v45, v46
v_min3_f32 v63, v63, v47, v76
v_mfma_f32_16x16x32_bf16 v[244:247], a[88:91], a[148:151], v[244:247]
ds_read_b64_tr_b16 a[110:111], v14 offset:25216
buffer_load_dwordx4 v6, s[32:35], s55 offen lds
v_mfma_f32_16x16x32_bf16 v[244:247], a[92:95], a[164:167], v[244:247]
v_min3_f32 v63, v63, v77, v78
v_min_f32 v63, v63, v79
v_mfma_f32_16x16x32_bf16 v[240:243], a[92:95], a[160:163], v[240:243]
v_permlane16_swap_b32 v28, v29
v_mfma_f32_16x16x32_bf16 v[240:243], a[88:91], a[144:147], v[240:243]
s_waitcnt lgkmcnt(4)
v_permlane16_swap_b32 v60, v61
v_mfma_f32_16x16x32_bf16 v[144:147], a[96:99], a[144:147], v[144:147]
ds_read_b64_tr_b16 a[80:81], v14 offset:160
ds_read_b64_tr_b16 a[82:83], v14 offset:3744
v_mfma_f32_16x16x32_bf16 v[144:147], a[100:103], a[160:163], v[144:147]
s_add_u32 m0, s91, 156672
v_permlane16_swap_b32 v30, v31
v_mfma_f32_16x16x32_bf16 v[148:151], a[100:103], a[164:167], v[148:151]
ds_read_b64_tr_b16 a[84:85], v14 offset:7328
v_mfma_f32_16x16x32_bf16 v[148:151], a[96:99], a[148:151], v[148:151]
v_permlane16_swap_b32 v62, v63
v_mfma_f32_16x16x32_bf16 v[152:155], a[96:99], a[152:155], v[152:155]
ds_read_b64_tr_b16 a[86:87], v14 offset:10912
buffer_load_dwordx4 v7, s[32:35], s55 offen lds
v_mfma_f32_16x16x32_bf16 v[152:155], a[100:103], a[168:171], v[152:155]
v_max_f32 v28, v28, v29
v_min_f32 v60, v60, v61
v_mfma_f32_16x16x32_bf16 v[156:159], a[100:103], a[172:175], v[156:159]
v_max_f32 v30, v30, v31
v_min_f32 v62, v62, v63
v_mfma_f32_16x16x32_bf16 v[156:159], a[96:99], a[156:159], v[156:159]
s_waitcnt lgkmcnt(4)
v_permlane32_swap_b32 v28, v30
v_mfma_f32_16x16x32_bf16 a[44:47], a[104:107], a[156:159], a[44:47]
ds_read_b64_tr_b16 a[88:89], v14 offset:14496
ds_read_b64_tr_b16 a[90:91], v14 offset:18080
v_mfma_f32_16x16x32_bf16 a[44:47], a[108:111], a[172:175], a[44:47]
s_add_u32 m0, s91, 40960
v_permlane32_swap_b32 v60, v62
v_mfma_f32_16x16x32_bf16 a[40:43], a[108:111], a[168:171], a[40:43]
s_add_u32 s55, s93, 524288
ds_read_b64_tr_b16 a[92:93], v14 offset:21664
v_max_f32 v28, v28, v30
v_mfma_f32_16x16x32_bf16 a[40:43], a[104:107], a[152:155], a[40:43]
s_and_b32 s55, s55, 0x1fffff
v_min_f32 v60, v60, v62
v_mul_f32 v28, s26, v28
v_mfma_f32_16x16x32_bf16 a[36:39], a[104:107], a[148:151], a[36:39]
ds_read_b64_tr_b16 a[94:95], v14 offset:25248
buffer_load_dwordx4 v6, s[32:35], s55 offen lds
v_mfma_f32_16x16x32_bf16 a[36:39], a[108:111], a[164:167], a[36:39]
v_mul_f32 v60, s28, v60
v_mov_b32 v30, v28
v_mfma_f32_16x16x32_bf16 a[32:35], a[108:111], a[160:163], a[32:35]
v_mov_b32 v62, v60
v_mfma_f32_16x16x32_bf16 a[32:35], a[104:107], a[144:147], a[32:35]
s_waitcnt lgkmcnt(4)
v_permlane32_swap_b32 v28, v30
v_mfma_f32_16x16x32_bf16 v[160:163], a[80:83], a[144:147], v[160:163]
ds_read_b64_tr_b16 a[96:97], v14 offset:192
ds_read_b64_tr_b16 a[98:99], v14 offset:3776
v_mfma_f32_16x16x32_bf16 v[160:163], a[84:87], a[160:163], v[160:163]
s_add_u32 m0, s91, 41984
v_permlane32_swap_b32 v60, v62
v_mfma_f32_16x16x32_bf16 v[164:167], a[84:87], a[164:167], v[164:167]
ds_read_b64_tr_b16 a[100:101], v14 offset:7360
v_mov_b32 v29, v28
v_mfma_f32_16x16x32_bf16 v[164:167], a[80:83], a[148:151], v[164:167]
v_mov_b32 v61, v60
v_mov_b32 v31, v30
v_mfma_f32_16x16x32_bf16 v[168:171], a[80:83], a[152:155], v[168:171]
ds_read_b64_tr_b16 a[102:103], v14 offset:10944
buffer_load_dwordx4 v7, s[32:35], s55 offen lds
v_mfma_f32_16x16x32_bf16 v[168:171], a[84:87], a[168:171], v[168:171]
v_mov_b32 v63, v62
v_mfma_f32_16x16x32_bf16 v[172:175], a[84:87], a[172:175], v[172:175]
v_permlane16_swap_b32 v28, v29
v_mfma_f32_16x16x32_bf16 v[172:175], a[80:83], a[156:159], v[172:175]
s_waitcnt lgkmcnt(4)
v_permlane16_swap_b32 v60, v61
v_mfma_f32_16x16x32_bf16 a[60:63], a[88:91], a[156:159], a[60:63]
ds_read_b64_tr_b16 a[104:105], v14 offset:14528
ds_read_b64_tr_b16 a[106:107], v14 offset:18112
v_mfma_f32_16x16x32_bf16 a[60:63], a[92:95], a[172:175], a[60:63]
v_permlane16_swap_b32 v30, v31
v_mfma_f32_16x16x32_bf16 a[56:59], a[92:95], a[168:171], a[56:59]
ds_read_b64_tr_b16 a[108:109], v14 offset:21696
v_mfma_f32_16x16x32_bf16 a[56:59], a[88:91], a[152:155], a[56:59]
v_permlane16_swap_b32 v62, v63
v_mfma_f32_16x16x32_bf16 a[52:55], a[88:91], a[148:151], a[52:55]
ds_read_b64_tr_b16 a[110:111], v14 offset:25280
v_fma_f32 v16, v32, s26, v60
v_mfma_f32_16x16x32_bf16 a[52:55], a[92:95], a[164:167], a[52:55]
v_fma_f32 v17, v33, s26, v60
v_fma_f32 v18, v34, s26, v60
v_mfma_f32_16x16x32_bf16 a[48:51], a[92:95], a[160:163], a[48:51]
buffer_load_dwordx4 a[244:247], v8, s[4:7], s65 offen offset:0
v_fma_f32 v19, v35, s26, v60
v_mfma_f32_16x16x32_bf16 a[48:51], a[88:91], a[144:147], a[48:51]
s_waitcnt lgkmcnt(4)
v_fma_f32 v48, v64, s26, v60
v_fma_f32 v49, v65, s26, v60
v_mfma_f32_16x16x32_bf16 v[176:179], a[96:99], a[144:147], v[176:179]
v_fma_f32 v50, v66, s26, v60
v_fma_f32 v51, v67, s26, v60
v_mfma_f32_16x16x32_bf16 v[176:179], a[100:103], a[160:163], v[176:179]
v_exp_f32 v16, v16
v_mfma_f32_16x16x32_bf16 v[180:183], a[100:103], a[164:167], v[180:183]
buffer_load_dwordx4 a[240:243], v8, s[4:7], s65 offen offset:64
v_mfma_f32_16x16x32_bf16 v[180:183], a[96:99], a[148:151], v[180:183]
s_waitcnt lgkmcnt(0)
s_barrier
v_mfma_f32_16x16x32_bf16 v[184:187], a[96:99], a[152:155], v[184:187]
v_exp_f32 v17, v17
v_mfma_f32_16x16x32_bf16 v[184:187], a[100:103], a[168:171], v[184:187]
v_exp_f32 v18, v18
v_mfma_f32_16x16x32_bf16 v[188:191], a[100:103], a[172:175], v[188:191]
v_exp_f32 v19, v19
v_mfma_f32_16x16x32_bf16 v[188:191], a[96:99], a[156:159], v[188:191]
v_exp_f32 v48, v48
v_mfma_f32_16x16x32_bf16 a[76:79], a[104:107], a[156:159], a[76:79]
v_exp_f32 v49, v49
v_mfma_f32_16x16x32_bf16 a[76:79], a[108:111], a[172:175], a[76:79]
s_add_u32 m0, s91, 32768
v_exp_f32 v50, v50
v_mfma_f32_16x16x32_bf16 a[72:75], a[108:111], a[168:171], a[72:75]
s_add_u32 s55, s93, 655360
v_exp_f32 v51, v51
v_mfma_f32_16x16x32_bf16 a[72:75], a[104:107], a[152:155], a[72:75]
s_and_b32 s55, s55, 0x1fffff
v_add_f32 v60, v16, v17
v_add_f32 v60, v60, v18
v_mfma_f32_16x16x32_bf16 a[68:71], a[104:107], a[148:151], a[68:71]
buffer_load_dwordx4 v6, s[32:35], s55 offen lds
v_add_f32 v60, v60, v19
v_mfma_f32_16x16x32_bf16 a[68:71], a[108:111], a[164:167], a[68:71]
s_add_u32 m0, s91, 33792
v_add_f32 v60, v60, v48
v_add_f32 v60, v60, v49
v_mfma_f32_16x16x32_bf16 a[64:67], a[108:111], a[160:163], a[64:67]
buffer_load_dwordx4 v7, s[32:35], s55 offen lds
v_add_f32 v60, v60, v50
v_mfma_f32_16x16x32_bf16 a[64:67], a[104:107], a[144:147], a[64:67]
v_add_f32 v60, v60, v51
s_add_u32 s59, s95, 0
v_pk_mul_f32 v[12:13], v[80:81], v[80:81]
v_pk_mul_f32 v[14:15], v[82:83], v[82:83]
v_pk_fma_f32 v[12:13], v[12:13], s[24:25], s[24:25] op_sel:[0,0,1] op_sel_hi:[1,0,1]
v_pk_fma_f32 v[14:15], v[14:15], s[24:25], s[24:25] op_sel:[0,0,1] op_sel_hi:[1,0,1]
v_pk_mul_f32 v[12:13], v[12:13], v[80:81]
v_pk_mul_f32 v[14:15], v[14:15], v[82:83]
v_exp_f32 v12, v12
v_exp_f32 v13, v13
v_exp_f32 v14, v14
v_exp_f32 v15, v15
v_pk_add_f32 v[12:13], v[12:13], 1.0 op_sel_hi:[1,0]
v_pk_add_f32 v[14:15], v[14:15], 1.0 op_sel_hi:[1,0]
v_rcp_f32 v12, v12
v_rcp_f32 v13, v13
v_rcp_f32 v14, v14
v_rcp_f32 v15, v15
v_pk_mul_f32 v[80:81], v[80:81], v[192:193]
v_pk_mul_f32 v[82:83], v[82:83], v[194:195]
v_pk_mul_f32 v[80:81], v[80:81], v[12:13]
v_pk_mul_f32 v[82:83], v[82:83], v[14:15]
v_cvt_pk_bf16_f32 v80, v80, v81
v_cvt_pk_bf16_f32 v81, v82, v83
v_pk_mul_f32 v[12:13], v[96:97], v[96:97]
v_pk_mul_f32 v[14:15], v[98:99], v[98:99]
v_pk_fma_f32 v[12:13], v[12:13], s[24:25], s[24:25] op_sel:[0,0,1] op_sel_hi:[1,0,1]
v_pk_fma_f32 v[14:15], v[14:15], s[24:25], s[24:25] op_sel:[0,0,1] op_sel_hi:[1,0,1]
v_pk_mul_f32 v[12:13], v[12:13], v[96:97]
v_pk_mul_f32 v[14:15], v[14:15], v[98:99]
v_exp_f32 v12, v12
v_exp_f32 v13, v13
v_exp_f32 v14, v14
v_exp_f32 v15, v15
v_pk_add_f32 v[12:13], v[12:13], 1.0 op_sel_hi:[1,0]
v_pk_add_f32 v[14:15], v[14:15], 1.0 op_sel_hi:[1,0]
v_rcp_f32 v12, v12
v_rcp_f32 v13, v13
v_rcp_f32 v14, v14
v_rcp_f32 v15, v15
v_pk_mul_f32 v[96:97], v[96:97], v[208:209]
v_pk_mul_f32 v[98:99], v[98:99], v[210:211]
v_pk_mul_f32 v[96:97], v[96:97], v[12:13]
v_pk_mul_f32 v[98:99], v[98:99], v[14:15]
v_cvt_pk_bf16_f32 v82, v96, v97
v_cvt_pk_bf16_f32 v83, v98, v99
buffer_store_dwordx4 v[80:83], v10, s[36:39], s59 offen offset:0 sc1
v_pk_mul_f32 v[12:13], v[84:85], v[84:85]
v_pk_mul_f32 v[14:15], v[86:87], v[86:87]
v_pk_fma_f32 v[12:13], v[12:13], s[24:25], s[24:25] op_sel:[0,0,1] op_sel_hi:[1,0,1]
v_pk_fma_f32 v[14:15], v[14:15], s[24:25], s[24:25] op_sel:[0,0,1] op_sel_hi:[1,0,1]
v_pk_mul_f32 v[12:13], v[12:13], v[84:85]
v_pk_mul_f32 v[14:15], v[14:15], v[86:87]
v_exp_f32 v12, v12
v_exp_f32 v13, v13
v_exp_f32 v14, v14
v_exp_f32 v15, v15
v_pk_add_f32 v[12:13], v[12:13], 1.0 op_sel_hi:[1,0]
v_pk_add_f32 v[14:15], v[14:15], 1.0 op_sel_hi:[1,0]
v_rcp_f32 v12, v12
v_rcp_f32 v13, v13
v_rcp_f32 v14, v14
v_rcp_f32 v15, v15
v_pk_mul_f32 v[84:85], v[84:85], v[196:197]
v_pk_mul_f32 v[86:87], v[86:87], v[198:199]
v_pk_mul_f32 v[84:85], v[84:85], v[12:13]
v_pk_mul_f32 v[86:87], v[86:87], v[14:15]
v_cvt_pk_bf16_f32 v84, v84, v85
v_cvt_pk_bf16_f32 v85, v86, v87
v_pk_mul_f32 v[12:13], v[100:101], v[100:101]
v_pk_mul_f32 v[14:15], v[102:103], v[102:103]
v_pk_fma_f32 v[12:13], v[12:13], s[24:25], s[24:25] op_sel:[0,0,1] op_sel_hi:[1,0,1]
v_pk_fma_f32 v[14:15], v[14:15], s[24:25], s[24:25] op_sel:[0,0,1] op_sel_hi:[1,0,1]
v_pk_mul_f32 v[12:13], v[12:13], v[100:101]
v_pk_mul_f32 v[14:15], v[14:15], v[102:103]
v_exp_f32 v12, v12
v_exp_f32 v13, v13
v_exp_f32 v14, v14
v_exp_f32 v15, v15
v_pk_add_f32 v[12:13], v[12:13], 1.0 op_sel_hi:[1,0]
v_pk_add_f32 v[14:15], v[14:15], 1.0 op_sel_hi:[1,0]
v_rcp_f32 v12, v12
v_rcp_f32 v13, v13
v_rcp_f32 v14, v14
v_rcp_f32 v15, v15
v_pk_mul_f32 v[100:101], v[100:101], v[212:213]
v_pk_mul_f32 v[102:103], v[102:103], v[214:215]
v_pk_mul_f32 v[100:101], v[100:101], v[12:13]
v_pk_mul_f32 v[102:103], v[102:103], v[14:15]
v_cvt_pk_bf16_f32 v86, v100, v101
v_cvt_pk_bf16_f32 v87, v102, v103
buffer_store_dwordx4 v[84:87], v10, s[36:39], s59 offen offset:1024 sc1
s_xor_b32 s59, s59, 2048
v_pk_mul_f32 v[12:13], v[88:89], v[88:89]
v_pk_mul_f32 v[14:15], v[90:91], v[90:91]
v_pk_fma_f32 v[12:13], v[12:13], s[24:25], s[24:25] op_sel:[0,0,1] op_sel_hi:[1,0,1]
v_pk_fma_f32 v[14:15], v[14:15], s[24:25], s[24:25] op_sel:[0,0,1] op_sel_hi:[1,0,1]
v_pk_mul_f32 v[12:13], v[12:13], v[88:89]
v_pk_mul_f32 v[14:15], v[14:15], v[90:91]
v_exp_f32 v12, v12
v_exp_f32 v13, v13
v_exp_f32 v14, v14
v_exp_f32 v15, v15
v_pk_add_f32 v[12:13], v[12:13], 1.0 op_sel_hi:[1,0]
v_pk_add_f32 v[14:15], v[14:15], 1.0 op_sel_hi:[1,0]
v_rcp_f32 v12, v12
v_rcp_f32 v13, v13
v_rcp_f32 v14, v14
v_rcp_f32 v15, v15
v_pk_mul_f32 v[88:89], v[88:89], v[200:201]
v_pk_mul_f32 v[90:91], v[90:91], v[202:203]
v_pk_mul_f32 v[88:89], v[88:89], v[12:13]
v_pk_mul_f32 v[90:91], v[90:91], v[14:15]
v_cvt_pk_bf16_f32 v88, v88, v89
v_cvt_pk_bf16_f32 v89, v90, v91
v_pk_mul_f32 v[12:13], v[104:105], v[104:105]
v_pk_mul_f32 v[14:15], v[106:107], v[106:107]
v_pk_fma_f32 v[12:13], v[12:13], s[24:25], s[24:25] op_sel:[0,0,1] op_sel_hi:[1,0,1]
v_pk_fma_f32 v[14:15], v[14:15], s[24:25], s[24:25] op_sel:[0,0,1] op_sel_hi:[1,0,1]
v_pk_mul_f32 v[12:13], v[12:13], v[104:105]
v_pk_mul_f32 v[14:15], v[14:15], v[106:107]
v_exp_f32 v12, v12
v_exp_f32 v13, v13
v_exp_f32 v14, v14
v_exp_f32 v15, v15
v_pk_add_f32 v[12:13], v[12:13], 1.0 op_sel_hi:[1,0]
v_pk_add_f32 v[14:15], v[14:15], 1.0 op_sel_hi:[1,0]
v_rcp_f32 v12, v12
v_rcp_f32 v13, v13
v_rcp_f32 v14, v14
v_rcp_f32 v15, v15
v_pk_mul_f32 v[104:105], v[104:105], v[216:217]
v_pk_mul_f32 v[106:107], v[106:107], v[218:219]
v_pk_mul_f32 v[104:105], v[104:105], v[12:13]
v_pk_mul_f32 v[106:107], v[106:107], v[14:15]
v_cvt_pk_bf16_f32 v90, v104, v105
v_cvt_pk_bf16_f32 v91, v106, v107
buffer_store_dwordx4 v[88:91], v10, s[36:39], s59 offen offset:0 sc1
v_pk_mul_f32 v[12:13], v[92:93], v[92:93]
v_pk_mul_f32 v[14:15], v[94:95], v[94:95]
v_pk_fma_f32 v[12:13], v[12:13], s[24:25], s[24:25] op_sel:[0,0,1] op_sel_hi:[1,0,1]
v_pk_fma_f32 v[14:15], v[14:15], s[24:25], s[24:25] op_sel:[0,0,1] op_sel_hi:[1,0,1]
v_pk_mul_f32 v[12:13], v[12:13], v[92:93]
v_pk_mul_f32 v[14:15], v[14:15], v[94:95]
v_exp_f32 v12, v12
v_exp_f32 v13, v13
v_exp_f32 v14, v14
v_exp_f32 v15, v15
v_pk_add_f32 v[12:13], v[12:13], 1.0 op_sel_hi:[1,0]
v_pk_add_f32 v[14:15], v[14:15], 1.0 op_sel_hi:[1,0]
v_rcp_f32 v12, v12
v_rcp_f32 v13, v13
v_rcp_f32 v14, v14
v_rcp_f32 v15, v15
v_pk_mul_f32 v[92:93], v[92:93], v[204:205]
v_pk_mul_f32 v[94:95], v[94:95], v[206:207]
v_pk_mul_f32 v[92:93], v[92:93], v[12:13]
v_pk_mul_f32 v[94:95], v[94:95], v[14:15]
v_cvt_pk_bf16_f32 v92, v92, v93
v_cvt_pk_bf16_f32 v93, v94, v95
v_pk_mul_f32 v[12:13], v[108:109], v[108:109]
v_pk_mul_f32 v[14:15], v[110:111], v[110:111]
v_pk_fma_f32 v[12:13], v[12:13], s[24:25], s[24:25] op_sel:[0,0,1] op_sel_hi:[1,0,1]
v_pk_fma_f32 v[14:15], v[14:15], s[24:25], s[24:25] op_sel:[0,0,1] op_sel_hi:[1,0,1]
v_pk_mul_f32 v[12:13], v[12:13], v[108:109]
v_pk_mul_f32 v[14:15], v[14:15], v[110:111]
v_exp_f32 v12, v12
v_exp_f32 v13, v13
v_exp_f32 v14, v14
v_exp_f32 v15, v15
v_pk_add_f32 v[12:13], v[12:13], 1.0 op_sel_hi:[1,0]
v_pk_add_f32 v[14:15], v[14:15], 1.0 op_sel_hi:[1,0]
v_rcp_f32 v12, v12
v_rcp_f32 v13, v13
v_rcp_f32 v14, v14
v_rcp_f32 v15, v15
v_pk_mul_f32 v[108:109], v[108:109], v[220:221]
v_pk_mul_f32 v[110:111], v[110:111], v[222:223]
v_pk_mul_f32 v[108:109], v[108:109], v[12:13]
v_pk_mul_f32 v[110:111], v[110:111], v[14:15]
v_cvt_pk_bf16_f32 v94, v108, v109
v_cvt_pk_bf16_f32 v95, v110, v111
buffer_store_dwordx4 v[92:95], v10, s[36:39], s59 offen offset:1024 sc1
v_mov_b32 v100, s9
v_lshlrev_b32 v101, 23, v0
v_lshlrev_b32 v102, 7, v0
v_and_b32 v102, 0x380, v102
s_lshr_b32 s12, s17, 1
s_lshl_b32 s12, s12, 11
v_add_u32 v104, s12, v10
v_xor_b32 v105, 2048, v104
s_add_u32 s59, s95, 16384
v_pk_mul_f32 v[12:13], v[112:113], v[112:113]
v_pk_mul_f32 v[14:15], v[114:115], v[114:115]
v_pk_fma_f32 v[12:13], v[12:13], s[24:25], s[24:25] op_sel:[0,0,1] op_sel_hi:[1,0,1]
v_pk_fma_f32 v[14:15], v[14:15], s[24:25], s[24:25] op_sel:[0,0,1] op_sel_hi:[1,0,1]
v_pk_mul_f32 v[12:13], v[12:13], v[112:113]
v_pk_mul_f32 v[14:15], v[14:15], v[114:115]
v_exp_f32 v12, v12
v_exp_f32 v13, v13
v_exp_f32 v14, v14
v_exp_f32 v15, v15
v_pk_add_f32 v[12:13], v[12:13], 1.0 op_sel_hi:[1,0]
v_pk_add_f32 v[14:15], v[14:15], 1.0 op_sel_hi:[1,0]
v_rcp_f32 v12, v12
v_rcp_f32 v13, v13
v_rcp_f32 v14, v14
v_rcp_f32 v15, v15
v_pk_mul_f32 v[112:113], v[112:113], v[224:225]
v_pk_mul_f32 v[114:115], v[114:115], v[226:227]
v_pk_mul_f32 v[112:113], v[112:113], v[12:13]
v_pk_mul_f32 v[114:115], v[114:115], v[14:15]
v_cvt_pk_bf16_f32 v112, v112, v113
L_pad3:
s_cbranch_execz L_pad7
v_cvt_pk_bf16_f32 v113, v114, v115
v_pk_mul_f32 v[12:13], v[128:129], v[128:129]
v_pk_mul_f32 v[14:15], v[130:131], v[130:131]
v_pk_fma_f32 v[12:13], v[12:13], s[24:25], s[24:25] op_sel:[0,0,1] op_sel_hi:[1,0,1]
v_pk_fma_f32 v[14:15], v[14:15], s[24:25], s[24:25] op_sel:[0,0,1] op_sel_hi:[1,0,1]
v_pk_mul_f32 v[12:13], v[12:13], v[128:129]
v_pk_mul_f32 v[14:15], v[14:15], v[130:131]
v_exp_f32 v12, v12
v_exp_f32 v13, v13
v_exp_f32 v14, v14
v_exp_f32 v15, v15
v_pk_add_f32 v[12:13], v[12:13], 1.0 op_sel_hi:[1,0]
v_pk_add_f32 v[14:15], v[14:15], 1.0 op_sel_hi:[1,0]
v_rcp_f32 v12, v12
v_rcp_f32 v13, v13
v_rcp_f32 v14, v14
v_rcp_f32 v15, v15
v_pk_mul_f32 v[128:129], v[128:129], v[240:241]
v_pk_mul_f32 v[130:131], v[130:131], v[242:243]
v_pk_mul_f32 v[128:129], v[128:129], v[12:13]
v_pk_mul_f32 v[130:131], v[130:131], v[14:15]
v_cvt_pk_bf16_f32 v114, v128, v129
v_cvt_pk_bf16_f32 v115, v130, v131
buffer_store_dwordx4 v[112:115], v10, s[36:39], s59 offen offset:0 sc1
v_pk_mul_f32 v[12:13], v[116:117], v[116:117]
v_pk_mul_f32 v[14:15], v[118:119], v[118:119]
v_pk_fma_f32 v[12:13], v[12:13], s[24:25], s[24:25] op_sel:[0,0,1] op_sel_hi:[1,0,1]
v_pk_fma_f32 v[14:15], v[14:15], s[24:25], s[24:25] op_sel:[0,0,1] op_sel_hi:[1,0,1]
v_pk_mul_f32 v[12:13], v[12:13], v[116:117]
v_pk_mul_f32 v[14:15], v[14:15], v[118:119]
v_exp_f32 v12, v12
v_exp_f32 v13, v13
v_exp_f32 v14, v14
v_exp_f32 v15, v15
v_pk_add_f32 v[12:13], v[12:13], 1.0 op_sel_hi:[1,0]
v_pk_add_f32 v[14:15], v[14:15], 1.0 op_sel_hi:[1,0]
v_rcp_f32 v12, v12
v_rcp_f32 v13, v13
v_rcp_f32 v14, v14
v_rcp_f32 v15, v15
v_pk_mul_f32 v[116:117], v[116:117], v[228:229]
v_pk_mul_f32 v[118:119], v[118:119], v[230:231]
v_pk_mul_f32 v[116:117], v[116:117], v[12:13]
v_pk_mul_f32 v[118:119], v[118:119], v[14:15]
v_cvt_pk_bf16_f32 v116, v116, v117
v_cvt_pk_bf16_f32 v117, v118, v119
v_pk_mul_f32 v[12:13], v[132:133], v[132:133]
v_pk_mul_f32 v[14:15], v[134:135], v[134:135]
v_pk_fma_f32 v[12:13], v[12:13], s[24:25], s[24:25] op_sel:[0,0,1] op_sel_hi:[1,0,1]
v_pk_fma_f32 v[14:15], v[14:15], s[24:25], s[24:25] op_sel:[0,0,1] op_sel_hi:[1,0,1]
v_pk_mul_f32 v[12:13], v[12:13], v[132:133]
v_pk_mul_f32 v[14:15], v[14:15], v[134:135]
v_exp_f32 v12, v12
v_exp_f32 v13, v13
v_exp_f32 v14, v14
v_exp_f32 v15, v15
v_pk_add_f32 v[12:13], v[12:13], 1.0 op_sel_hi:[1,0]
v_pk_add_f32 v[14:15], v[14:15], 1.0 op_sel_hi:[1,0]
v_rcp_f32 v12, v12
v_rcp_f32 v13, v13
v_rcp_f32 v14, v14
v_rcp_f32 v15, v15
v_pk_mul_f32 v[132:133], v[132:133], v[244:245]
v_pk_mul_f32 v[134:135], v[134:135], v[246:247]
v_pk_mul_f32 v[132:133], v[132:133], v[12:13]
v_pk_mul_f32 v[134:135], v[134:135], v[14:15]
v_cvt_pk_bf16_f32 v118, v132, v133
v_cvt_pk_bf16_f32 v119, v134, v135
buffer_store_dwordx4 v[116:119], v10, s[36:39], s59 offen offset:1024 sc1
s_xor_b32 s59, s59, 2048
v_pk_mul_f32 v[12:13], v[120:121], v[120:121]
v_pk_mul_f32 v[14:15], v[122:123], v[122:123]
v_pk_fma_f32 v[12:13], v[12:13], s[24:25], s[24:25] op_sel:[0,0,1] op_sel_hi:[1,0,1]
v_pk_fma_f32 v[14:15], v[14:15], s[24:25], s[24:25] op_sel:[0,0,1] op_sel_hi:[1,0,1]
v_pk_mul_f32 v[12:13], v[12:13], v[120:121]
v_pk_mul_f32 v[14:15], v[14:15], v[122:123]
v_exp_f32 v12, v12
v_exp_f32 v13, v13
v_exp_f32 v14, v14
v_exp_f32 v15, v15
v_pk_add_f32 v[12:13], v[12:13], 1.0 op_sel_hi:[1,0]
v_pk_add_f32 v[14:15], v[14:15], 1.0 op_sel_hi:[1,0]
v_rcp_f32 v12, v12
v_rcp_f32 v13, v13
v_rcp_f32 v14, v14
v_rcp_f32 v15, v15
v_pk_mul_f32 v[120:121], v[120:121], v[232:233]
v_pk_mul_f32 v[122:123], v[122:123], v[234:235]
v_pk_mul_f32 v[120:121], v[120:121], v[12:13]
v_pk_mul_f32 v[122:123], v[122:123], v[14:15]
v_cvt_pk_bf16_f32 v120, v120, v121
v_cvt_pk_bf16_f32 v121, v122, v123
v_pk_mul_f32 v[12:13], v[136:137], v[136:137]
v_pk_mul_f32 v[14:15], v[138:139], v[138:139]
v_pk_fma_f32 v[12:13], v[12:13], s[24:25], s[24:25] op_sel:[0,0,1] op_sel_hi:[1,0,1]
v_pk_fma_f32 v[14:15], v[14:15], s[24:25], s[24:25] op_sel:[0,0,1] op_sel_hi:[1,0,1]
v_pk_mul_f32 v[12:13], v[12:13], v[136:137]
v_pk_mul_f32 v[14:15], v[14:15], v[138:139]
v_exp_f32 v12, v12
v_exp_f32 v13, v13
v_exp_f32 v14, v14
v_exp_f32 v15, v15
v_pk_add_f32 v[12:13], v[12:13], 1.0 op_sel_hi:[1,0]
v_pk_add_f32 v[14:15], v[14:15], 1.0 op_sel_hi:[1,0]
v_rcp_f32 v12, v12
v_rcp_f32 v13, v13
v_rcp_f32 v14, v14
v_rcp_f32 v15, v15
v_pk_mul_f32 v[136:137], v[136:137], v[248:249]
v_pk_mul_f32 v[138:139], v[138:139], v[250:251]
v_pk_mul_f32 v[136:137], v[136:137], v[12:13]
v_pk_mul_f32 v[138:139], v[138:139], v[14:15]
v_cvt_pk_bf16_f32 v122, v136, v137
v_cvt_pk_bf16_f32 v123, v138, v139
buffer_store_dwordx4 v[120:123], v10, s[36:39], s59 offen offset:0 sc1
v_pk_mul_f32 v[12:13], v[124:125], v[124:125]
v_pk_mul_f32 v[14:15], v[126:127], v[126:127]
v_pk_fma_f32 v[12:13], v[12:13], s[24:25], s[24:25] op_sel:[0,0,1] op_sel_hi:[1,0,1]
v_pk_fma_f32 v[14:15], v[14:15], s[24:25], s[24:25] op_sel:[0,0,1] op_sel_hi:[1,0,1]
v_pk_mul_f32 v[12:13], v[12:13], v[124:125]
v_pk_mul_f32 v[14:15], v[14:15], v[126:127]
v_exp_f32 v12, v12
s_waitcnt vmcnt(3)
buffer_store_dword v100, v101, s[48:51], s98 offen offset:0 sc1
v_exp_f32 v13, v13
v_exp_f32 v14, v14
v_exp_f32 v15, v15
v_pk_add_f32 v[12:13], v[12:13], 1.0 op_sel_hi:[1,0]
v_pk_add_f32 v[14:15], v[14:15], 1.0 op_sel_hi:[1,0]
v_rcp_f32 v12, v12
v_rcp_f32 v13, v13
v_rcp_f32 v14, v14
v_rcp_f32 v15, v15
v_pk_mul_f32 v[124:125], v[124:125], v[236:237]
v_pk_mul_f32 v[126:127], v[126:127], v[238:239]
v_pk_mul_f32 v[124:125], v[124:125], v[12:13]
v_pk_mul_f32 v[126:127], v[126:127], v[14:15]
v_cvt_pk_bf16_f32 v124, v124, v125
v_cvt_pk_bf16_f32 v125, v126, v127
v_pk_mul_f32 v[12:13], v[140:141], v[140:141]
v_pk_mul_f32 v[14:15], v[142:143], v[142:143]
v_pk_fma_f32 v[12:13], v[12:13], s[24:25], s[24:25] op_sel:[0,0,1] op_sel_hi:[1,0,1]
v_pk_fma_f32 v[14:15], v[14:15], s[24:25], s[24:25] op_sel:[0,0,1] op_sel_hi:[1,0,1]
v_pk_mul_f32 v[12:13], v[12:13], v[140:141]
v_pk_mul_f32 v[14:15], v[14:15], v[142:143]
v_exp_f32 v12, v12
v_exp_f32 v13, v13
v_exp_f32 v14, v14
v_exp_f32 v15, v15
v_pk_add_f32 v[12:13], v[12:13], 1.0 op_sel_hi:[1,0]
v_pk_add_f32 v[14:15], v[14:15], 1.0 op_sel_hi:[1,0]
v_rcp_f32 v12, v12
v_rcp_f32 v13, v13
v_rcp_f32 v14, v14
v_rcp_f32 v15, v15
v_pk_mul_f32 v[140:141], v[140:141], v[252:253]
v_pk_mul_f32 v[142:143], v[142:143], v[254:255]
v_pk_mul_f32 v[140:141], v[140:141], v[12:13]
v_pk_mul_f32 v[142:143], v[142:143], v[14:15]
v_cvt_pk_bf16_f32 v126, v140, v141
v_cvt_pk_bf16_f32 v127, v142, v143
buffer_store_dwordx4 v[124:127], v10, s[36:39], s59 offen offset:1024 sc1
s_add_u32 s59, s95, 32768
v_accvgpr_read_b32 v96, a32
v_accvgpr_read_b32 v97, a33
v_accvgpr_read_b32 v98, a34
v_accvgpr_read_b32 v99, a35
v_pk_mul_f32 v[12:13], v[144:145], v[144:145]
v_pk_mul_f32 v[14:15], v[146:147], v[146:147]
v_pk_fma_f32 v[12:13], v[12:13], s[24:25], s[24:25] op_sel:[0,0,1] op_sel_hi:[1,0,1]
v_pk_fma_f32 v[14:15], v[14:15], s[24:25], s[24:25] op_sel:[0,0,1] op_sel_hi:[1,0,1]
v_pk_mul_f32 v[12:13], v[12:13], v[144:145]
v_pk_mul_f32 v[14:15], v[14:15], v[146:147]
v_exp_f32 v12, v12
v_exp_f32 v13, v13
v_exp_f32 v14, v14
v_exp_f32 v15, v15
v_pk_add_f32 v[12:13], v[12:13], 1.0 op_sel_hi:[1,0]
v_pk_add_f32 v[14:15], v[14:15], 1.0 op_sel_hi:[1,0]
v_rcp_f32 v12, v12
v_rcp_f32 v13, v13
v_rcp_f32 v14, v14
v_rcp_f32 v15, v15
v_pk_mul_f32 v[144:145], v[144:145], v[96:97]
v_pk_mul_f32 v[146:147], v[146:147], v[98:99]
v_pk_mul_f32 v[144:145], v[144:145], v[12:13]
v_pk_mul_f32 v[146:147], v[146:147], v[14:15]
v_cvt_pk_bf16_f32 v240, v144, v145
v_cvt_pk_bf16_f32 v241, v146, v147
v_accvgpr_read_b32 v96, a48
v_accvgpr_read_b32 v97, a49
v_accvgpr_read_b32 v98, a50
v_accvgpr_read_b32 v99, a51
v_pk_mul_f32 v[12:13], v[160:161], v[160:161]
v_pk_mul_f32 v[14:15], v[162:163], v[162:163]
v_pk_fma_f32 v[12:13], v[12:13], s[24:25], s[24:25] op_sel:[0,0,1] op_sel_hi:[1,0,1]
v_pk_fma_f32 v[14:15], v[14:15], s[24:25], s[24:25] op_sel:[0,0,1] op_sel_hi:[1,0,1]
v_pk_mul_f32 v[12:13], v[12:13], v[160:161]
v_pk_mul_f32 v[14:15], v[14:15], v[162:163]
v_exp_f32 v12, v12
v_exp_f32 v13, v13
v_exp_f32 v14, v14
v_exp_f32 v15, v15
v_pk_add_f32 v[12:13], v[12:13], 1.0 op_sel_hi:[1,0]
v_pk_add_f32 v[14:15], v[14:15], 1.0 op_sel_hi:[1,0]
v_rcp_f32 v12, v12
v_rcp_f32 v13, v13
v_rcp_f32 v14, v14
v_rcp_f32 v15, v15
v_pk_mul_f32 v[160:161], v[160:161], v[96:97]
v_pk_mul_f32 v[162:163], v[162:163], v[98:99]
v_pk_mul_f32 v[160:161], v[160:161], v[12:13]
v_pk_mul_f32 v[162:163], v[162:163], v[14:15]
v_cvt_pk_bf16_f32 v242, v160, v161
v_cvt_pk_bf16_f32 v243, v162, v163
buffer_store_dwordx4 v[240:243], v10, s[36:39], s59 offen offset:0 sc1
v_accvgpr_read_b32 v96, a36
v_accvgpr_read_b32 v97, a37
v_accvgpr_read_b32 v98, a38
v_accvgpr_read_b32 v99, a39
v_pk_mul_f32 v[12:13], v[148:149], v[148:149]
v_pk_mul_f32 v[14:15], v[150:151], v[150:151]
v_pk_fma_f32 v[12:13], v[12:13], s[24:25], s[24:25] op_sel:[0,0,1] op_sel_hi:[1,0,1]
v_pk_fma_f32 v[14:15], v[14:15], s[24:25], s[24:25] op_sel:[0,0,1] op_sel_hi:[1,0,1]
v_pk_mul_f32 v[12:13], v[12:13], v[148:149]
v_pk_mul_f32 v[14:15], v[14:15], v[150:151]
v_exp_f32 v12, v12
v_exp_f32 v13, v13
v_exp_f32 v14, v14
v_exp_f32 v15, v15
v_pk_add_f32 v[12:13], v[12:13], 1.0 op_sel_hi:[1,0]
v_pk_add_f32 v[14:15], v[14:15], 1.0 op_sel_hi:[1,0]
v_rcp_f32 v12, v12
v_rcp_f32 v13, v13
v_rcp_f32 v14, v14
v_rcp_f32 v15, v15
v_pk_mul_f32 v[148:149], v[148:149], v[96:97]
v_pk_mul_f32 v[150:151], v[150:151], v[98:99]
v_pk_mul_f32 v[148:149], v[148:149], v[12:13]
v_pk_mul_f32 v[150:151], v[150:151], v[14:15]
v_cvt_pk_bf16_f32 v244, v148, v149
v_cvt_pk_bf16_f32 v245, v150, v151
v_accvgpr_read_b32 v96, a52
v_accvgpr_read_b32 v97, a53
v_accvgpr_read_b32 v98, a54
v_accvgpr_read_b32 v99, a55
v_pk_mul_f32 v[12:13], v[164:165], v[164:165]
v_pk_mul_f32 v[14:15], v[166:167], v[166:167]
v_pk_fma_f32 v[12:13], v[12:13], s[24:25], s[24:25] op_sel:[0,0,1] op_sel_hi:[1,0,1]
v_pk_fma_f32 v[14:15], v[14:15], s[24:25], s[24:25] op_sel:[0,0,1] op_sel_hi:[1,0,1]
v_pk_mul_f32 v[12:13], v[12:13], v[164:165]
v_pk_mul_f32 v[14:15], v[14:15], v[166:167]
v_exp_f32 v12, v12
v_exp_f32 v13, v13
v_exp_f32 v14, v14
v_exp_f32 v15, v15
v_pk_add_f32 v[12:13], v[12:13], 1.0 op_sel_hi:[1,0]
v_pk_add_f32 v[14:15], v[14:15], 1.0 op_sel_hi:[1,0]
v_rcp_f32 v12, v12
v_rcp_f32 v13, v13
v_rcp_f32 v14, v14
v_rcp_f32 v15, v15
v_pk_mul_f32 v[164:165], v[164:165], v[96:97]
v_pk_mul_f32 v[166:167], v[166:167], v[98:99]
v_pk_mul_f32 v[164:165], v[164:165], v[12:13]
v_pk_mul_f32 v[166:167], v[166:167], v[14:15]
v_cvt_pk_bf16_f32 v246, v164, v165
v_cvt_pk_bf16_f32 v247, v166, v167
buffer_store_dwordx4 v[244:247], v10, s[36:39], s59 offen offset:1024 sc1
s_xor_b32 s59, s59, 2048
v_accvgpr_read_b32 v96, a40
v_accvgpr_read_b32 v97, a41
v_accvgpr_read_b32 v98, a42
v_accvgpr_read_b32 v99, a43
v_pk_mul_f32 v[12:13], v[152:153], v[152:153]
v_pk_mul_f32 v[14:15], v[154:155], v[154:155]
v_pk_fma_f32 v[12:13], v[12:13], s[24:25], s[24:25] op_sel:[0,0,1] op_sel_hi:[1,0,1]
v_pk_fma_f32 v[14:15], v[14:15], s[24:25], s[24:25] op_sel:[0,0,1] op_sel_hi:[1,0,1]
v_pk_mul_f32 v[12:13], v[12:13], v[152:153]
v_pk_mul_f32 v[14:15], v[14:15], v[154:155]
v_exp_f32 v12, v12
v_exp_f32 v13, v13
v_exp_f32 v14, v14
v_exp_f32 v15, v15
v_pk_add_f32 v[12:13], v[12:13], 1.0 op_sel_hi:[1,0]
v_pk_add_f32 v[14:15], v[14:15], 1.0 op_sel_hi:[1,0]
v_rcp_f32 v12, v12
v_rcp_f32 v13, v13
v_rcp_f32 v14, v14
v_rcp_f32 v15, v15
v_pk_mul_f32 v[152:153], v[152:153], v[96:97]
v_pk_mul_f32 v[154:155], v[154:155], v[98:99]
v_pk_mul_f32 v[152:153], v[152:153], v[12:13]
v_pk_mul_f32 v[154:155], v[154:155], v[14:15]
v_cvt_pk_bf16_f32 v248, v152, v153
v_cvt_pk_bf16_f32 v249, v154, v155
v_accvgpr_read_b32 v96, a56
v_accvgpr_read_b32 v97, a57
v_accvgpr_read_b32 v98, a58
v_accvgpr_read_b32 v99, a59
v_pk_mul_f32 v[12:13], v[168:169], v[168:169]
v_pk_mul_f32 v[14:15], v[170:171], v[170:171]
v_pk_fma_f32 v[12:13], v[12:13], s[24:25], s[24:25] op_sel:[0,0,1] op_sel_hi:[1,0,1]
v_pk_fma_f32 v[14:15], v[14:15], s[24:25], s[24:25] op_sel:[0,0,1] op_sel_hi:[1,0,1]
v_pk_mul_f32 v[12:13], v[12:13], v[168:169]
v_pk_mul_f32 v[14:15], v[14:15], v[170:171]
v_exp_f32 v12, v12
v_exp_f32 v13, v13
v_exp_f32 v14, v14
v_exp_f32 v15, v15
v_pk_add_f32 v[12:13], v[12:13], 1.0 op_sel_hi:[1,0]
v_pk_add_f32 v[14:15], v[14:15], 1.0 op_sel_hi:[1,0]
v_rcp_f32 v12, v12
buffer_load_dword v103, v102, s[48:51], s97 offen offset:0 sc1
v_rcp_f32 v13, v13
v_rcp_f32 v14, v14
v_rcp_f32 v15, v15
v_pk_mul_f32 v[168:169], v[168:169], v[96:97]
v_pk_mul_f32 v[170:171], v[170:171], v[98:99]
v_pk_mul_f32 v[168:169], v[168:169], v[12:13]
v_pk_mul_f32 v[170:171], v[170:171], v[14:15]
v_cvt_pk_bf16_f32 v250, v168, v169
v_cvt_pk_bf16_f32 v251, v170, v171
buffer_store_dwordx4 v[248:251], v10, s[36:39], s59 offen offset:0 sc1
v_accvgpr_read_b32 v96, a44
v_accvgpr_read_b32 v97, a45
v_accvgpr_read_b32 v98, a46
v_accvgpr_read_b32 v99, a47
v_pk_mul_f32 v[12:13], v[156:157], v[156:157]
v_pk_mul_f32 v[14:15], v[158:159], v[158:159]
v_pk_fma_f32 v[12:13], v[12:13], s[24:25], s[24:25] op_sel:[0,0,1] op_sel_hi:[1,0,1]
v_pk_fma_f32 v[14:15], v[14:15], s[24:25], s[24:25] op_sel:[0,0,1] op_sel_hi:[1,0,1]
v_pk_mul_f32 v[12:13], v[12:13], v[156:157]
v_pk_mul_f32 v[14:15], v[14:15], v[158:159]
v_exp_f32 v12, v12
v_exp_f32 v13, v13
v_exp_f32 v14, v14
v_exp_f32 v15, v15
v_pk_add_f32 v[12:13], v[12:13], 1.0 op_sel_hi:[1,0]
v_pk_add_f32 v[14:15], v[14:15], 1.0 op_sel_hi:[1,0]
v_rcp_f32 v12, v12
v_rcp_f32 v13, v13
v_rcp_f32 v14, v14
v_rcp_f32 v15, v15
v_pk_mul_f32 v[156:157], v[156:157], v[96:97]
v_pk_mul_f32 v[158:159], v[158:159], v[98:99]
v_pk_mul_f32 v[156:157], v[156:157], v[12:13]
v_pk_mul_f32 v[158:159], v[158:159], v[14:15]
v_cvt_pk_bf16_f32 v252, v156, v157
v_cvt_pk_bf16_f32 v253, v158, v159
v_accvgpr_read_b32 v96, a60
v_accvgpr_read_b32 v97, a61
v_accvgpr_read_b32 v98, a62
v_accvgpr_read_b32 v99, a63
v_pk_mul_f32 v[12:13], v[172:173], v[172:173]
v_pk_mul_f32 v[14:15], v[174:175], v[174:175]
v_pk_fma_f32 v[12:13], v[12:13], s[24:25], s[24:25] op_sel:[0,0,1] op_sel_hi:[1,0,1]
v_pk_fma_f32 v[14:15], v[14:15], s[24:25], s[24:25] op_sel:[0,0,1] op_sel_hi:[1,0,1]
v_pk_mul_f32 v[12:13], v[12:13], v[172:173]
v_pk_mul_f32 v[14:15], v[14:15], v[174:175]
v_exp_f32 v12, v12
v_exp_f32 v13, v13
v_exp_f32 v14, v14
v_exp_f32 v15, v15
v_pk_add_f32 v[12:13], v[12:13], 1.0 op_sel_hi:[1,0]
v_pk_add_f32 v[14:15], v[14:15], 1.0 op_sel_hi:[1,0]
v_rcp_f32 v12, v12
v_rcp_f32 v13, v13
v_rcp_f32 v14, v14
v_rcp_f32 v15, v15
v_pk_mul_f32 v[172:173], v[172:173], v[96:97]
v_pk_mul_f32 v[174:175], v[174:175], v[98:99]
v_pk_mul_f32 v[172:173], v[172:173], v[12:13]
v_pk_mul_f32 v[174:175], v[174:175], v[14:15]
v_cvt_pk_bf16_f32 v254, v172, v173
v_cvt_pk_bf16_f32 v255, v174, v175
buffer_store_dwordx4 v[252:255], v10, s[36:39], s59 offen offset:1024 sc1
v_accvgpr_read_b32 v96, a64
v_accvgpr_read_b32 v97, a65
v_accvgpr_read_b32 v98, a66
v_accvgpr_read_b32 v99, a67
v_pk_mul_f32 v[12:13], v[176:177], v[176:177]
v_pk_mul_f32 v[14:15], v[178:179], v[178:179]
v_pk_fma_f32 v[12:13], v[12:13], s[24:25], s[24:25] op_sel:[0,0,1] op_sel_hi:[1,0,1]
v_pk_fma_f32 v[14:15], v[14:15], s[24:25], s[24:25] op_sel:[0,0,1] op_sel_hi:[1,0,1]
v_pk_mul_f32 v[12:13], v[12:13], v[176:177]
v_pk_mul_f32 v[14:15], v[14:15], v[178:179]
v_exp_f32 v12, v12
v_exp_f32 v13, v13
v_exp_f32 v14, v14
v_exp_f32 v15, v15
v_pk_add_f32 v[12:13], v[12:13], 1.0 op_sel_hi:[1,0]
v_pk_add_f32 v[14:15], v[14:15], 1.0 op_sel_hi:[1,0]
v_rcp_f32 v12, v12
v_rcp_f32 v13, v13
v_rcp_f32 v14, v14
v_rcp_f32 v15, v15
v_pk_mul_f32 v[176:177], v[176:177], v[96:97]
v_pk_mul_f32 v[178:179], v[178:179], v[98:99]
v_pk_mul_f32 v[176:177], v[176:177], v[12:13]
v_pk_mul_f32 v[178:179], v[178:179], v[14:15]
v_cvt_pk_bf16_f32 v176, v176, v177
v_cvt_pk_bf16_f32 v177, v178, v179
v_accvgpr_read_b32 v96, a68
v_accvgpr_read_b32 v97, a69
v_accvgpr_read_b32 v98, a70
v_accvgpr_read_b32 v99, a71
v_pk_mul_f32 v[12:13], v[180:181], v[180:181]
v_pk_mul_f32 v[14:15], v[182:183], v[182:183]
v_pk_fma_f32 v[12:13], v[12:13], s[24:25], s[24:25] op_sel:[0,0,1] op_sel_hi:[1,0,1]
v_pk_fma_f32 v[14:15], v[14:15], s[24:25], s[24:25] op_sel:[0,0,1] op_sel_hi:[1,0,1]
v_pk_mul_f32 v[12:13], v[12:13], v[180:181]
v_pk_mul_f32 v[14:15], v[14:15], v[182:183]
v_exp_f32 v12, v12
v_exp_f32 v13, v13
v_exp_f32 v14, v14
v_exp_f32 v15, v15
v_pk_add_f32 v[12:13], v[12:13], 1.0 op_sel_hi:[1,0]
v_pk_add_f32 v[14:15], v[14:15], 1.0 op_sel_hi:[1,0]
v_rcp_f32 v12, v12
v_rcp_f32 v13, v13
v_rcp_f32 v14, v14
v_rcp_f32 v15, v15
v_pk_mul_f32 v[180:181], v[180:181], v[96:97]
v_pk_mul_f32 v[182:183], v[182:183], v[98:99]
v_pk_mul_f32 v[180:181], v[180:181], v[12:13]
v_pk_mul_f32 v[182:183], v[182:183], v[14:15]
v_cvt_pk_bf16_f32 v178, v180, v181
v_cvt_pk_bf16_f32 v179, v182, v183
v_and_b32 v1, 15, v0
v_lshlrev_b32 v1, 4, v1
v_bfe_u32 v9, v0, 4, 1
v_lshl_add_u32 v1, v9, 10, v1
v_lshrrev_b32 v9, 5, v0
v_lshl_add_u32 v1, v9, 8, v1
s_lshl_b32 s12, s67, 9
s_add_u32 s12, s12, s90
v_add_u32 v1, s12, v1
s_mul_i32 s12, s67, 65536
s_sub_u32 s58, s95, s12
s_add_u32 s58, s58, 49152
v_permlane16_swap_b32 v176, v178
v_permlane16_swap_b32 v177, v179
buffer_store_dwordx4 v[176:179], v1, s[36:39], s58 offen sc1
v_accvgpr_read_b32 v96, a72
v_accvgpr_read_b32 v97, a73
v_accvgpr_read_b32 v98, a74
v_accvgpr_read_b32 v99, a75
v_pk_mul_f32 v[12:13], v[184:185], v[184:185]
v_pk_mul_f32 v[14:15], v[186:187], v[186:187]
v_pk_fma_f32 v[12:13], v[12:13], s[24:25], s[24:25] op_sel:[0,0,1] op_sel_hi:[1,0,1]
v_pk_fma_f32 v[14:15], v[14:15], s[24:25], s[24:25] op_sel:[0,0,1] op_sel_hi:[1,0,1]
v_pk_mul_f32 v[12:13], v[12:13], v[184:185]
v_pk_mul_f32 v[14:15], v[14:15], v[186:187]
v_exp_f32 v12, v12
v_exp_f32 v13, v13
v_exp_f32 v14, v14
v_exp_f32 v15, v15
v_pk_add_f32 v[12:13], v[12:13], 1.0 op_sel_hi:[1,0]
v_pk_add_f32 v[14:15], v[14:15], 1.0 op_sel_hi:[1,0]
v_rcp_f32 v12, v12
v_rcp_f32 v13, v13
v_rcp_f32 v14, v14
v_rcp_f32 v15, v15
v_pk_mul_f32 v[184:185], v[184:185], v[96:97]
v_pk_mul_f32 v[186:187], v[186:187], v[98:99]
v_pk_mul_f32 v[184:185], v[184:185], v[12:13]
v_pk_mul_f32 v[186:187], v[186:187], v[14:15]
v_cvt_pk_bf16_f32 v184, v184, v185
v_cvt_pk_bf16_f32 v185, v186, v187
v_accvgpr_read_b32 v96, a76
v_accvgpr_read_b32 v97, a77
v_accvgpr_read_b32 v98, a78
v_accvgpr_read_b32 v99, a79
v_pk_mul_f32 v[12:13], v[188:189], v[188:189]
v_pk_mul_f32 v[14:15], v[190:191], v[190:191]
v_pk_fma_f32 v[12:13], v[12:13], s[24:25], s[24:25] op_sel:[0,0,1] op_sel_hi:[1,0,1]
v_pk_fma_f32 v[14:15], v[14:15], s[24:25], s[24:25] op_sel:[0,0,1] op_sel_hi:[1,0,1]
v_pk_mul_f32 v[12:13], v[12:13], v[188:189]
s_waitcnt vmcnt(3)
v_cmp_ne_u32 vcc, s9, v103
s_mov_b32 s16, 0
s_nop 0
s_cbranch_vccz L_ph0_ok
L_ph0:
buffer_load_dword v103, v102, s[48:51], s97 offen offset:0 sc1
s_waitcnt vmcnt(0)
v_cmp_ne_u32 vcc, s9, v103
s_add_u32 s16, s16, 1
s_nop 0
s_cbranch_vccz L_ph0_ok
s_cmp_lt_u32 s16, 0x100000
s_cbranch_scc1 L_ph0
L_ph0_ok:
s_add_u32 s53, s8, 0
buffer_load_dwordx4 a[120:123], v104, s[36:39], s53 offen offset:0 sc1
v_pk_mul_f32 v[14:15], v[14:15], v[190:191]
v_exp_f32 v12, v12
v_exp_f32 v13, v13
v_exp_f32 v14, v14
v_exp_f32 v15, v15
v_pk_add_f32 v[12:13], v[12:13], 1.0 op_sel_hi:[1,0]
v_pk_add_f32 v[14:15], v[14:15], 1.0 op_sel_hi:[1,0]
v_rcp_f32 v12, v12
v_rcp_f32 v13, v13
v_rcp_f32 v14, v14
v_rcp_f32 v15, v15
v_pk_mul_f32 v[188:189], v[188:189], v[96:97]
v_pk_mul_f32 v[190:191], v[190:191], v[98:99]
v_pk_mul_f32 v[188:189], v[188:189], v[12:13]
v_pk_mul_f32 v[190:191], v[190:191], v[14:15]
v_cvt_pk_bf16_f32 v186, v188, v189
v_cvt_pk_bf16_f32 v187, v190, v191
s_xor_b32 s58, s58, 2048
v_permlane16_swap_b32 v184, v186
v_permlane16_swap_b32 v185, v187
buffer_store_dwordx4 v[184:187], v1, s[36:39], s58 offen sc1
buffer_load_dwordx4 a[124:127], v104, s[36:39], s53 offen offset:1024 sc1
v_pk_fma_f32 v[32:33], v[32:33], s[28:29], v[28:29] op_sel:[0,0,0] op_sel_hi:[1,0,0]
v_pk_fma_f32 v[34:35], v[34:35], s[28:29], v[28:29] op_sel:[0,0,0] op_sel_hi:[1,0,0]
v_pk_fma_f32 v[64:65], v[64:65], s[28:29], v[28:29] op_sel:[0,0,0] op_sel_hi:[1,0,0]
v_pk_fma_f32 v[66:67], v[66:67], s[28:29], v[28:29] op_sel:[0,0,0] op_sel_hi:[1,0,0]
v_exp_f32 v32, v32
v_exp_f32 v33, v33
v_exp_f32 v34, v34
v_exp_f32 v35, v35
v_exp_f32 v64, v64
v_exp_f32 v65, v65
v_exp_f32 v66, v66
buffer_load_dwordx4 a[128:131], v105, s[36:39], s53 offen offset:0 sc1
v_exp_f32 v67, v67
v_pk_add_f32 v[200:201], v[32:33], v[34:35]
v_pk_add_f32 v[200:201], v[200:201], v[64:65]
v_pk_add_f32 v[200:201], v[200:201], v[66:67]
v_add_f32 v28, v200, v201
v_pk_fma_f32 v[20:21], v[36:37], s[26:27], v[60:61] op_sel:[0,0,1] op_sel_hi:[1,0,1]
v_pk_fma_f32 v[22:23], v[38:39], s[26:27], v[60:61] op_sel:[0,0,1] op_sel_hi:[1,0,1]
v_pk_fma_f32 v[52:53], v[68:69], s[26:27], v[60:61] op_sel:[0,0,1] op_sel_hi:[1,0,1]
v_pk_fma_f32 v[54:55], v[70:71], s[26:27], v[60:61] op_sel:[0,0,1] op_sel_hi:[1,0,1]
v_exp_f32 v20, v20
v_exp_f32 v21, v21
v_exp_f32 v22, v22
v_exp_f32 v23, v23
buffer_load_dwordx4 a[132:135], v105, s[36:39], s53 offen offset:1024 sc1
v_exp_f32 v52, v52
v_exp_f32 v53, v53
v_exp_f32 v54, v54
v_exp_f32 v55, v55
v_pk_add_f32 v[200:201], v[20:21], v[22:23]
v_pk_add_f32 v[200:201], v[200:201], v[52:53]
v_pk_add_f32 v[200:201], v[200:201], v[54:55]
v_add_f32 v61, v200, v201
v_pk_fma_f32 v[36:37], v[36:37], s[28:29], v[28:29] op_sel:[0,0,1] op_sel_hi:[1,0,1]
v_pk_fma_f32 v[38:39], v[38:39], s[28:29], v[28:29] op_sel:[0,0,1] op_sel_hi:[1,0,1]
v_pk_fma_f32 v[68:69], v[68:69], s[28:29], v[28:29] op_sel:[0,0,1] op_sel_hi:[1,0,1]
v_pk_fma_f32 v[70:71], v[70:71], s[28:29], v[28:29] op_sel:[0,0,1] op_sel_hi:[1,0,1]
v_exp_f32 v36, v36
s_add_u32 s53, s81, 0
buffer_load_dwordx4 a[136:139], v104, s[36:39], s53 offen offset:0 sc1
v_exp_f32 v37, v37
v_exp_f32 v38, v38
v_exp_f32 v39, v39
v_exp_f32 v68, v68
v_exp_f32 v69, v69
v_exp_f32 v70, v70
v_exp_f32 v71, v71
v_pk_add_f32 v[200:201], v[36:37], v[38:39]
v_pk_add_f32 v[200:201], v[200:201], v[68:69]
v_pk_add_f32 v[200:201], v[200:201], v[70:71]
v_add_f32 v29, v200, v201
buffer_load_dwordx4 a[140:143], v104, s[36:39], s53 offen offset:1024 sc1
v_pk_fma_f32 v[24:25], v[40:41], s[26:27], v[62:63] op_sel:[0,0,0] op_sel_hi:[1,0,0]
v_pk_fma_f32 v[26:27], v[42:43], s[26:27], v[62:63] op_sel:[0,0,0] op_sel_hi:[1,0,0]
v_pk_fma_f32 v[56:57], v[72:73], s[26:27], v[62:63] op_sel:[0,0,0] op_sel_hi:[1,0,0]
v_pk_fma_f32 v[58:59], v[74:75], s[26:27], v[62:63] op_sel:[0,0,0] op_sel_hi:[1,0,0]
v_exp_f32 v24, v24
v_exp_f32 v25, v25
v_exp_f32 v26, v26
v_exp_f32 v27, v27
v_exp_f32 v56, v56
v_exp_f32 v57, v57
v_exp_f32 v58, v58
buffer_load_dwordx4 a[144:147], v105, s[36:39], s53 offen offset:0 sc1
v_exp_f32 v59, v59
v_pk_add_f32 v[200:201], v[24:25], v[26:27]
v_pk_add_f32 v[200:201], v[200:201], v[56:57]
v_pk_add_f32 v[200:201], v[200:201], v[58:59]
v_add_f32 v62, v200, v201
v_pk_fma_f32 v[40:41], v[40:41], s[28:29], v[30:31] op_sel:[0,0,0] op_sel_hi:[1,0,0]
v_pk_fma_f32 v[42:43], v[42:43], s[28:29], v[30:31] op_sel:[0,0,0] op_sel_hi:[1,0,0]
v_pk_fma_f32 v[72:73], v[72:73], s[28:29], v[30:31] op_sel:[0,0,0] op_sel_hi:[1,0,0]
v_pk_fma_f32 v[74:75], v[74:75], s[28:29], v[30:31] op_sel:[0,0,0] op_sel_hi:[1,0,0]
v_exp_f32 v40, v40
v_exp_f32 v41, v41
v_exp_f32 v42, v42
v_exp_f32 v43, v43
buffer_load_dwordx4 a[148:151], v105, s[36:39], s53 offen offset:1024 sc1
v_exp_f32 v72, v72
v_exp_f32 v73, v73
v_exp_f32 v74, v74
v_exp_f32 v75, v75
v_pk_add_f32 v[200:201], v[40:41], v[42:43]
v_pk_add_f32 v[200:201], v[200:201], v[72:73]
v_pk_add_f32 v[200:201], v[200:201], v[74:75]
v_add_f32 v30, v200, v201
v_pk_fma_f32 v[192:193], v[44:45], s[26:27], v[62:63] op_sel:[0,0,1] op_sel_hi:[1,0,1]
v_pk_fma_f32 v[194:195], v[46:47], s[26:27], v[62:63] op_sel:[0,0,1] op_sel_hi:[1,0,1]
v_pk_fma_f32 v[196:197], v[76:77], s[26:27], v[62:63] op_sel:[0,0,1] op_sel_hi:[1,0,1]
v_pk_fma_f32 v[198:199], v[78:79], s[26:27], v[62:63] op_sel:[0,0,1] op_sel_hi:[1,0,1]
v_exp_f32 v192, v192
s_add_u32 s53, s81, 65536
buffer_load_dwordx4 a[152:155], v104, s[36:39], s53 offen offset:0 sc1
v_exp_f32 v193, v193
v_exp_f32 v194, v194
v_exp_f32 v195, v195
v_exp_f32 v196, v196
v_exp_f32 v197, v197
v_exp_f32 v198, v198
v_exp_f32 v199, v199
v_pk_add_f32 v[200:201], v[192:193], v[194:195]
v_pk_add_f32 v[200:201], v[200:201], v[196:197]
v_pk_add_f32 v[200:201], v[200:201], v[198:199]
v_add_f32 v63, v200, v201
buffer_load_dwordx4 a[156:159], v104, s[36:39], s53 offen offset:1024 sc1
v_pk_fma_f32 v[44:45], v[44:45], s[28:29], v[30:31] op_sel:[0,0,1] op_sel_hi:[1,0,1]
v_pk_fma_f32 v[46:47], v[46:47], s[28:29], v[30:31] op_sel:[0,0,1] op_sel_hi:[1,0,1]
v_pk_fma_f32 v[76:77], v[76:77], s[28:29], v[30:31] op_sel:[0,0,1] op_sel_hi:[1,0,1]
v_pk_fma_f32 v[78:79], v[78:79], s[28:29], v[30:31] op_sel:[0,0,1] op_sel_hi:[1,0,1]
v_exp_f32 v44, v44
L_pad4:
s_cbranch_execz L_pad8
v_exp_f32 v45, v45
v_exp_f32 v46, v46
v_exp_f32 v47, v47
v_exp_f32 v76, v76
v_exp_f32 v77, v77
v_exp_f32 v78, v78
buffer_load_dwordx4 a[160:163], v105, s[36:39], s53 offen offset:0 sc1
v_exp_f32 v79, v79
v_pk_add_f32 v[200:201], v[44:45], v[46:47]
v_pk_add_f32 v[200:201], v[200:201], v[76:77]
v_pk_add_f32 v[200:201], v[200:201], v[78:79]
v_add_f32 v31, v200, v201
v_permlane16_swap_b32 v28, v29
v_subrev_u32 v11, 114688, v11
v_permlane16_swap_b32 v60, v61
v_lshrrev_b32 v14, 4, v0
v_permlane16_swap_b32 v30, v31
v_and_b32 v12, 3, v0
v_permlane16_swap_b32 v62, v63
v_lshrrev_b32 v15, 2, v0
buffer_load_dwordx4 a[164:167], v105, s[36:39], s53 offen offset:1024 sc1
v_add_f32 v28, v28, v29
v_lshlrev_b32 v13, 3, v12
v_add_f32 v60, v60, v61
v_xor_b32 v9, v12, v14
v_add_f32 v30, v30, v31
v_lshlrev_b32 v9, 3, v9
v_add_f32 v62, v62, v63
v_lshl_add_u32 v9, v15, 5, v9
v_permlane32_swap_b32 v28, v30
s_lshl_b32 s12, s3, 13
v_permlane32_swap_b32 v60, v62
v_add_u32 v109, s12, v9
v_add_f32 v28, v28, v30
v_add_u32 v108, 114688, v9
v_add_f32 v60, v60, v62
v_lshlrev_b32 v107, 4, v0
s_add_u32 s53, s82, 0
buffer_load_dwordx4 a[168:171], v104, s[36:39], s53 offen offset:0 sc1
v_rcp_f32 v28, v28
v_and_b32 v110, 48, v0
v_rcp_f32 v60, v60
v_and_b32 v9, 1, v0
v_mov_b32 v30, v28
v_lshl_add_u32 v110, v9, 6, v110
v_mov_b32 v62, v60
v_mov_b32 v9, 0x3f803f80
v_permlane32_swap_b32 v28, v30
v_accvgpr_write_b32 a116, v9
v_permlane32_swap_b32 v60, v62
v_accvgpr_write_b32 a117, v9
v_mov_b32 v29, v28
v_accvgpr_write_b32 a118, v9
buffer_load_dwordx4 a[172:175], v104, s[36:39], s53 offen offset:1024 sc1
v_mov_b32 v61, v60
v_accvgpr_write_b32 a119, v9
v_mov_b32 v31, v30
v_mov_b32 v63, v62
v_permlane16_swap_b32 v28, v29
v_permlane16_swap_b32 v60, v61
v_permlane16_swap_b32 v30, v31
v_permlane16_swap_b32 v62, v63
v_pk_mul_f32 v[32:33], v[32:33], v[28:29] op_sel:[0,0] op_sel_hi:[1,0]
v_pk_mul_f32 v[34:35], v[34:35], v[28:29] op_sel:[0,0] op_sel_hi:[1,0]
v_pk_mul_f32 v[64:65], v[64:65], v[28:29] op_sel:[0,0] op_sel_hi:[1,0]
v_pk_mul_f32 v[66:67], v[66:67], v[28:29] op_sel:[0,0] op_sel_hi:[1,0]
v_cvt_pk_bf16_f32 v32, v32, v33
v_cvt_pk_bf16_f32 v33, v34, v35
buffer_load_dwordx4 a[188:191], v105, s[36:39], s53 offen offset:0 sc1
v_cvt_pk_bf16_f32 v34, v64, v65
v_cvt_pk_bf16_f32 v35, v66, v67
ds_write_b64 v11, v[32:33] offset:0
ds_write_b64 v11, v[34:35] offset:8192
v_pk_mul_f32 v[16:17], v[16:17], v[60:61] op_sel:[0,0] op_sel_hi:[1,0]
v_pk_mul_f32 v[18:19], v[18:19], v[60:61] op_sel:[0,0] op_sel_hi:[1,0]
v_pk_mul_f32 v[48:49], v[48:49], v[60:61] op_sel:[0,0] op_sel_hi:[1,0]
v_pk_mul_f32 v[50:51], v[50:51], v[60:61] op_sel:[0,0] op_sel_hi:[1,0]
v_cvt_pk_bf16_f32 v16, v16, v17
v_cvt_pk_bf16_f32 v17, v18, v19
v_cvt_pk_bf16_f32 v18, v48, v49
v_cvt_pk_bf16_f32 v19, v50, v51
ds_write_b64 v11, v[16:17] offset:16384
ds_write_b64 v11, v[18:19] offset:24576
v_pk_mul_f32 v[36:37], v[36:37], v[28:29] op_sel:[0,1] op_sel_hi:[1,1]
v_pk_mul_f32 v[38:39], v[38:39], v[28:29] op_sel:[0,1] op_sel_hi:[1,1]
s_waitcnt vmcnt(14)
buffer_store_dword v100, v101, s[48:51], s98 offen offset:4 sc1
v_pk_mul_f32 v[68:69], v[68:69], v[28:29] op_sel:[0,1] op_sel_hi:[1,1]
v_pk_mul_f32 v[70:71], v[70:71], v[28:29] op_sel:[0,1] op_sel_hi:[1,1]
buffer_load_dwordx4 a[192:195], v105, s[36:39], s53 offen offset:1024 sc1
v_cvt_pk_bf16_f32 v36, v36, v37
v_cvt_pk_bf16_f32 v37, v38, v39
v_cvt_pk_bf16_f32 v38, v68, v69
v_cvt_pk_bf16_f32 v39, v70, v71
ds_write_b64 v11, v[36:37] offset:512
ds_write_b64 v11, v[38:39] offset:8704
v_pk_mul_f32 v[20:21], v[20:21], v[60:61] op_sel:[0,1] op_sel_hi:[1,1]
v_pk_mul_f32 v[22:23], v[22:23], v[60:61] op_sel:[0,1] op_sel_hi:[1,1]
v_pk_mul_f32 v[52:53], v[52:53], v[60:61] op_sel:[0,1] op_sel_hi:[1,1]
v_pk_mul_f32 v[54:55], v[54:55], v[60:61] op_sel:[0,1] op_sel_hi:[1,1]
v_cvt_pk_bf16_f32 v20, v20, v21
v_cvt_pk_bf16_f32 v21, v22, v23
v_cvt_pk_bf16_f32 v22, v52, v53
v_cvt_pk_bf16_f32 v23, v54, v55
ds_write_b64 v11, v[20:21] offset:16896
ds_write_b64 v11, v[22:23] offset:25088
v_pk_mul_f32 v[40:41], v[40:41], v[30:31] op_sel:[0,0] op_sel_hi:[1,0]
v_pk_mul_f32 v[42:43], v[42:43], v[30:31] op_sel:[0,0] op_sel_hi:[1,0]
s_add_u32 s53, s82, 65536
buffer_load_dwordx4 a[196:199], v104, s[36:39], s53 offen offset:0 sc1
v_pk_mul_f32 v[72:73], v[72:73], v[30:31] op_sel:[0,0] op_sel_hi:[1,0]
v_pk_mul_f32 v[74:75], v[74:75], v[30:31] op_sel:[0,0] op_sel_hi:[1,0]
v_cvt_pk_bf16_f32 v40, v40, v41
v_cvt_pk_bf16_f32 v41, v42, v43
v_cvt_pk_bf16_f32 v42, v72, v73
v_cvt_pk_bf16_f32 v43, v74, v75
ds_write_b64 v11, v[40:41] offset:1024
ds_write_b64 v11, v[42:43] offset:9216
v_pk_mul_f32 v[24:25], v[24:25], v[62:63] op_sel:[0,0] op_sel_hi:[1,0]
v_pk_mul_f32 v[26:27], v[26:27], v[62:63] op_sel:[0,0] op_sel_hi:[1,0]
v_pk_mul_f32 v[56:57], v[56:57], v[62:63] op_sel:[0,0] op_sel_hi:[1,0]
v_pk_mul_f32 v[58:59], v[58:59], v[62:63] op_sel:[0,0] op_sel_hi:[1,0]
v_cvt_pk_bf16_f32 v24, v24, v25
v_cvt_pk_bf16_f32 v25, v26, v27
v_cvt_pk_bf16_f32 v26, v56, v57
v_cvt_pk_bf16_f32 v27, v58, v59
ds_write_b64 v11, v[24:25] offset:17408
ds_write_b64 v11, v[26:27] offset:25600
buffer_load_dwordx4 a[200:203], v104, s[36:39], s53 offen offset:1024 sc1
v_pk_mul_f32 v[44:45], v[44:45], v[30:31] op_sel:[0,1] op_sel_hi:[1,1]
v_pk_mul_f32 v[46:47], v[46:47], v[30:31] op_sel:[0,1] op_sel_hi:[1,1]
v_pk_mul_f32 v[76:77], v[76:77], v[30:31] op_sel:[0,1] op_sel_hi:[1,1]
v_pk_mul_f32 v[78:79], v[78:79], v[30:31] op_sel:[0,1] op_sel_hi:[1,1]
v_cvt_pk_bf16_f32 v44, v44, v45
v_cvt_pk_bf16_f32 v45, v46, v47
v_cvt_pk_bf16_f32 v46, v76, v77
v_cvt_pk_bf16_f32 v47, v78, v79
ds_write_b64 v11, v[44:45] offset:1536
ds_write_b64 v11, v[46:47] offset:9728
v_pk_mul_f32 v[192:193], v[192:193], v[62:63] op_sel:[0,1] op_sel_hi:[1,1]
v_pk_mul_f32 v[194:195], v[194:195], v[62:63] op_sel:[0,1] op_sel_hi:[1,1]
v_pk_mul_f32 v[196:197], v[196:197], v[62:63] op_sel:[0,1] op_sel_hi:[1,1]
v_pk_mul_f32 v[198:199], v[198:199], v[62:63] op_sel:[0,1] op_sel_hi:[1,1]
v_cvt_pk_bf16_f32 v192, v192, v193
v_cvt_pk_bf16_f32 v193, v194, v195
v_cvt_pk_bf16_f32 v194, v196, v197
v_cvt_pk_bf16_f32 v195, v198, v199
buffer_load_dwordx4 a[204:207], v105, s[36:39], s53 offen offset:0 sc1
ds_write_b64 v11, v[192:193] offset:17920
ds_write_b64 v11, v[194:195] offset:26112
v_and_b32 v9, 7, v15
s_and_b32 s12, s17, 1
s_lshl_b32 s12, s12, 2
v_xor_b32 v9, s12, v9
v_lshl_add_u32 v1, v15, 8, v13
v_lshl_add_u32 v1, v9, 5, v1
v_add_u32 v96, 49152, v1
v_xor_b32 v97, 32, v96
v_xor_b32 v98, 64, v96
v_xor_b32 v99, 96, v96
v_xor_b32 v106, 128, v96
v_xor_b32 v111, 160, v96
v_xor_b32 v1, 192, v96
v_xor_b32 v9, 224, v96
s_waitcnt lgkmcnt(0)
s_barrier
buffer_load_dwordx4 a[208:211], v105, s[36:39], s53 offen offset:1024 sc1
ds_read_b64_tr_b16 a[80:81], v109 offset:0
ds_read_b64_tr_b16 a[82:83], v109 offset:512
ds_read_b64_tr_b16 a[84:85], v108 offset:0
ds_read_b64_tr_b16 a[86:87], v108 offset:512
ds_read_b64_tr_b16 a[88:89], v108 offset:8192
ds_read_b64_tr_b16 a[90:91], v108 offset:8704
ds_read_b64_tr_b16 a[92:93], v109 offset:1024
ds_read_b64_tr_b16 a[94:95], v109 offset:1536
ds_read_b64_tr_b16 a[96:97], v108 offset:1024
ds_read_b64_tr_b16 a[98:99], v108 offset:1536
ds_read_b64_tr_b16 a[100:101], v108 offset:9216
ds_read_b64_tr_b16 a[102:103], v108 offset:9728
s_waitcnt lgkmcnt(6)
v_mfma_f32_16x16x32_bf16 v[48:51], a[80:83], a[84:87], 0
ds_read_b64_tr_b16 a[104:105], v109 offset:2048
s_add_u32 s53, s83, 0
buffer_load_dwordx4 a[212:215], v104, s[36:39], s53 offen offset:0 sc1
ds_read_b64_tr_b16 a[106:107], v109 offset:2560
v_mfma_f32_16x16x32_bf16 v[52:55], a[80:83], a[88:91], 0
ds_read_b64_tr_b16 a[108:109], v108 offset:2048
ds_read_b64_tr_b16 a[110:111], v108 offset:2560
v_mfma_f32_16x16x32_bf16 v[56:59], a[80:83], a[116:119], 0
ds_read_b64_tr_b16 a[112:113], v108 offset:10240
ds_read_b64_tr_b16 a[114:115], v108 offset:10752
s_waitcnt lgkmcnt(6)
v_mfma_f32_16x16x32_bf16 v[48:51], a[92:95], a[96:99], v[48:51]
buffer_load_dwordx4 a[216:219], v104, s[36:39], s53 offen offset:1024 sc1
ds_read_b64_tr_b16 a[80:81], v109 offset:3072
ds_read_b64_tr_b16 a[82:83], v109 offset:3584
v_mfma_f32_16x16x32_bf16 v[52:55], a[92:95], a[100:103], v[52:55]
ds_read_b64_tr_b16 a[84:85], v108 offset:3072
ds_read_b64_tr_b16 a[86:87], v108 offset:3584
v_mfma_f32_16x16x32_bf16 v[56:59], a[92:95], a[116:119], v[56:59]
ds_read_b64_tr_b16 a[88:89], v108 offset:11264
ds_read_b64_tr_b16 a[90:91], v108 offset:11776
s_waitcnt lgkmcnt(6)
v_mfma_f32_16x16x32_bf16 v[48:51], a[104:107], a[108:111], v[48:51]
buffer_load_dwordx4 a[220:223], v105, s[36:39], s53 offen offset:0 sc1
ds_read_b64_tr_b16 a[92:93], v109 offset:4096
ds_read_b64_tr_b16 a[94:95], v109 offset:4608
v_mfma_f32_16x16x32_bf16 v[52:55], a[104:107], a[112:115], v[52:55]
ds_read_b64_tr_b16 a[96:97], v108 offset:4096
ds_read_b64_tr_b16 a[98:99], v108 offset:4608
v_mfma_f32_16x16x32_bf16 v[56:59], a[104:107], a[116:119], v[56:59]
ds_read_b64_tr_b16 a[100:101], v108 offset:12288
ds_read_b64_tr_b16 a[102:103], v108 offset:12800
s_waitcnt lgkmcnt(6)
v_mfma_f32_16x16x32_bf16 v[48:51], a[80:83], a[84:87], v[48:51]
buffer_load_dwordx4 a[224:227], v105, s[36:39], s53 offen offset:1024 sc1
ds_read_b64_tr_b16 a[104:105], v109 offset:5120
ds_read_b64_tr_b16 a[106:107], v109 offset:5632
v_mfma_f32_16x16x32_bf16 v[52:55], a[80:83], a[88:91], v[52:55]
ds_read_b64_tr_b16 a[108:109], v108 offset:5120
ds_read_b64_tr_b16 a[110:111], v108 offset:5632
v_mfma_f32_16x16x32_bf16 v[56:59], a[80:83], a[116:119], v[56:59]
ds_read_b64_tr_b16 a[112:113], v108 offset:13312
ds_read_b64_tr_b16 a[114:115], v108 offset:13824
s_waitcnt lgkmcnt(6)
v_mfma_f32_16x16x32_bf16 v[48:51], a[92:95], a[96:99], v[48:51]
s_add_u32 s53, s83, 65536
buffer_load_dwordx4 a[228:231], v104, s[36:39], s53 offen offset:0 sc1
ds_read_b64_tr_b16 a[80:81], v109 offset:6144
ds_read_b64_tr_b16 a[82:83], v109 offset:6656
v_mfma_f32_16x16x32_bf16 v[52:55], a[92:95], a[100:103], v[52:55]
ds_read_b64_tr_b16 a[84:85], v108 offset:6144
ds_read_b64_tr_b16 a[86:87], v108 offset:6656
v_mfma_f32_16x16x32_bf16 v[56:59], a[92:95], a[116:119], v[56:59]
ds_read_b64_tr_b16 a[88:89], v108 offset:14336
ds_read_b64_tr_b16 a[90:91], v108 offset:14848
s_waitcnt lgkmcnt(6)
v_mfma_f32_16x16x32_bf16 v[48:51], a[104:107], a[108:111], v[48:51]
buffer_load_dwordx4 a[232:235], v104, s[36:39], s53 offen offset:1024 sc1
ds_read_b64_tr_b16 a[92:93], v109 offset:7168
ds_read_b64_tr_b16 a[94:95], v109 offset:7680
v_mfma_f32_16x16x32_bf16 v[52:55], a[104:107], a[112:115], v[52:55]
ds_read_b64_tr_b16 a[96:97], v108 offset:7168
ds_read_b64_tr_b16 a[98:99], v108 offset:7680
v_mfma_f32_16x16x32_bf16 v[56:59], a[104:107], a[116:119], v[56:59]
ds_read_b64_tr_b16 a[100:101], v108 offset:15360
ds_read_b64_tr_b16 a[102:103], v108 offset:15872
s_waitcnt lgkmcnt(6)
v_mfma_f32_16x16x32_bf16 v[48:51], a[80:83], a[84:87], v[48:51]
buffer_load_dwordx4 a[236:239], v105, s[36:39], s53 offen offset:0 sc1
ds_read_b64_tr_b16 a[32:33], v96 offset:0
ds_read_b64_tr_b16 a[34:35], v96 offset:4096
v_mfma_f32_16x16x32_bf16 v[52:55], a[80:83], a[88:91], v[52:55]
ds_read_b64_tr_b16 a[36:37], v96 offset:8192
ds_read_b64_tr_b16 a[38:39], v96 offset:12288
v_mfma_f32_16x16x32_bf16 v[56:59], a[80:83], a[116:119], v[56:59]
ds_read_b64_tr_b16 a[40:41], v97 offset:0
ds_read_b64_tr_b16 a[42:43], v97 offset:4096
s_waitcnt lgkmcnt(6)
buffer_load_dword v11, v102, s[48:51], s97 offen offset:4 sc1
v_mfma_f32_16x16x32_bf16 v[48:51], a[92:95], a[96:99], v[48:51]
buffer_load_dwordx4 a[64:67], v105, s[36:39], s53 offen offset:1024 sc1
ds_read_b64_tr_b16 a[44:45], v97 offset:8192
ds_read_b64_tr_b16 a[46:47], v97 offset:12288
v_mfma_f32_16x16x32_bf16 v[52:55], a[92:95], a[100:103], v[52:55]
v_cmp_eq_u32 s[30:31], 1, v12
s_lshr_b32 s61, s13, 5
v_mfma_f32_16x16x32_bf16 v[56:59], a[92:95], a[116:119], v[56:59]
s_mul_i32 s61, s61, 1152
s_barrier
v_cvt_pk_bf16_f32 v48, v48, v49
v_cvt_pk_bf16_f32 v49, v50, v51
s_nop 0
v_cvt_pk_bf16_f32 v50, v52, v53
v_cvt_pk_bf16_f32 v51, v54, v55
buffer_store_dwordx4 v[48:51], v107, s[44:47], s61 offen sc1
buffer_store_dwordx4 v[56:59], v110, s[44:47], s61 offen offset:1024 sc1
s_waitcnt vmcnt(28) lgkmcnt(4)
v_mfma_f32_16x16x32_bf16 v[128:131], a[32:35], v[80:83], 0
s_add_u32 m0, s91, 0
ds_read_b64_tr_b16 a[48:49], v98 offset:0
v_accvgpr_write_b32 a104, v240
v_accvgpr_write_b32 a105, v241
v_mfma_f32_16x16x32_bf16 v[128:131], a[36:39], a[120:123], v[128:131]
s_add_u32 s55, s93, 786432
v_accvgpr_write_b32 a106, v242
v_accvgpr_write_b32 a107, v243
v_mfma_f32_16x16x32_bf16 v[132:135], a[36:39], a[124:127], 0
s_and_b32 s55, s55, 0x1fffff
ds_read_b64_tr_b16 a[50:51], v98 offset:4096
ds_read_b64_tr_b16 a[52:53], v98 offset:8192
v_mfma_f32_16x16x32_bf16 v[132:135], a[32:35], v[84:87], v[132:135]
v_accvgpr_write_b32 a100, v244
v_accvgpr_write_b32 a101, v245
v_mfma_f32_16x16x32_bf16 v[136:139], a[32:35], v[88:91], 0
ds_read_b64_tr_b16 a[54:55], v98 offset:12288
buffer_load_dwordx4 v6, s[32:35], s55 offen lds
v_accvgpr_write_b32 a102, v246
v_mfma_f32_16x16x32_bf16 v[136:139], a[36:39], a[128:131], v[136:139]
s_add_u32 m0, s91, 1024
v_accvgpr_write_b32 a103, v247
v_accvgpr_write_b32 a96, v248
v_mfma_f32_16x16x32_bf16 v[140:143], a[36:39], a[132:135], 0
v_accvgpr_write_b32 a97, v249
v_accvgpr_write_b32 a98, v250
v_mfma_f32_16x16x32_bf16 v[140:143], a[32:35], v[92:95], v[140:143]
s_waitcnt lgkmcnt(4)
v_accvgpr_write_b32 a99, v251
v_accvgpr_write_b32 a92, v252
v_mfma_f32_16x16x32_bf16 v[156:159], a[40:43], v[92:95], 0
ds_read_b64_tr_b16 a[56:57], v99 offset:0
buffer_load_dwordx4 v7, s[32:35], s55 offen lds
v_accvgpr_write_b32 a93, v253
v_mfma_f32_16x16x32_bf16 v[156:159], a[44:47], a[132:135], v[156:159]
s_add_u32 m0, s91, 8192
v_accvgpr_write_b32 a94, v254
v_accvgpr_write_b32 a95, v255
v_mfma_f32_16x16x32_bf16 v[152:155], a[44:47], a[128:131], 0
s_add_u32 s55, s93, 917504
ds_read_b64_tr_b16 a[58:59], v99 offset:4096
ds_read_b64_tr_b16 a[60:61], v99 offset:8192
v_mfma_f32_16x16x32_bf16 v[152:155], a[40:43], v[88:91], v[152:155]
s_and_b32 s55, s55, 0x1fffff
v_accvgpr_write_b32 a184, v112
v_accvgpr_write_b32 a185, v113
v_mfma_f32_16x16x32_bf16 v[148:151], a[40:43], v[84:87], 0
ds_read_b64_tr_b16 a[62:63], v99 offset:12288
buffer_load_dwordx4 v6, s[32:35], s55 offen lds
v_accvgpr_write_b32 a186, v114
v_mfma_f32_16x16x32_bf16 v[148:151], a[44:47], a[124:127], v[148:151]
s_add_u32 m0, s91, 9216
v_accvgpr_write_b32 a187, v115
v_accvgpr_write_b32 a116, v116
v_mfma_f32_16x16x32_bf16 v[144:147], a[44:47], a[120:123], 0
v_accvgpr_write_b32 a117, v117
v_accvgpr_write_b32 a118, v118
v_mfma_f32_16x16x32_bf16 v[144:147], a[40:43], v[80:83], v[144:147]
s_waitcnt lgkmcnt(4)
v_accvgpr_write_b32 a119, v119
v_accvgpr_write_b32 a112, v120
v_mfma_f32_16x16x32_bf16 v[160:163], a[48:51], v[80:83], 0
ds_read_b64_tr_b16 a[32:33], v106 offset:0
buffer_load_dwordx4 v7, s[32:35], s55 offen lds
v_accvgpr_write_b32 a113, v121
v_mfma_f32_16x16x32_bf16 v[160:163], a[52:55], a[120:123], v[160:163]
s_add_u32 m0, s91, 16384
v_accvgpr_write_b32 a114, v122
v_accvgpr_write_b32 a115, v123
v_mfma_f32_16x16x32_bf16 v[164:167], a[52:55], a[124:127], 0
s_add_u32 s55, s93, 1048576
ds_read_b64_tr_b16 a[34:35], v106 offset:4096
ds_read_b64_tr_b16 a[36:37], v106 offset:8192
v_mfma_f32_16x16x32_bf16 v[164:167], a[48:51], v[84:87], v[164:167]
s_and_b32 s55, s55, 0x1fffff
v_accvgpr_write_b32 a108, v124
v_accvgpr_write_b32 a109, v125
v_mfma_f32_16x16x32_bf16 v[168:171], a[48:51], v[88:91], 0
ds_read_b64_tr_b16 a[38:39], v106 offset:12288
buffer_load_dwordx4 v6, s[32:35], s55 offen lds
v_accvgpr_write_b32 a110, v126
v_mfma_f32_16x16x32_bf16 v[168:171], a[52:55], a[128:131], v[168:171]
s_add_u32 m0, s91, 17408
v_accvgpr_write_b32 a111, v127
v_accvgpr_read_b32 v16, a0
v_mfma_f32_16x16x32_bf16 v[172:175], a[52:55], a[132:135], 0
v_accvgpr_read_b32 v17, a1
v_accvgpr_read_b32 v18, a2
v_mfma_f32_16x16x32_bf16 v[172:175], a[48:51], v[92:95], v[172:175]
s_waitcnt lgkmcnt(4)
v_accvgpr_read_b32 v19, a3
v_accvgpr_read_b32 v20, a4
v_mfma_f32_16x16x32_bf16 v[188:191], a[56:59], v[92:95], 0
ds_read_b64_tr_b16 a[40:41], v111 offset:0
buffer_load_dwordx4 v7, s[32:35], s55 offen lds
v_accvgpr_read_b32 v21, a5
v_mfma_f32_16x16x32_bf16 v[188:191], a[60:63], a[132:135], v[188:191]
v_accvgpr_read_b32 v22, a6
v_accvgpr_read_b32 v23, a7
v_mfma_f32_16x16x32_bf16 v[184:187], a[60:63], a[128:131], 0
s_add_u32 m0, s91, 24576
ds_read_b64_tr_b16 a[42:43], v111 offset:4096
ds_read_b64_tr_b16 a[44:45], v111 offset:8192
v_mfma_f32_16x16x32_bf16 v[184:187], a[56:59], v[88:91], v[184:187]
s_add_u32 s55, s93, 1179648
v_accvgpr_read_b32 v24, a8
v_accvgpr_read_b32 v25, a9
v_mfma_f32_16x16x32_bf16 v[180:183], a[56:59], v[84:87], 0
s_and_b32 s55, s55, 0x1fffff
ds_read_b64_tr_b16 a[46:47], v111 offset:12288
buffer_load_dwordx4 v6, s[32:35], s55 offen lds
v_accvgpr_read_b32 v26, a10
v_mfma_f32_16x16x32_bf16 v[180:183], a[60:63], a[124:127], v[180:183]
v_accvgpr_read_b32 v27, a11
v_accvgpr_read_b32 v28, a12
v_mfma_f32_16x16x32_bf16 v[176:179], a[60:63], a[120:123], 0
s_add_u32 m0, s91, 25600
v_accvgpr_read_b32 v29, a13
v_accvgpr_read_b32 v30, a14
v_mfma_f32_16x16x32_bf16 v[176:179], a[56:59], v[80:83], v[176:179]
s_waitcnt lgkmcnt(4)
v_accvgpr_read_b32 v31, a15
v_accvgpr_read_b32 v32, a16
v_mfma_f32_16x16x32_bf16 v[192:195], a[32:35], v[80:83], 0
ds_read_b64_tr_b16 a[48:49], v1 offset:0
buffer_load_dwordx4 v7, s[32:35], s55 offen lds
v_accvgpr_read_b32 v33, a17
v_mfma_f32_16x16x32_bf16 v[192:195], a[36:39], a[120:123], v[192:195]
v_accvgpr_read_b32 v34, a18
v_accvgpr_read_b32 v35, a19
v_mfma_f32_16x16x32_bf16 v[196:199], a[36:39], a[124:127], 0
ds_read_b64_tr_b16 a[50:51], v1 offset:4096
ds_read_b64_tr_b16 a[52:53], v1 offset:8192
v_mfma_f32_16x16x32_bf16 v[196:199], a[32:35], v[84:87], v[196:199]
s_add_u32 m0, s91, 114688
v_accvgpr_read_b32 v36, a20
v_accvgpr_read_b32 v37, a21
v_mfma_f32_16x16x32_bf16 v[200:203], a[32:35], v[88:91], 0
s_add_u32 s55, s93, 1310720
ds_read_b64_tr_b16 a[54:55], v1 offset:12288
v_accvgpr_read_b32 v38, a22
v_accvgpr_read_b32 v39, a23
v_mfma_f32_16x16x32_bf16 v[200:203], a[36:39], a[128:131], v[200:203]
s_and_b32 s55, s55, 0x1fffff
v_accvgpr_read_b32 v40, a24
v_accvgpr_read_b32 v41, a25
v_mfma_f32_16x16x32_bf16 v[204:207], a[36:39], a[132:135], 0
v_accvgpr_read_b32 v42, a26
v_accvgpr_read_b32 v43, a27
v_mfma_f32_16x16x32_bf16 v[204:207], a[32:35], v[92:95], v[204:207]
s_waitcnt lgkmcnt(4)
v_accvgpr_read_b32 v44, a28
v_accvgpr_read_b32 v45, a29
v_mfma_f32_16x16x32_bf16 v[220:223], a[40:43], v[92:95], 0
ds_read_b64_tr_b16 a[56:57], v9 offset:0
buffer_load_dwordx4 v6, s[32:35], s55 offen lds
v_accvgpr_read_b32 v46, a30
v_mfma_f32_16x16x32_bf16 v[220:223], a[44:47], a[132:135], v[220:223]
s_add_u32 m0, s91, 115712
v_accvgpr_read_b32 v47, a31
v_cvt_pk_bf16_f32 v16, v16, v17
v_mfma_f32_16x16x32_bf16 v[216:219], a[44:47], a[128:131], 0
ds_read_b64_tr_b16 a[58:59], v9 offset:4096
ds_read_b64_tr_b16 a[60:61], v9 offset:8192
v_mfma_f32_16x16x32_bf16 v[216:219], a[40:43], v[88:91], v[216:219]
v_cvt_pk_bf16_f32 v17, v18, v19
v_cvt_pk_bf16_f32 v18, v32, v33
v_mfma_f32_16x16x32_bf16 v[212:215], a[40:43], v[84:87], 0
ds_read_b64_tr_b16 a[62:63], v9 offset:12288
buffer_load_dwordx4 v7, s[32:35], s55 offen lds
v_cvt_pk_bf16_f32 v19, v34, v35
v_mfma_f32_16x16x32_bf16 v[212:215], a[44:47], a[124:127], v[212:215]
v_cvt_pk_bf16_f32 v20, v20, v21
v_cvt_pk_bf16_f32 v21, v22, v23
v_mfma_f32_16x16x32_bf16 v[208:211], a[44:47], a[120:123], 0
v_cvt_pk_bf16_f32 v22, v36, v37
v_cvt_pk_bf16_f32 v23, v38, v39
v_mfma_f32_16x16x32_bf16 v[208:211], a[40:43], v[80:83], v[208:211]
s_waitcnt lgkmcnt(4)
v_cvt_pk_bf16_f32 v24, v24, v25
v_cvt_pk_bf16_f32 v25, v26, v27
v_mfma_f32_16x16x32_bf16 v[224:227], a[48:51], v[80:83], 0
v_cvt_pk_bf16_f32 v26, v40, v41
v_cvt_pk_bf16_f32 v27, v42, v43
v_cvt_pk_bf16_f32 v28, v28, v29
v_mfma_f32_16x16x32_bf16 v[224:227], a[52:55], a[120:123], v[224:227]
v_cvt_pk_bf16_f32 v29, v30, v31
v_cvt_pk_bf16_f32 v30, v44, v45
v_mfma_f32_16x16x32_bf16 v[228:231], a[52:55], a[124:127], 0
s_waitcnt vmcnt(10)
buffer_store_dword v100, v101, s[48:51], s68 offen offset:0 sc1
v_cvt_pk_bf16_f32 v31, v46, v47
v_mfma_f32_16x16x32_bf16 v[32:35], a[176:179], v[16:19], 0
v_cmp_ne_u32 vcc, s9, v11
s_mov_b32 s16, 0
s_nop 0
s_cbranch_vccz L_ph1_ok
L_ph1:
buffer_load_dword v11, v102, s[48:51], s97 offen offset:4 sc1
s_waitcnt vmcnt(0)
v_cmp_ne_u32 vcc, s9, v11
s_add_u32 s16, s16, 1
s_nop 0
s_cbranch_vccz L_ph1_ok
s_cmp_lt_u32 s16, 0x100000
s_cbranch_scc1 L_ph1
L_ph1_ok:
v_mfma_f32_16x16x32_bf16 v[64:67], a[180:183], v[16:19], 0
v_mfma_f32_16x16x32_bf16 v[36:39], a[176:179], v[20:23], 0
v_mfma_f32_16x16x32_bf16 v[68:71], a[180:183], v[20:23], 0
v_mfma_f32_16x16x32_bf16 v[40:43], a[176:179], v[24:27], 0
v_mfma_f32_16x16x32_bf16 v[72:75], a[180:183], v[24:27], 0
v_mfma_f32_16x16x32_bf16 v[44:47], a[176:179], v[28:31], 0
v_mfma_f32_16x16x32_bf16 v[76:79], a[180:183], v[28:31], 0
v_and_b32 v12, 15, v0
v_lshrrev_b32 v13, 4, v0
v_mfma_f32_16x16x32_bf16 v[228:231], a[48:51], v[84:87], v[228:231]
s_waitcnt lgkmcnt(0)
s_barrier
v_lshlrev_b32 v13, 2, v13
v_mfma_f32_16x16x32_bf16 v[232:235], a[48:51], v[88:91], 0
s_add_u32 s53, s8, 16384
ds_read_b64_tr_b16 a[32:33], v96 offset:16384
buffer_load_dwordx4 a[68:71], v104, s[36:39], s53 offen offset:0 sc1
v_sub_u32 v12, v12, v13
v_mfma_f32_16x16x32_bf16 v[232:235], a[52:55], a[128:131], v[232:235]
s_add_u32 m0, s90, 49152
ds_read_b64_tr_b16 a[34:35], v96 offset:20480
ds_read_b64_tr_b16 a[36:37], v96 offset:24576
v_mfma_f32_16x16x32_bf16 v[236:239], a[52:55], a[132:135], 0
s_add_u32 s54, s84, 65536
ds_read_b64_tr_b16 a[38:39], v96 offset:28672
v_cmp_gt_u32 s[0:1], 4, v12
v_mfma_f32_16x16x32_bf16 v[236:239], a[48:51], v[92:95], v[236:239]
v_lshlrev_b32 v12, 4, v12
v_mov_b32 v14, 0x3f80
v_mfma_f32_16x16x32_bf16 v[252:255], a[56:59], v[92:95], 0
ds_read_b64_tr_b16 a[40:41], v97 offset:16384
buffer_load_dwordx4 v2, s[72:75], s54 offen lds
v_mov_b32 v15, 0
v_mfma_f32_16x16x32_bf16 v[252:255], a[60:63], a[132:135], v[252:255]
s_add_u32 m0, s90, 50176
v_cndmask_b32 v14, 0, v14, s[0:1]
v_lshlrev_b64 v[14:15], v12, v[14:15]
v_mfma_f32_16x16x32_bf16 v[248:251], a[60:63], a[128:131], 0
ds_read_b64_tr_b16 a[42:43], v97 offset:20480
ds_read_b64_tr_b16 a[44:45], v97 offset:24576
v_mfma_f32_16x16x32_bf16 v[248:251], a[56:59], v[88:91], v[248:251]
v_accvgpr_write_b32 a176, 0
v_accvgpr_write_b32 a177, 0
v_mfma_f32_16x16x32_bf16 v[244:247], a[56:59], v[84:87], 0
ds_read_b64_tr_b16 a[46:47], v97 offset:28672
buffer_load_dwordx4 v3, s[72:75], s54 offen lds
v_accvgpr_write_b32 a178, v14
v_mfma_f32_16x16x32_bf16 v[244:247], a[60:63], a[124:127], v[244:247]
s_add_u32 m0, s90, 51200
v_accvgpr_write_b32 a179, v15
v_accvgpr_write_b32 a180, 0
v_mfma_f32_16x16x32_bf16 v[240:243], a[60:63], a[120:123], 0
v_accvgpr_write_b32 a181, 0
v_mfma_f32_16x16x32_bf16 v[240:243], a[56:59], v[80:83], v[240:243]
s_waitcnt lgkmcnt(4)
buffer_load_dwordx4 v4, s[72:75], s54 offen lds
v_and_b32 v82, 7, v0
v_mfma_f32_16x16x32_bf16 v[128:131], a[32:35], a[136:139], v[128:131]
ds_read_b64_tr_b16 a[48:49], v98 offset:16384
v_mul_u32_u24 v82, 1152, v82
v_add_u32 v82, v82, v110
v_mfma_f32_16x16x32_bf16 v[128:131], a[36:39], a[152:155], v[128:131]
s_add_u32 m0, s90, 52224
s_lshl_b32 s62, s18, 19
v_add_u32 v83, s62, v104
v_mfma_f32_16x16x32_bf16 v[132:135], a[36:39], a[156:159], v[132:135]
ds_read_b64_tr_b16 a[50:51], v98 offset:20480
ds_read_b64_tr_b16 a[52:53], v98 offset:24576
v_mfma_f32_16x16x32_bf16 v[132:135], a[32:35], a[140:143], v[132:135]
v_add_u32 v80, 122880, v107
v_mov_b32 v120, 0x3f803f80
v_mfma_f32_16x16x32_bf16 v[136:139], a[32:35], a[144:147], v[136:139]
s_lshl_b32 s62, s66, 3
ds_read_b64_tr_b16 a[54:55], v98 offset:28672
buffer_load_dwordx4 v5, s[72:75], s54 offen lds
v_add_u32 v81, s62, v80
v_mfma_f32_16x16x32_bf16 v[136:139], a[36:39], a[160:163], v[136:139]
s_lshr_b32 s62, s3, 1
s_mul_i32 s62, s62, 3072
L_pad5:
s_cbranch_execz L_pad9
v_add_u32 v81, s62, v81
v_mfma_f32_16x16x32_bf16 v[140:143], a[36:39], a[164:167], v[140:143]
v_cvt_pk_bf16_f32 v33, v32, v33
v_lshlrev_b32 v32, 16, v33
v_mfma_f32_16x16x32_bf16 v[140:143], a[32:35], a[148:151], v[140:143]
s_waitcnt lgkmcnt(4)
v_and_b32 v33, 0xffff0000, v33
v_cvt_pk_bf16_f32 v35, v34, v35
v_mfma_f32_16x16x32_bf16 v[156:159], a[40:43], a[148:151], v[156:159]
ds_read_b64_tr_b16 a[56:57], v99 offset:16384
buffer_load_dwordx4 a[72:75], v104, s[36:39], s53 offen offset:1024 sc1
v_lshlrev_b32 v34, 16, v35
v_mfma_f32_16x16x32_bf16 v[156:159], a[44:47], a[164:167], v[156:159]
v_and_b32 v35, 0xffff0000, v35
v_cvt_pk_bf16_f32 v65, v64, v65
v_mfma_f32_16x16x32_bf16 v[152:155], a[44:47], a[160:163], v[152:155]
ds_read_b64_tr_b16 a[58:59], v99 offset:20480
ds_read_b64_tr_b16 a[60:61], v99 offset:24576
v_mfma_f32_16x16x32_bf16 v[152:155], a[40:43], a[144:147], v[152:155]
v_lshlrev_b32 v64, 16, v65
v_and_b32 v65, 0xffff0000, v65
v_mfma_f32_16x16x32_bf16 v[148:151], a[40:43], a[140:143], v[148:151]
ds_read_b64_tr_b16 a[62:63], v99 offset:28672
buffer_load_dwordx4 a[76:79], v105, s[36:39], s53 offen offset:0 sc1
v_cvt_pk_bf16_f32 v67, v66, v67
v_mfma_f32_16x16x32_bf16 v[148:151], a[44:47], a[156:159], v[148:151]
v_lshlrev_b32 v66, 16, v67
v_and_b32 v67, 0xffff0000, v67
v_mfma_f32_16x16x32_bf16 v[144:147], a[44:47], a[152:155], v[144:147]
v_max3_f32 v112, v32, v33, v34
v_max3_f32 v112, v112, v35, v64
v_mfma_f32_16x16x32_bf16 v[144:147], a[40:43], a[136:139], v[144:147]
s_waitcnt lgkmcnt(4)
v_max3_f32 v112, v112, v65, v66
v_max_f32 v112, v112, v67
v_mfma_f32_16x16x32_bf16 v[160:163], a[48:51], a[136:139], v[160:163]
ds_read_b64_tr_b16 a[32:33], v106 offset:16384
buffer_load_dwordx4 a[80:83], v105, s[36:39], s53 offen offset:1024 sc1
v_min3_f32 v116, v32, v33, v34
v_mfma_f32_16x16x32_bf16 v[160:163], a[52:55], a[152:155], v[160:163]
v_min3_f32 v116, v116, v35, v64
v_min3_f32 v116, v116, v65, v66
v_mfma_f32_16x16x32_bf16 v[164:167], a[52:55], a[156:159], v[164:167]
ds_read_b64_tr_b16 a[34:35], v106 offset:20480
ds_read_b64_tr_b16 a[36:37], v106 offset:24576
v_mfma_f32_16x16x32_bf16 v[164:167], a[48:51], a[140:143], v[164:167]
s_add_u32 s53, s81, 16384
v_min_f32 v116, v116, v67
v_cvt_pk_bf16_f32 v37, v36, v37
v_mfma_f32_16x16x32_bf16 v[168:171], a[48:51], a[144:147], v[168:171]
ds_read_b64_tr_b16 a[38:39], v106 offset:28672
v_lshlrev_b32 v36, 16, v37
v_and_b32 v37, 0xffff0000, v37
v_mfma_f32_16x16x32_bf16 v[168:171], a[52:55], a[160:163], v[168:171]
v_cvt_pk_bf16_f32 v39, v38, v39
v_lshlrev_b32 v38, 16, v39
v_mfma_f32_16x16x32_bf16 v[172:175], a[52:55], a[164:167], v[172:175]
v_and_b32 v39, 0xffff0000, v39
v_cvt_pk_bf16_f32 v69, v68, v69
v_mfma_f32_16x16x32_bf16 v[172:175], a[48:51], a[148:151], v[172:175]
s_waitcnt lgkmcnt(4)
v_lshlrev_b32 v68, 16, v69
v_and_b32 v69, 0xffff0000, v69
v_mfma_f32_16x16x32_bf16 v[188:191], a[56:59], a[148:151], v[188:191]
ds_read_b64_tr_b16 a[40:41], v111 offset:16384
buffer_load_dwordx4 a[84:87], v104, s[36:39], s53 offen offset:0 sc1
v_cvt_pk_bf16_f32 v71, v70, v71
v_mfma_f32_16x16x32_bf16 v[188:191], a[60:63], a[164:167], v[188:191]
v_lshlrev_b32 v70, 16, v71
v_and_b32 v71, 0xffff0000, v71
v_mfma_f32_16x16x32_bf16 v[184:187], a[60:63], a[160:163], v[184:187]
ds_read_b64_tr_b16 a[42:43], v111 offset:20480
ds_read_b64_tr_b16 a[44:45], v111 offset:24576
v_mfma_f32_16x16x32_bf16 v[184:187], a[56:59], a[144:147], v[184:187]
v_max3_f32 v113, v36, v37, v38
v_max3_f32 v113, v113, v39, v68
v_mfma_f32_16x16x32_bf16 v[180:183], a[56:59], a[140:143], v[180:183]
ds_read_b64_tr_b16 a[46:47], v111 offset:28672
buffer_load_dwordx4 a[88:91], v104, s[36:39], s53 offen offset:1024 sc1
v_max3_f32 v113, v113, v69, v70
v_mfma_f32_16x16x32_bf16 v[180:183], a[60:63], a[156:159], v[180:183]
v_max_f32 v113, v113, v71
v_min3_f32 v117, v36, v37, v38
v_mfma_f32_16x16x32_bf16 v[176:179], a[60:63], a[152:155], v[176:179]
v_min3_f32 v117, v117, v39, v68
v_min3_f32 v117, v117, v69, v70
v_mfma_f32_16x16x32_bf16 v[176:179], a[56:59], a[136:139], v[176:179]
s_waitcnt lgkmcnt(4)
v_min_f32 v117, v117, v71
v_cvt_pk_bf16_f32 v41, v40, v41
v_mfma_f32_16x16x32_bf16 v[192:195], a[32:35], a[136:139], v[192:195]
ds_read_b64_tr_b16 a[48:49], v1 offset:16384
buffer_load_dwordx4 a[120:123], v105, s[36:39], s53 offen offset:0 sc1
v_lshlrev_b32 v40, 16, v41
v_mfma_f32_16x16x32_bf16 v[192:195], a[36:39], a[152:155], v[192:195]
v_and_b32 v41, 0xffff0000, v41
v_cvt_pk_bf16_f32 v43, v42, v43
v_mfma_f32_16x16x32_bf16 v[196:199], a[36:39], a[156:159], v[196:199]
ds_read_b64_tr_b16 a[50:51], v1 offset:20480
ds_read_b64_tr_b16 a[52:53], v1 offset:24576
v_mfma_f32_16x16x32_bf16 v[196:199], a[32:35], a[140:143], v[196:199]
v_lshlrev_b32 v42, 16, v43
v_and_b32 v43, 0xffff0000, v43
v_mfma_f32_16x16x32_bf16 v[200:203], a[32:35], a[144:147], v[200:203]
ds_read_b64_tr_b16 a[54:55], v1 offset:28672
buffer_load_dwordx4 a[124:127], v105, s[36:39], s53 offen offset:1024 sc1
v_cvt_pk_bf16_f32 v73, v72, v73
v_mfma_f32_16x16x32_bf16 v[200:203], a[36:39], a[160:163], v[200:203]
s_add_u32 s53, s81, 81920
v_lshlrev_b32 v72, 16, v73
v_and_b32 v73, 0xffff0000, v73
v_mfma_f32_16x16x32_bf16 v[204:207], a[36:39], a[164:167], v[204:207]
v_cvt_pk_bf16_f32 v75, v74, v75
v_lshlrev_b32 v74, 16, v75
v_mfma_f32_16x16x32_bf16 v[204:207], a[32:35], a[148:151], v[204:207]
s_waitcnt lgkmcnt(4)
v_and_b32 v75, 0xffff0000, v75
v_max3_f32 v114, v40, v41, v42
v_mfma_f32_16x16x32_bf16 v[220:223], a[40:43], a[148:151], v[220:223]
ds_read_b64_tr_b16 a[56:57], v9 offset:16384
buffer_load_dwordx4 a[128:131], v104, s[36:39], s53 offen offset:0 sc1
v_max3_f32 v114, v114, v43, v72
v_mfma_f32_16x16x32_bf16 v[220:223], a[44:47], a[164:167], v[220:223]
v_max3_f32 v114, v114, v73, v74
v_max_f32 v114, v114, v75
v_mfma_f32_16x16x32_bf16 v[216:219], a[44:47], a[160:163], v[216:219]
ds_read_b64_tr_b16 a[58:59], v9 offset:20480
ds_read_b64_tr_b16 a[60:61], v9 offset:24576
v_mfma_f32_16x16x32_bf16 v[216:219], a[40:43], a[144:147], v[216:219]
v_min3_f32 v118, v40, v41, v42
v_min3_f32 v118, v118, v43, v72
v_mfma_f32_16x16x32_bf16 v[212:215], a[40:43], a[140:143], v[212:215]
ds_read_b64_tr_b16 a[62:63], v9 offset:28672
buffer_load_dwordx4 a[132:135], v104, s[36:39], s53 offen offset:1024 sc1
v_min3_f32 v118, v118, v73, v74
v_mfma_f32_16x16x32_bf16 v[212:215], a[44:47], a[156:159], v[212:215]
v_min_f32 v118, v118, v75
v_cvt_pk_bf16_f32 v45, v44, v45
v_mfma_f32_16x16x32_bf16 v[208:211], a[44:47], a[152:155], v[208:211]
v_lshlrev_b32 v44, 16, v45
v_and_b32 v45, 0xffff0000, v45
v_mfma_f32_16x16x32_bf16 v[208:211], a[40:43], a[136:139], v[208:211]
s_waitcnt lgkmcnt(4)
v_cvt_pk_bf16_f32 v47, v46, v47
v_lshlrev_b32 v46, 16, v47
v_mfma_f32_16x16x32_bf16 v[224:227], a[48:51], a[136:139], v[224:227]
v_and_b32 v47, 0xffff0000, v47
v_cvt_pk_bf16_f32 v77, v76, v77
v_lshlrev_b32 v76, 16, v77
v_mfma_f32_16x16x32_bf16 v[224:227], a[52:55], a[152:155], v[224:227]
v_and_b32 v77, 0xffff0000, v77
v_cvt_pk_bf16_f32 v79, v78, v79
v_mfma_f32_16x16x32_bf16 v[228:231], a[52:55], a[156:159], v[228:231]
v_lshlrev_b32 v78, 16, v79
v_and_b32 v79, 0xffff0000, v79
v_mfma_f32_16x16x32_bf16 v[228:231], a[48:51], a[140:143], v[228:231]
s_waitcnt lgkmcnt(0)
s_barrier
v_max3_f32 v115, v44, v45, v46
v_mfma_f32_16x16x32_bf16 v[232:235], a[48:51], a[144:147], v[232:235]
s_add_u32 m0, s90, 65536
ds_read_b64_tr_b16 a[32:33], v96 offset:32768
v_max3_f32 v115, v115, v47, v76
v_max3_f32 v115, v115, v77, v78
v_mfma_f32_16x16x32_bf16 v[232:235], a[52:55], a[160:163], v[232:235]
s_add_u32 s54, s85, 65536
ds_read_b64_tr_b16 a[34:35], v96 offset:36864
ds_read_b64_tr_b16 a[36:37], v96 offset:40960
v_mfma_f32_16x16x32_bf16 v[236:239], a[52:55], a[164:167], v[236:239]
ds_read_b64_tr_b16 a[38:39], v96 offset:45056
v_max_f32 v115, v115, v79
v_mfma_f32_16x16x32_bf16 v[236:239], a[48:51], a[148:151], v[236:239]
v_min3_f32 v119, v44, v45, v46
v_min3_f32 v119, v119, v47, v76
v_mfma_f32_16x16x32_bf16 v[252:255], a[56:59], a[148:151], v[252:255]
ds_read_b64_tr_b16 a[40:41], v97 offset:32768
buffer_load_dwordx4 v2, s[72:75], s54 offen lds
v_min3_f32 v119, v119, v77, v78
v_mfma_f32_16x16x32_bf16 v[252:255], a[60:63], a[164:167], v[252:255]
s_add_u32 m0, s90, 66560
v_min_f32 v119, v119, v79
v_mfma_f32_16x16x32_bf16 v[248:251], a[60:63], a[160:163], v[248:251]
ds_read_b64_tr_b16 a[42:43], v97 offset:36864
ds_read_b64_tr_b16 a[44:45], v97 offset:40960
v_mfma_f32_16x16x32_bf16 v[248:251], a[56:59], a[144:147], v[248:251]
buffer_load_dword v103, v102, s[48:51], s99 offen offset:0 sc1
v_mfma_f32_16x16x32_bf16 v[244:247], a[56:59], a[140:143], v[244:247]
ds_read_b64_tr_b16 a[46:47], v97 offset:45056
v_permlane16_swap_b32 v112, v113
v_mfma_f32_16x16x32_bf16 v[244:247], a[60:63], a[156:159], v[244:247]
v_permlane16_swap_b32 v116, v117
v_mfma_f32_16x16x32_bf16 v[240:243], a[60:63], a[152:155], v[240:243]
v_permlane16_swap_b32 v114, v115
v_mfma_f32_16x16x32_bf16 v[240:243], a[56:59], a[136:139], v[240:243]
s_waitcnt lgkmcnt(4)
v_permlane16_swap_b32 v118, v119
v_mfma_f32_16x16x32_bf16 v[128:131], a[32:35], a[168:171], v[128:131]
ds_read_b64_tr_b16 a[48:49], v98 offset:32768
buffer_load_dwordx4 v3, s[72:75], s54 offen lds
v_max_f32 v112, v112, v113
v_mfma_f32_16x16x32_bf16 v[128:131], a[36:39], a[196:199], v[128:131]
s_add_u32 m0, s90, 67584
v_min_f32 v116, v116, v117
v_max_f32 v114, v114, v115
v_mfma_f32_16x16x32_bf16 v[132:135], a[36:39], a[200:203], v[132:135]
ds_read_b64_tr_b16 a[50:51], v98 offset:36864
ds_read_b64_tr_b16 a[52:53], v98 offset:40960
v_mfma_f32_16x16x32_bf16 v[132:135], a[32:35], a[172:175], v[132:135]
v_min_f32 v118, v118, v119
v_mfma_f32_16x16x32_bf16 v[136:139], a[32:35], a[188:191], v[136:139]
ds_read_b64_tr_b16 a[54:55], v98 offset:45056
buffer_load_dwordx4 v4, s[72:75], s54 offen lds
v_mfma_f32_16x16x32_bf16 v[136:139], a[36:39], a[204:207], v[136:139]
s_add_u32 m0, s90, 68608
v_permlane32_swap_b32 v112, v114
v_mfma_f32_16x16x32_bf16 v[140:143], a[36:39], a[208:211], v[140:143]
v_permlane32_swap_b32 v116, v118
v_mfma_f32_16x16x32_bf16 v[140:143], a[32:35], a[192:195], v[140:143]
s_waitcnt lgkmcnt(4)
v_max_f32 v112, v112, v114
v_min_f32 v116, v116, v118
v_mfma_f32_16x16x32_bf16 v[156:159], a[40:43], a[192:195], v[156:159]
ds_read_b64_tr_b16 a[56:57], v99 offset:32768
buffer_load_dwordx4 v5, s[72:75], s54 offen lds
v_mul_f32 v112, s26, v112
v_mfma_f32_16x16x32_bf16 v[156:159], a[44:47], a[208:211], v[156:159]
v_mul_f32 v116, s28, v116
v_mov_b32 v114, v112
v_mfma_f32_16x16x32_bf16 v[152:155], a[44:47], a[204:207], v[152:155]
ds_read_b64_tr_b16 a[58:59], v99 offset:36864
ds_read_b64_tr_b16 a[60:61], v99 offset:40960
v_mfma_f32_16x16x32_bf16 v[152:155], a[40:43], a[188:191], v[152:155]
v_mov_b32 v118, v116
v_mfma_f32_16x16x32_bf16 v[148:151], a[40:43], a[172:175], v[148:151]
ds_read_b64_tr_b16 a[62:63], v99 offset:45056
buffer_load_dwordx4 a[136:139], v105, s[36:39], s53 offen offset:0 sc1
v_mfma_f32_16x16x32_bf16 v[148:151], a[44:47], a[200:203], v[148:151]
v_permlane32_swap_b32 v112, v114
v_mfma_f32_16x16x32_bf16 v[144:147], a[44:47], a[196:199], v[144:147]
v_permlane32_swap_b32 v116, v118
v_mfma_f32_16x16x32_bf16 v[144:147], a[40:43], a[168:171], v[144:147]
s_waitcnt lgkmcnt(4)
v_mov_b32 v113, v112
v_mov_b32 v117, v116
v_mfma_f32_16x16x32_bf16 v[160:163], a[48:51], a[168:171], v[160:163]
ds_read_b64_tr_b16 a[32:33], v106 offset:32768
buffer_load_dwordx4 a[140:143], v105, s[36:39], s53 offen offset:1024 sc1
v_mov_b32 v115, v114
v_mfma_f32_16x16x32_bf16 v[160:163], a[52:55], a[196:199], v[160:163]
v_mov_b32 v119, v118
v_mfma_f32_16x16x32_bf16 v[164:167], a[52:55], a[200:203], v[164:167]
s_add_u32 s53, s82, 16384
ds_read_b64_tr_b16 a[34:35], v106 offset:36864
ds_read_b64_tr_b16 a[36:37], v106 offset:40960
v_mfma_f32_16x16x32_bf16 v[164:167], a[48:51], a[172:175], v[164:167]
v_permlane16_swap_b32 v112, v113
v_mfma_f32_16x16x32_bf16 v[168:171], a[48:51], a[188:191], v[168:171]
ds_read_b64_tr_b16 a[38:39], v106 offset:45056
buffer_load_dwordx4 a[144:147], v104, s[36:39], s53 offen offset:0 sc1
v_mfma_f32_16x16x32_bf16 v[168:171], a[52:55], a[204:207], v[168:171]
v_permlane16_swap_b32 v116, v117
v_mfma_f32_16x16x32_bf16 v[172:175], a[52:55], a[208:211], v[172:175]
v_permlane16_swap_b32 v114, v115
v_mfma_f32_16x16x32_bf16 v[172:175], a[48:51], a[192:195], v[172:175]
s_waitcnt lgkmcnt(4)
v_permlane16_swap_b32 v118, v119
v_mfma_f32_16x16x32_bf16 v[188:191], a[56:59], a[192:195], v[188:191]
ds_read_b64_tr_b16 a[40:41], v111 offset:32768
v_fma_f32 v16, v32, s26, v116
v_fma_f32 v17, v33, s26, v116
v_mfma_f32_16x16x32_bf16 v[188:191], a[60:63], a[208:211], v[188:191]
v_fma_f32 v18, v34, s26, v116
v_fma_f32 v19, v35, s26, v116
v_mfma_f32_16x16x32_bf16 v[184:187], a[60:63], a[204:207], v[184:187]
ds_read_b64_tr_b16 a[42:43], v111 offset:36864
ds_read_b64_tr_b16 a[44:45], v111 offset:40960
v_mfma_f32_16x16x32_bf16 v[184:187], a[56:59], a[188:191], v[184:187]
v_fma_f32 v20, v64, s26, v116
v_fma_f32 v21, v65, s26, v116
v_mfma_f32_16x16x32_bf16 v[180:183], a[56:59], a[172:175], v[180:183]
ds_read_b64_tr_b16 a[46:47], v111 offset:45056
buffer_load_dwordx4 a[148:151], v104, s[36:39], s53 offen offset:1024 sc1
v_fma_f32 v22, v66, s26, v116
v_mfma_f32_16x16x32_bf16 v[180:183], a[60:63], a[200:203], v[180:183]
v_fma_f32 v23, v67, s26, v116
v_fma_f32 v32, v32, s28, v112
v_mfma_f32_16x16x32_bf16 v[176:179], a[60:63], a[196:199], v[176:179]
v_fma_f32 v33, v33, s28, v112
v_fma_f32 v34, v34, s28, v112
v_mfma_f32_16x16x32_bf16 v[176:179], a[56:59], a[168:171], v[176:179]
s_waitcnt lgkmcnt(4)
v_fma_f32 v35, v35, s28, v112
v_fma_f32 v64, v64, s28, v112
v_mfma_f32_16x16x32_bf16 v[192:195], a[32:35], a[168:171], v[192:195]
ds_read_b64_tr_b16 a[48:49], v1 offset:32768
buffer_load_dwordx4 a[152:155], v105, s[36:39], s53 offen offset:0 sc1
v_fma_f32 v65, v65, s28, v112
v_mfma_f32_16x16x32_bf16 v[192:195], a[36:39], a[196:199], v[192:195]
v_fma_f32 v66, v66, s28, v112
v_fma_f32 v67, v67, s28, v112
v_mfma_f32_16x16x32_bf16 v[196:199], a[36:39], a[200:203], v[196:199]
ds_read_b64_tr_b16 a[50:51], v1 offset:36864
ds_read_b64_tr_b16 a[52:53], v1 offset:40960
v_mfma_f32_16x16x32_bf16 v[196:199], a[32:35], a[172:175], v[196:199]
v_exp_f32 v32, v32
v_mfma_f32_16x16x32_bf16 v[200:203], a[32:35], a[188:191], v[200:203]
ds_read_b64_tr_b16 a[54:55], v1 offset:45056
buffer_load_dwordx4 a[156:159], v105, s[36:39], s53 offen offset:1024 sc1
v_mfma_f32_16x16x32_bf16 v[200:203], a[36:39], a[204:207], v[200:203]
s_add_u32 s53, s82, 81920
v_exp_f32 v33, v33
v_mfma_f32_16x16x32_bf16 v[204:207], a[36:39], a[208:211], v[204:207]
v_exp_f32 v34, v34
v_mfma_f32_16x16x32_bf16 v[204:207], a[32:35], a[192:195], v[204:207]
s_waitcnt lgkmcnt(4)
v_exp_f32 v35, v35
v_mfma_f32_16x16x32_bf16 v[220:223], a[40:43], a[192:195], v[220:223]
ds_read_b64_tr_b16 a[56:57], v9 offset:32768
buffer_load_dwordx4 a[160:163], v104, s[36:39], s53 offen offset:0 sc1
v_mfma_f32_16x16x32_bf16 v[220:223], a[44:47], a[208:211], v[220:223]
v_exp_f32 v64, v64
v_mfma_f32_16x16x32_bf16 v[216:219], a[44:47], a[204:207], v[216:219]
ds_read_b64_tr_b16 a[58:59], v9 offset:36864
ds_read_b64_tr_b16 a[60:61], v9 offset:40960
v_mfma_f32_16x16x32_bf16 v[216:219], a[40:43], a[188:191], v[216:219]
s_waitcnt vmcnt(10)
v_cmp_ne_u32 vcc, s9, v103
s_mov_b32 s16, 0
s_nop 0
s_cbranch_vccz L_pk_ok
L_pk:
buffer_load_dword v103, v102, s[48:51], s99 offen offset:0 sc1
s_waitcnt vmcnt(0)
v_cmp_ne_u32 vcc, s9, v103
s_add_u32 s16, s16, 1
s_nop 0
s_cbranch_vccz L_pk_ok
s_cmp_lt_u32 s16, 0x100000
s_cbranch_scc1 L_pk
L_pk_ok:
v_mfma_f32_16x16x32_bf16 v[212:215], a[40:43], a[172:175], v[212:215]
ds_read_b64_tr_b16 a[62:63], v9 offset:45056
buffer_load_dwordx4 a[164:167], v104, s[36:39], s53 offen offset:1024 sc1
v_mfma_f32_16x16x32_bf16 v[212:215], a[44:47], a[200:203], v[212:215]
s_mov_b32 s57, 0
v_exp_f32 v65, v65
v_mfma_f32_16x16x32_bf16 v[208:211], a[44:47], a[196:199], v[208:211]
v_exp_f32 v66, v66
v_mfma_f32_16x16x32_bf16 v[208:211], a[40:43], a[168:171], v[208:211]
s_waitcnt lgkmcnt(4)
v_exp_f32 v67, v67
v_mfma_f32_16x16x32_bf16 v[224:227], a[48:51], a[168:171], v[224:227]
buffer_load_dwordx4 a[0:3], v107, s[44:47], s57 offen offset:0 sc1
v_exp_f32 v16, v16
v_mfma_f32_16x16x32_bf16 v[224:227], a[52:55], a[196:199], v[224:227]
v_exp_f32 v17, v17
v_mfma_f32_16x16x32_bf16 v[228:231], a[52:55], a[200:203], v[228:231]
v_exp_f32 v18, v18
v_mfma_f32_16x16x32_bf16 v[228:231], a[48:51], a[172:175], v[228:231]
s_waitcnt lgkmcnt(0)
s_barrier
v_mfma_f32_16x16x32_bf16 v[232:235], a[48:51], a[188:191], v[232:235]
ds_read_b64_tr_b16 a[32:33], v96 offset:49152
buffer_load_dwordx4 a[4:7], v107, s[44:47], s57 offen offset:1152 sc1
v_mfma_f32_16x16x32_bf16 v[232:235], a[52:55], a[204:207], v[232:235]
ds_read_b64_tr_b16 a[34:35], v96 offset:53248
ds_read_b64_tr_b16 a[36:37], v96 offset:57344
v_mfma_f32_16x16x32_bf16 v[236:239], a[52:55], a[208:211], v[236:239]
s_add_u32 m0, s90, 81920
ds_read_b64_tr_b16 a[38:39], v96 offset:61440
s_add_u32 s54, s86, 65536
v_mfma_f32_16x16x32_bf16 v[236:239], a[48:51], a[192:195], v[236:239]
v_exp_f32 v19, v19
v_mfma_f32_16x16x32_bf16 v[252:255], a[56:59], a[192:195], v[252:255]
ds_read_b64_tr_b16 a[40:41], v97 offset:49152
buffer_load_dwordx4 v2, s[72:75], s54 offen lds
v_mfma_f32_16x16x32_bf16 v[252:255], a[60:63], a[208:211], v[252:255]
v_exp_f32 v20, v20
v_mfma_f32_16x16x32_bf16 v[248:251], a[60:63], a[204:207], v[248:251]
ds_read_b64_tr_b16 a[42:43], v97 offset:53248
ds_read_b64_tr_b16 a[44:45], v97 offset:57344
v_mfma_f32_16x16x32_bf16 v[248:251], a[56:59], a[188:191], v[248:251]
s_add_u32 m0, s90, 82944
v_exp_f32 v21, v21
v_mfma_f32_16x16x32_bf16 v[244:247], a[56:59], a[172:175], v[244:247]
ds_read_b64_tr_b16 a[46:47], v97 offset:61440
v_exp_f32 v22, v22
v_mfma_f32_16x16x32_bf16 v[244:247], a[60:63], a[200:203], v[244:247]
v_exp_f32 v23, v23
v_mfma_f32_16x16x32_bf16 v[240:243], a[60:63], a[196:199], v[240:243]
v_cvt_pk_bf16_f32 v32, v32, v33
v_cvt_pk_bf16_f32 v33, v34, v35
v_mfma_f32_16x16x32_bf16 v[240:243], a[56:59], a[168:171], v[240:243]
s_waitcnt lgkmcnt(4)
v_cvt_pk_bf16_f32 v34, v64, v65
v_cvt_pk_bf16_f32 v35, v66, v67
v_mfma_f32_16x16x32_bf16 v[128:131], a[32:35], a[212:215], v[128:131]
ds_read_b64_tr_b16 a[48:49], v98 offset:49152
buffer_load_dwordx4 v3, s[72:75], s54 offen lds
v_cvt_pk_bf16_f32 v64, v16, v17
v_mfma_f32_16x16x32_bf16 v[128:131], a[36:39], a[228:231], v[128:131]
s_add_u32 m0, s90, 83968
v_cvt_pk_bf16_f32 v65, v18, v19
v_cvt_pk_bf16_f32 v66, v20, v21
v_mfma_f32_16x16x32_bf16 v[132:135], a[36:39], a[232:235], v[132:135]
ds_read_b64_tr_b16 a[50:51], v98 offset:53248
ds_read_b64_tr_b16 a[52:53], v98 offset:57344
v_mfma_f32_16x16x32_bf16 v[132:135], a[32:35], a[216:219], v[132:135]
v_cvt_pk_bf16_f32 v67, v22, v23
v_fma_f32 v16, v36, s26, v117
v_mfma_f32_16x16x32_bf16 v[136:139], a[32:35], a[220:223], v[136:139]
ds_read_b64_tr_b16 a[54:55], v98 offset:61440
buffer_load_dwordx4 v4, s[72:75], s54 offen lds
v_fma_f32 v17, v37, s26, v117
v_mfma_f32_16x16x32_bf16 v[136:139], a[36:39], a[236:239], v[136:139]
s_add_u32 m0, s90, 84992
v_fma_f32 v18, v38, s26, v117
v_fma_f32 v19, v39, s26, v117
v_mfma_f32_16x16x32_bf16 v[140:143], a[36:39], a[64:67], v[140:143]
v_fma_f32 v20, v68, s26, v117
v_fma_f32 v21, v69, s26, v117
v_mfma_f32_16x16x32_bf16 v[140:143], a[32:35], a[224:227], v[140:143]
s_waitcnt lgkmcnt(4)
v_fma_f32 v22, v70, s26, v117
v_fma_f32 v23, v71, s26, v117
v_mfma_f32_16x16x32_bf16 v[156:159], a[40:43], a[224:227], v[156:159]
ds_read_b64_tr_b16 a[56:57], v99 offset:49152
buffer_load_dwordx4 v5, s[72:75], s54 offen lds
v_fma_f32 v36, v36, s28, v113
v_mfma_f32_16x16x32_bf16 v[156:159], a[44:47], a[64:67], v[156:159]
s_mov_b32 s57, 2304
v_fma_f32 v37, v37, s28, v113
v_fma_f32 v38, v38, s28, v113
v_mfma_f32_16x16x32_bf16 v[152:155], a[44:47], a[236:239], v[152:155]
ds_read_b64_tr_b16 a[58:59], v99 offset:53248
ds_read_b64_tr_b16 a[60:61], v99 offset:57344
v_mfma_f32_16x16x32_bf16 v[152:155], a[40:43], a[220:223], v[152:155]
v_fma_f32 v39, v39, s28, v113
v_fma_f32 v68, v68, s28, v113
v_mfma_f32_16x16x32_bf16 v[148:151], a[40:43], a[216:219], v[148:151]
ds_read_b64_tr_b16 a[62:63], v99 offset:61440
buffer_load_dwordx4 a[8:11], v107, s[44:47], s57 offen offset:0 sc1
v_fma_f32 v69, v69, s28, v113
v_mfma_f32_16x16x32_bf16 v[148:151], a[44:47], a[232:235], v[148:151]
v_fma_f32 v70, v70, s28, v113
v_fma_f32 v71, v71, s28, v113
v_mfma_f32_16x16x32_bf16 v[144:147], a[44:47], a[228:231], v[144:147]
v_exp_f32 v36, v36
v_mfma_f32_16x16x32_bf16 v[144:147], a[40:43], a[212:215], v[144:147]
s_waitcnt lgkmcnt(4)
v_exp_f32 v37, v37
v_mfma_f32_16x16x32_bf16 v[160:163], a[48:51], a[212:215], v[160:163]
ds_read_b64_tr_b16 a[32:33], v106 offset:49152
buffer_load_dwordx4 a[12:15], v107, s[44:47], s57 offen offset:1152 sc1
v_mfma_f32_16x16x32_bf16 v[160:163], a[52:55], a[228:231], v[160:163]
s_mov_b32 s57, 4608
v_exp_f32 v38, v38
v_mfma_f32_16x16x32_bf16 v[164:167], a[52:55], a[232:235], v[164:167]
ds_read_b64_tr_b16 a[34:35], v106 offset:53248
ds_read_b64_tr_b16 a[36:37], v106 offset:57344
v_mfma_f32_16x16x32_bf16 v[164:167], a[48:51], a[216:219], v[164:167]
v_exp_f32 v39, v39
v_mfma_f32_16x16x32_bf16 v[168:171], a[48:51], a[220:223], v[168:171]
ds_read_b64_tr_b16 a[38:39], v106 offset:61440
buffer_load_dwordx4 a[16:19], v107, s[44:47], s57 offen offset:0 sc1
v_mfma_f32_16x16x32_bf16 v[168:171], a[52:55], a[236:239], v[168:171]
v_exp_f32 v68, v68
v_mfma_f32_16x16x32_bf16 v[172:175], a[52:55], a[64:67], v[172:175]
v_exp_f32 v69, v69
v_mfma_f32_16x16x32_bf16 v[172:175], a[48:51], a[224:227], v[172:175]
s_waitcnt lgkmcnt(4)
v_exp_f32 v70, v70
v_mfma_f32_16x16x32_bf16 v[188:191], a[56:59], a[224:227], v[188:191]
ds_read_b64_tr_b16 a[40:41], v111 offset:49152
buffer_load_dwordx4 a[20:23], v107, s[44:47], s57 offen offset:1152 sc1
v_mfma_f32_16x16x32_bf16 v[188:191], a[60:63], a[64:67], v[188:191]
v_exp_f32 v71, v71
v_mfma_f32_16x16x32_bf16 v[184:187], a[60:63], a[236:239], v[184:187]
s_mov_b32 s57, 6912
ds_read_b64_tr_b16 a[42:43], v111 offset:53248
ds_read_b64_tr_b16 a[44:45], v111 offset:57344
v_mfma_f32_16x16x32_bf16 v[184:187], a[56:59], a[220:223], v[184:187]
v_exp_f32 v16, v16
v_mfma_f32_16x16x32_bf16 v[180:183], a[56:59], a[216:219], v[180:183]
ds_read_b64_tr_b16 a[46:47], v111 offset:61440
buffer_load_dwordx4 a[24:27], v107, s[44:47], s57 offen offset:0 sc1
v_mfma_f32_16x16x32_bf16 v[180:183], a[60:63], a[232:235], v[180:183]
v_exp_f32 v17, v17
v_mfma_f32_16x16x32_bf16 v[176:179], a[60:63], a[228:231], v[176:179]
v_exp_f32 v18, v18
v_mfma_f32_16x16x32_bf16 v[176:179], a[56:59], a[212:215], v[176:179]
s_waitcnt lgkmcnt(4)
v_exp_f32 v19, v19
v_mfma_f32_16x16x32_bf16 v[192:195], a[32:35], a[212:215], v[192:195]
ds_read_b64_tr_b16 a[48:49], v1 offset:49152
v_exp_f32 v20, v20
v_mfma_f32_16x16x32_bf16 v[192:195], a[36:39], a[228:231], v[192:195]
v_exp_f32 v21, v21
v_mfma_f32_16x16x32_bf16 v[196:199], a[36:39], a[232:235], v[196:199]
ds_read_b64_tr_b16 a[50:51], v1 offset:53248
ds_read_b64_tr_b16 a[52:53], v1 offset:57344
v_mfma_f32_16x16x32_bf16 v[196:199], a[32:35], a[216:219], v[196:199]
v_exp_f32 v22, v22
v_mfma_f32_16x16x32_bf16 v[200:203], a[32:35], a[220:223], v[200:203]
ds_read_b64_tr_b16 a[54:55], v1 offset:61440
buffer_load_dwordx4 a[28:31], v107, s[44:47], s57 offen offset:1152 sc1
v_mfma_f32_16x16x32_bf16 v[200:203], a[36:39], a[236:239], v[200:203]
v_exp_f32 v23, v23
v_mfma_f32_16x16x32_bf16 v[204:207], a[36:39], a[64:67], v[204:207]
v_cvt_pk_bf16_f32 v36, v36, v37
v_cvt_pk_bf16_f32 v37, v38, v39
v_mfma_f32_16x16x32_bf16 v[204:207], a[32:35], a[224:227], v[204:207]
s_waitcnt lgkmcnt(4)
v_cvt_pk_bf16_f32 v38, v68, v69
v_cvt_pk_bf16_f32 v39, v70, v71
v_mfma_f32_16x16x32_bf16 v[220:223], a[40:43], a[224:227], v[220:223]
ds_read_b64_tr_b16 a[56:57], v9 offset:49152
buffer_load_dwordx4 v[124:127], v82, s[44:47], 0 offen offset:1024 sc1
v_cvt_pk_bf16_f32 v68, v16, v17
v_mfma_f32_16x16x32_bf16 v[220:223], a[44:47], a[64:67], v[220:223]
v_cvt_pk_bf16_f32 v69, v18, v19
v_cvt_pk_bf16_f32 v70, v20, v21
v_mfma_f32_16x16x32_bf16 v[216:219], a[44:47], a[236:239], v[216:219]
ds_read_b64_tr_b16 a[58:59], v9 offset:53248
ds_read_b64_tr_b16 a[60:61], v9 offset:57344
v_mfma_f32_16x16x32_bf16 v[216:219], a[40:43], a[220:223], v[216:219]
v_cvt_pk_bf16_f32 v71, v22, v23
v_fma_f32 v16, v40, s26, v118
v_mfma_f32_16x16x32_bf16 v[212:215], a[40:43], a[216:219], v[212:215]
ds_read_b64_tr_b16 a[62:63], v9 offset:61440
buffer_load_dwordx4 a[168:171], v105, s[36:39], s53 offen offset:0 sc1
v_fma_f32 v17, v41, s26, v118
v_mfma_f32_16x16x32_bf16 v[212:215], a[44:47], a[232:235], v[212:215]
v_fma_f32 v18, v42, s26, v118
v_fma_f32 v19, v43, s26, v118
v_mfma_f32_16x16x32_bf16 v[208:211], a[44:47], a[228:231], v[208:211]
v_fma_f32 v20, v72, s26, v118
v_fma_f32 v21, v73, s26, v118
v_mfma_f32_16x16x32_bf16 v[208:211], a[40:43], a[212:215], v[208:211]
s_waitcnt lgkmcnt(4)
v_fma_f32 v22, v74, s26, v118
v_fma_f32 v23, v75, s26, v118
v_mfma_f32_16x16x32_bf16 v[224:227], a[48:51], a[212:215], v[224:227]
buffer_load_dwordx4 a[172:175], v105, s[36:39], s53 offen offset:1024 sc1
v_fma_f32 v40, v40, s28, v114
v_fma_f32 v41, v41, s28, v114
v_mfma_f32_16x16x32_bf16 v[224:227], a[52:55], a[228:231], v[224:227]
s_add_u32 s53, s83, 16384
v_fma_f32 v42, v42, s28, v114
v_fma_f32 v43, v43, s28, v114
v_mfma_f32_16x16x32_bf16 v[228:231], a[52:55], a[232:235], v[228:231]
v_fma_f32 v72, v72, s28, v114
v_fma_f32 v73, v73, s28, v114
v_mfma_f32_16x16x32_bf16 v[228:231], a[48:51], a[216:219], v[228:231]
s_waitcnt lgkmcnt(0)
s_barrier
v_fma_f32 v74, v74, s28, v114
v_mfma_f32_16x16x32_bf16 v[232:235], a[48:51], a[220:223], v[232:235]
ds_read_b64_tr_b16 a[32:33], v96 offset:0
buffer_load_dwordx4 a[188:191], v104, s[36:39], s53 offen offset:0 sc1
v_fma_f32 v75, v75, s28, v114
v_mfma_f32_16x16x32_bf16 v[232:235], a[52:55], a[236:239], v[232:235]
s_add_u32 m0, s90, 98304
ds_read_b64_tr_b16 a[34:35], v96 offset:4096
ds_read_b64_tr_b16 a[36:37], v96 offset:8192
v_mfma_f32_16x16x32_bf16 v[236:239], a[52:55], a[64:67], v[236:239]
s_add_u32 s54, s87, 65536
ds_read_b64_tr_b16 a[38:39], v96 offset:12288
v_mfma_f32_16x16x32_bf16 v[236:239], a[48:51], a[224:227], v[236:239]
v_exp_f32 v40, v40
v_mfma_f32_16x16x32_bf16 v[252:255], a[56:59], a[224:227], v[252:255]
ds_read_b64_tr_b16 a[40:41], v97 offset:0
buffer_load_dwordx4 v2, s[72:75], s54 offen lds
v_mfma_f32_16x16x32_bf16 v[252:255], a[60:63], a[64:67], v[252:255]
L_pad6:
s_cbranch_execz L_pad10
v_exp_f32 v41, v41
v_mfma_f32_16x16x32_bf16 v[248:251], a[60:63], a[236:239], v[248:251]
s_add_u32 m0, s90, 99328
ds_read_b64_tr_b16 a[42:43], v97 offset:4096
ds_read_b64_tr_b16 a[44:45], v97 offset:8192
v_mfma_f32_16x16x32_bf16 v[248:251], a[56:59], a[220:223], v[248:251]
v_exp_f32 v42, v42
v_mfma_f32_16x16x32_bf16 v[244:247], a[56:59], a[216:219], v[244:247]
ds_read_b64_tr_b16 a[46:47], v97 offset:12288
buffer_load_dwordx4 v3, s[72:75], s54 offen lds
v_mfma_f32_16x16x32_bf16 v[244:247], a[60:63], a[232:235], v[244:247]
v_exp_f32 v43, v43
v_mfma_f32_16x16x32_bf16 v[240:243], a[60:63], a[228:231], v[240:243]
s_add_u32 m0, s90, 100352
v_exp_f32 v72, v72
v_mfma_f32_16x16x32_bf16 v[240:243], a[56:59], a[212:215], v[240:243]
s_waitcnt lgkmcnt(4)
v_exp_f32 v73, v73
v_mfma_f32_16x16x32_bf16 v[128:131], a[32:35], a[184:187], v[128:131]
ds_read_b64_tr_b16 a[48:49], v98 offset:0
buffer_load_dwordx4 v4, s[72:75], s54 offen lds
v_mfma_f32_16x16x32_bf16 v[128:131], a[36:39], a[68:71], v[128:131]
v_exp_f32 v74, v74
v_mfma_f32_16x16x32_bf16 v[132:135], a[36:39], a[72:75], v[132:135]
ds_read_b64_tr_b16 a[50:51], v98 offset:4096
ds_read_b64_tr_b16 a[52:53], v98 offset:8192
v_mfma_f32_16x16x32_bf16 v[132:135], a[32:35], a[116:119], v[132:135]
s_add_u32 m0, s90, 101376
v_exp_f32 v75, v75
v_mfma_f32_16x16x32_bf16 v[136:139], a[32:35], a[112:115], v[136:139]
ds_read_b64_tr_b16 a[54:55], v98 offset:12288
v_exp_f32 v16, v16
v_mfma_f32_16x16x32_bf16 v[136:139], a[36:39], a[76:79], v[136:139]
v_exp_f32 v17, v17
v_mfma_f32_16x16x32_bf16 v[140:143], a[36:39], a[80:83], v[140:143]
v_exp_f32 v18, v18
v_mfma_f32_16x16x32_bf16 v[140:143], a[32:35], a[108:111], v[140:143]
s_waitcnt lgkmcnt(4)
v_exp_f32 v19, v19
v_mfma_f32_16x16x32_bf16 v[156:159], a[40:43], a[108:111], v[156:159]
ds_read_b64_tr_b16 a[56:57], v99 offset:0
buffer_load_dwordx4 v5, s[72:75], s54 offen lds
v_mfma_f32_16x16x32_bf16 v[156:159], a[44:47], a[80:83], v[156:159]
v_exp_f32 v20, v20
v_mfma_f32_16x16x32_bf16 v[152:155], a[44:47], a[76:79], v[152:155]
ds_read_b64_tr_b16 a[58:59], v99 offset:4096
ds_read_b64_tr_b16 a[60:61], v99 offset:8192
v_mfma_f32_16x16x32_bf16 v[152:155], a[40:43], a[112:115], v[152:155]
v_exp_f32 v21, v21
v_mfma_f32_16x16x32_bf16 v[148:151], a[40:43], a[116:119], v[148:151]
ds_read_b64_tr_b16 a[62:63], v99 offset:12288
buffer_load_dwordx4 a[192:195], v104, s[36:39], s53 offen offset:1024 sc1
v_mfma_f32_16x16x32_bf16 v[148:151], a[44:47], a[72:75], v[148:151]
v_exp_f32 v22, v22
v_mfma_f32_16x16x32_bf16 v[144:147], a[44:47], a[68:71], v[144:147]
v_exp_f32 v23, v23
v_mfma_f32_16x16x32_bf16 v[144:147], a[40:43], a[184:187], v[144:147]
s_waitcnt lgkmcnt(4)
v_cvt_pk_bf16_f32 v40, v40, v41
v_cvt_pk_bf16_f32 v41, v42, v43
v_mfma_f32_16x16x32_bf16 v[160:163], a[48:51], a[184:187], v[160:163]
ds_read_b64_tr_b16 a[32:33], v106 offset:0
buffer_load_dwordx4 a[196:199], v105, s[36:39], s53 offen offset:0 sc1
v_cvt_pk_bf16_f32 v42, v72, v73
v_mfma_f32_16x16x32_bf16 v[160:163], a[52:55], a[68:71], v[160:163]
v_cvt_pk_bf16_f32 v43, v74, v75
v_cvt_pk_bf16_f32 v72, v16, v17
v_mfma_f32_16x16x32_bf16 v[164:167], a[52:55], a[72:75], v[164:167]
ds_read_b64_tr_b16 a[34:35], v106 offset:4096
ds_read_b64_tr_b16 a[36:37], v106 offset:8192
v_mfma_f32_16x16x32_bf16 v[164:167], a[48:51], a[116:119], v[164:167]
v_cvt_pk_bf16_f32 v73, v18, v19
v_cvt_pk_bf16_f32 v74, v20, v21
v_mfma_f32_16x16x32_bf16 v[168:171], a[48:51], a[112:115], v[168:171]
ds_read_b64_tr_b16 a[38:39], v106 offset:12288
buffer_load_dwordx4 a[200:203], v105, s[36:39], s53 offen offset:1024 sc1
v_cvt_pk_bf16_f32 v75, v22, v23
v_mfma_f32_16x16x32_bf16 v[168:171], a[52:55], a[76:79], v[168:171]
s_add_u32 s53, s83, 81920
s_waitcnt vmcnt(10)
v_mfma_f32_16x16x32_bf16 v[48:51], a[178:181], a[0:3], 0
v_add_f32_dpp v124, v124, v124 row_ror:1 row_mask:0xf bank_mask:0xf
v_mfma_f32_16x16x32_bf16 v[48:51], a[178:181], a[4:7], v[48:51]
v_add_f32_dpp v125, v125, v125 row_ror:1 row_mask:0xf bank_mask:0xf
v_mfma_f32_16x16x32_bf16 v[48:51], a[178:181], a[8:11], v[48:51]
v_add_f32_dpp v126, v126, v126 row_ror:1 row_mask:0xf bank_mask:0xf
v_mfma_f32_16x16x32_bf16 v[48:51], a[178:181], a[12:15], v[48:51]
v_add_f32_dpp v127, v127, v127 row_ror:1 row_mask:0xf bank_mask:0xf
v_mfma_f32_16x16x32_bf16 v[48:51], a[178:181], a[16:19], v[48:51]
v_add_f32_dpp v124, v124, v124 row_ror:2 row_mask:0xf bank_mask:0xf
v_mfma_f32_16x16x32_bf16 v[48:51], a[178:181], a[20:23], v[48:51]
v_add_f32_dpp v125, v125, v125 row_ror:2 row_mask:0xf bank_mask:0xf
v_mfma_f32_16x16x32_bf16 v[48:51], a[178:181], a[24:27], v[48:51]
v_add_f32_dpp v126, v126, v126 row_ror:2 row_mask:0xf bank_mask:0xf
v_mfma_f32_16x16x32_bf16 v[48:51], a[178:181], a[28:31], v[48:51]
v_add_f32_dpp v127, v127, v127 row_ror:2 row_mask:0xf bank_mask:0xf
v_mfma_f32_16x16x32_bf16 v[52:55], a[176:179], a[0:3], 0
v_add_f32_dpp v124, v124, v124 row_ror:4 row_mask:0xf bank_mask:0xf
v_mfma_f32_16x16x32_bf16 v[52:55], a[176:179], a[4:7], v[52:55]
v_add_f32_dpp v125, v125, v125 row_ror:4 row_mask:0xf bank_mask:0xf
v_mfma_f32_16x16x32_bf16 v[52:55], a[176:179], a[8:11], v[52:55]
v_add_f32_dpp v126, v126, v126 row_ror:4 row_mask:0xf bank_mask:0xf
v_mfma_f32_16x16x32_bf16 v[52:55], a[176:179], a[12:15], v[52:55]
v_add_f32_dpp v127, v127, v127 row_ror:4 row_mask:0xf bank_mask:0xf
v_mfma_f32_16x16x32_bf16 v[52:55], a[176:179], a[16:19], v[52:55]
v_mfma_f32_16x16x32_bf16 v[52:55], a[176:179], a[20:23], v[52:55]
v_mfma_f32_16x16x32_bf16 v[52:55], a[176:179], a[24:27], v[52:55]
v_mfma_f32_16x16x32_bf16 v[52:55], a[176:179], a[28:31], v[52:55]
v_cvt_pk_bf16_f32 v124, v124, v125
v_cvt_pk_bf16_f32 v125, v126, v127
v_mfma_f32_16x16x32_bf16 v[172:175], a[52:55], a[80:83], v[172:175]
v_cndmask_b32 v124, v124, v120, s[30:31]
v_cndmask_b32 v125, v125, v120, s[30:31]
v_mfma_f32_16x16x32_bf16 v[172:175], a[48:51], a[108:111], v[172:175]
s_waitcnt lgkmcnt(4)
ds_write_b64 v81, v[124:125] offset:2048
v_cvt_pk_bf16_f32 v48, v48, v49
v_mfma_f32_16x16x32_bf16 v[188:191], a[56:59], a[108:111], v[188:191]
ds_read_b64_tr_b16 a[40:41], v111 offset:0
buffer_load_dwordx4 a[204:207], v104, s[36:39], s53 offen offset:0 sc1
v_cvt_pk_bf16_f32 v49, v50, v51
v_mfma_f32_16x16x32_bf16 v[188:191], a[60:63], a[80:83], v[188:191]
ds_write_b64 v81, v[48:49] offset:0
v_cvt_pk_bf16_f32 v52, v52, v53
v_mfma_f32_16x16x32_bf16 v[184:187], a[60:63], a[76:79], v[184:187]
ds_read_b64_tr_b16 a[42:43], v111 offset:4096
ds_read_b64_tr_b16 a[44:45], v111 offset:8192
v_mfma_f32_16x16x32_bf16 v[184:187], a[56:59], a[112:115], v[184:187]
v_cvt_pk_bf16_f32 v53, v54, v55
v_mfma_f32_16x16x32_bf16 v[180:183], a[56:59], a[116:119], v[180:183]
ds_read_b64_tr_b16 a[46:47], v111 offset:12288
buffer_load_dwordx4 a[208:211], v104, s[36:39], s53 offen offset:1024 sc1
ds_write_b64 v81, v[52:53] offset:1024
v_mfma_f32_16x16x32_bf16 v[180:183], a[60:63], a[72:75], v[180:183]
v_fma_f32 v16, v44, s26, v119
v_fma_f32 v17, v45, s26, v119
v_mfma_f32_16x16x32_bf16 v[176:179], a[60:63], a[68:71], v[176:179]
v_fma_f32 v18, v46, s26, v119
v_fma_f32 v19, v47, s26, v119
v_mfma_f32_16x16x32_bf16 v[176:179], a[56:59], a[184:187], v[176:179]
s_waitcnt lgkmcnt(7)
v_fma_f32 v20, v76, s26, v119
v_fma_f32 v21, v77, s26, v119
v_mfma_f32_16x16x32_bf16 v[192:195], a[32:35], a[184:187], v[192:195]
ds_read_b64_tr_b16 a[48:49], v1 offset:0
buffer_load_dwordx4 a[212:215], v105, s[36:39], s53 offen offset:0 sc1
v_fma_f32 v22, v78, s26, v119
v_mfma_f32_16x16x32_bf16 v[192:195], a[36:39], a[68:71], v[192:195]
v_fma_f32 v23, v79, s26, v119
v_fma_f32 v44, v44, s28, v115
v_mfma_f32_16x16x32_bf16 v[196:199], a[36:39], a[72:75], v[196:199]
ds_read_b64_tr_b16 a[50:51], v1 offset:4096
ds_read_b64_tr_b16 a[52:53], v1 offset:8192
v_mfma_f32_16x16x32_bf16 v[196:199], a[32:35], a[116:119], v[196:199]
v_fma_f32 v45, v45, s28, v115
v_fma_f32 v46, v46, s28, v115
v_mfma_f32_16x16x32_bf16 v[200:203], a[32:35], a[112:115], v[200:203]
ds_read_b64_tr_b16 a[54:55], v1 offset:12288
buffer_load_dwordx4 a[216:219], v105, s[36:39], s53 offen offset:1024 sc1
v_fma_f32 v47, v47, s28, v115
v_mfma_f32_16x16x32_bf16 v[200:203], a[36:39], a[76:79], v[200:203]
s_add_u32 s53, s8, 32768
v_fma_f32 v76, v76, s28, v115
v_fma_f32 v77, v77, s28, v115
v_mfma_f32_16x16x32_bf16 v[204:207], a[36:39], a[80:83], v[204:207]
v_fma_f32 v78, v78, s28, v115
v_fma_f32 v79, v79, s28, v115
v_mfma_f32_16x16x32_bf16 v[204:207], a[32:35], a[108:111], v[204:207]
s_waitcnt lgkmcnt(5)
v_exp_f32 v44, v44
v_mfma_f32_16x16x32_bf16 v[220:223], a[40:43], a[108:111], v[220:223]
ds_read_b64_tr_b16 a[56:57], v9 offset:0
buffer_load_dwordx4 a[220:223], v104, s[36:39], s53 offen offset:0 sc1
v_mfma_f32_16x16x32_bf16 v[220:223], a[44:47], a[80:83], v[220:223]
v_exp_f32 v45, v45
v_mfma_f32_16x16x32_bf16 v[216:219], a[44:47], a[76:79], v[216:219]
ds_read_b64_tr_b16 a[58:59], v9 offset:4096
ds_read_b64_tr_b16 a[60:61], v9 offset:8192
v_mfma_f32_16x16x32_bf16 v[216:219], a[40:43], a[112:115], v[216:219]
v_exp_f32 v46, v46
v_mfma_f32_16x16x32_bf16 v[212:215], a[40:43], a[116:119], v[212:215]
ds_read_b64_tr_b16 a[62:63], v9 offset:12288
buffer_load_dwordx4 a[224:227], v104, s[36:39], s53 offen offset:1024 sc1
v_mfma_f32_16x16x32_bf16 v[212:215], a[44:47], a[72:75], v[212:215]
v_exp_f32 v47, v47
v_mfma_f32_16x16x32_bf16 v[208:211], a[44:47], a[68:71], v[208:211]
v_exp_f32 v76, v76
v_mfma_f32_16x16x32_bf16 v[208:211], a[40:43], a[184:187], v[208:211]
s_waitcnt lgkmcnt(4)
v_exp_f32 v77, v77
v_mfma_f32_16x16x32_bf16 v[224:227], a[48:51], a[184:187], v[224:227]
buffer_load_dwordx4 a[228:231], v105, s[36:39], s53 offen offset:0 sc1
v_exp_f32 v78, v78
v_mfma_f32_16x16x32_bf16 v[224:227], a[52:55], a[68:71], v[224:227]
v_exp_f32 v79, v79
v_mfma_f32_16x16x32_bf16 v[228:231], a[52:55], a[72:75], v[228:231]
v_exp_f32 v16, v16
v_mfma_f32_16x16x32_bf16 v[228:231], a[48:51], a[116:119], v[228:231]
s_waitcnt lgkmcnt(0)
s_barrier
ds_read_b128 a[0:3], v80 offset:0
v_mfma_f32_16x16x32_bf16 v[232:235], a[48:51], a[112:115], v[232:235]
ds_read_b64_tr_b16 a[32:33], v96 offset:16384
buffer_load_dwordx4 a[232:235], v105, s[36:39], s53 offen offset:1024 sc1
ds_read_b128 a[4:7], v80 offset:1024
v_mfma_f32_16x16x32_bf16 v[232:235], a[52:55], a[76:79], v[232:235]
ds_read_b64_tr_b16 a[34:35], v96 offset:20480
ds_read_b64_tr_b16 a[36:37], v96 offset:24576
v_mfma_f32_16x16x32_bf16 v[236:239], a[52:55], a[80:83], v[236:239]
ds_read_b64_tr_b16 a[38:39], v96 offset:28672
ds_read_b128 a[8:11], v80 offset:2048
v_mfma_f32_16x16x32_bf16 v[236:239], a[48:51], a[108:111], v[236:239]
ds_read_b128 a[12:15], v80 offset:3072
ds_read_b128 a[16:19], v80 offset:4096
v_mfma_f32_16x16x32_bf16 v[252:255], a[56:59], a[108:111], v[252:255]
s_add_u32 m0, s90, 49152
ds_read_b64_tr_b16 a[40:41], v97 offset:16384
ds_read_b128 a[20:23], v80 offset:5120
s_add_u32 s54, s84, 131072
v_mfma_f32_16x16x32_bf16 v[252:255], a[60:63], a[80:83], v[252:255]
v_exp_f32 v17, v17
v_mfma_f32_16x16x32_bf16 v[248:251], a[60:63], a[76:79], v[248:251]
ds_read_b64_tr_b16 a[42:43], v97 offset:20480
ds_read_b64_tr_b16 a[44:45], v97 offset:24576
v_mfma_f32_16x16x32_bf16 v[248:251], a[56:59], a[112:115], v[248:251]
v_exp_f32 v18, v18
v_mfma_f32_16x16x32_bf16 v[244:247], a[56:59], a[116:119], v[244:247]
ds_read_b64_tr_b16 a[46:47], v97 offset:28672
buffer_load_dwordx4 v2, s[72:75], s54 offen lds
v_mfma_f32_16x16x32_bf16 v[244:247], a[60:63], a[72:75], v[244:247]
s_add_u32 m0, s90, 50176
v_exp_f32 v19, v19
v_mfma_f32_16x16x32_bf16 v[240:243], a[60:63], a[68:71], v[240:243]
v_exp_f32 v20, v20
v_mfma_f32_16x16x32_bf16 v[240:243], a[56:59], a[184:187], v[240:243]
s_waitcnt lgkmcnt(8)
v_exp_f32 v21, v21
v_mfma_f32_16x16x32_bf16 v[128:131], a[32:35], a[84:87], v[128:131]
ds_read_b64_tr_b16 a[48:49], v98 offset:16384
buffer_load_dwordx4 v3, s[72:75], s54 offen lds
v_mfma_f32_16x16x32_bf16 v[128:131], a[36:39], a[128:131], v[128:131]
s_add_u32 m0, s90, 51200
v_exp_f32 v22, v22
v_mfma_f32_16x16x32_bf16 v[132:135], a[36:39], a[132:135], v[132:135]
ds_read_b64_tr_b16 a[50:51], v98 offset:20480
ds_read_b64_tr_b16 a[52:53], v98 offset:24576
v_mfma_f32_16x16x32_bf16 v[132:135], a[32:35], a[88:91], v[132:135]
v_exp_f32 v23, v23
v_mfma_f32_16x16x32_bf16 v[136:139], a[32:35], a[120:123], v[136:139]
ds_read_b64_tr_b16 a[54:55], v98 offset:28672
buffer_load_dwordx4 v4, s[72:75], s54 offen lds
v_cvt_pk_bf16_f32 v44, v44, v45
v_mfma_f32_16x16x32_bf16 v[136:139], a[36:39], a[136:139], v[136:139]
s_add_u32 m0, s90, 52224
v_cvt_pk_bf16_f32 v45, v46, v47
v_cvt_pk_bf16_f32 v46, v76, v77
v_mfma_f32_16x16x32_bf16 v[140:143], a[36:39], a[140:143], v[140:143]
v_cvt_pk_bf16_f32 v47, v78, v79
v_cvt_pk_bf16_f32 v76, v16, v17
v_mfma_f32_16x16x32_bf16 v[140:143], a[32:35], a[124:127], v[140:143]
s_waitcnt lgkmcnt(4)
v_cvt_pk_bf16_f32 v77, v18, v19
v_cvt_pk_bf16_f32 v78, v20, v21
v_mfma_f32_16x16x32_bf16 v[156:159], a[40:43], a[124:127], v[156:159]
ds_read_b64_tr_b16 a[56:57], v99 offset:16384
buffer_load_dwordx4 v5, s[72:75], s54 offen lds
v_cvt_pk_bf16_f32 v79, v22, v23
v_mfma_f32_16x16x32_bf16 v[156:159], a[44:47], a[140:143], v[156:159]
s_add_u32 s53, s81, 32768
s_lshl_b32 s62, s13, 14
v_mfma_f32_16x16x32_bf16 v[112:115], a[8:11], v[32:35], 0
v_mfma_f32_16x16x32_bf16 v[116:119], a[20:23], v[64:67], 0
v_mfma_f32_16x16x32_bf16 v[16:19], a[0:3], v[32:35], 0
v_mfma_f32_16x16x32_bf16 v[24:27], a[12:15], v[64:67], 0
v_mfma_f32_16x16x32_bf16 v[20:23], a[4:7], v[32:35], 0
v_mfma_f32_16x16x32_bf16 v[28:31], a[16:19], v[64:67], 0
v_mfma_f32_16x16x32_bf16 v[120:123], a[8:11], v[36:39], 0
v_mfma_f32_16x16x32_bf16 v[124:127], a[20:23], v[68:71], 0
v_mfma_f32_16x16x32_bf16 v[48:51], a[0:3], v[36:39], 0
v_mfma_f32_16x16x32_bf16 v[56:59], a[12:15], v[68:71], 0
v_mfma_f32_16x16x32_bf16 v[52:55], a[4:7], v[36:39], 0
v_mfma_f32_16x16x32_bf16 v[60:63], a[16:19], v[68:71], 0
v_rcp_f32 v113, v113
v_mfma_f32_16x16x32_bf16 v[152:155], a[44:47], a[136:139], v[152:155]
ds_read_b64_tr_b16 a[58:59], v99 offset:20480
ds_read_b64_tr_b16 a[60:61], v99 offset:24576
v_mfma_f32_16x16x32_bf16 v[152:155], a[40:43], a[120:123], v[152:155]
v_rcp_f32 v117, v117
v_mfma_f32_16x16x32_bf16 v[148:151], a[40:43], a[88:91], v[148:151]
ds_read_b64_tr_b16 a[62:63], v99 offset:28672
buffer_load_dwordx4 a[236:239], v104, s[36:39], s53 offen offset:0 sc1
v_mul_f32 v112, v112, v113
v_mfma_f32_16x16x32_bf16 v[148:151], a[44:47], a[132:135], v[148:151]
v_fmac_f32 v112, v116, v117
v_add_f32 v112, 0x358637bd, v112
v_mfma_f32_16x16x32_bf16 v[144:147], a[44:47], a[128:131], v[144:147]
v_rcp_f32 v112, v112
v_mfma_f32_16x16x32_bf16 v[144:147], a[40:43], a[84:87], v[144:147]
s_waitcnt lgkmcnt(4)
v_mul_f32 v113, v113, v112
v_mul_f32 v117, v117, v112
v_mfma_f32_16x16x32_bf16 v[160:163], a[48:51], a[84:87], v[160:163]
ds_read_b64_tr_b16 a[32:33], v106 offset:16384
buffer_load_dwordx4 a[64:67], v104, s[36:39], s53 offen offset:1024 sc1
v_mul_f32 v16, v16, v113
v_mfma_f32_16x16x32_bf16 v[160:163], a[52:55], a[128:131], v[160:163]
v_mul_f32 v17, v17, v113
v_mul_f32 v18, v18, v113
v_mfma_f32_16x16x32_bf16 v[164:167], a[52:55], a[132:135], v[164:167]
ds_read_b64_tr_b16 a[34:35], v106 offset:20480
ds_read_b64_tr_b16 a[36:37], v106 offset:24576
v_mfma_f32_16x16x32_bf16 v[164:167], a[48:51], a[88:91], v[164:167]
v_mul_f32 v19, v19, v113
v_mul_f32 v20, v20, v113
v_mfma_f32_16x16x32_bf16 v[168:171], a[48:51], a[120:123], v[168:171]
ds_read_b64_tr_b16 a[38:39], v106 offset:28672
buffer_load_dwordx4 a[24:27], v105, s[36:39], s53 offen offset:0 sc1
v_mul_f32 v21, v21, v113
v_mfma_f32_16x16x32_bf16 v[168:171], a[52:55], a[136:139], v[168:171]
v_mul_f32 v22, v22, v113
v_mul_f32 v23, v23, v113
v_mfma_f32_16x16x32_bf16 v[172:175], a[52:55], a[140:143], v[172:175]
v_fmac_f32 v16, v24, v117
v_fmac_f32 v17, v25, v117
v_mfma_f32_16x16x32_bf16 v[172:175], a[48:51], a[124:127], v[172:175]
s_waitcnt lgkmcnt(4)
v_fmac_f32 v18, v26, v117
v_fmac_f32 v19, v27, v117
v_mfma_f32_16x16x32_bf16 v[188:191], a[56:59], a[124:127], v[188:191]
ds_read_b64_tr_b16 a[40:41], v111 offset:16384
buffer_load_dwordx4 a[28:31], v105, s[36:39], s53 offen offset:1024 sc1
v_fmac_f32 v20, v28, v117
v_mfma_f32_16x16x32_bf16 v[188:191], a[60:63], a[140:143], v[188:191]
s_add_u32 s53, s81, 98304
v_fmac_f32 v21, v29, v117
v_fmac_f32 v22, v30, v117
v_mfma_f32_16x16x32_bf16 v[184:187], a[60:63], a[136:139], v[184:187]
ds_read_b64_tr_b16 a[42:43], v111 offset:20480
ds_read_b64_tr_b16 a[44:45], v111 offset:24576
v_mfma_f32_16x16x32_bf16 v[184:187], a[56:59], a[120:123], v[184:187]
v_fmac_f32 v23, v31, v117
v_cvt_pk_bf16_f32 v32, v16, v17
v_mfma_f32_16x16x32_bf16 v[180:183], a[56:59], a[88:91], v[180:183]
ds_read_b64_tr_b16 a[46:47], v111 offset:28672
buffer_load_dwordx4 a[184:187], v104, s[36:39], s53 offen offset:0 sc1
v_cvt_pk_bf16_f32 v33, v18, v19
v_mfma_f32_16x16x32_bf16 v[180:183], a[60:63], a[132:135], v[180:183]
v_cvt_pk_bf16_f32 v34, v20, v21
v_cvt_pk_bf16_f32 v35, v22, v23
v_mfma_f32_16x16x32_bf16 v[112:115], a[8:11], v[40:43], 0
v_rcp_f32 v121, v121
v_mfma_f32_16x16x32_bf16 v[176:179], a[60:63], a[128:131], v[176:179]
v_rcp_f32 v125, v125
v_mfma_f32_16x16x32_bf16 v[116:119], a[20:23], v[72:75], 0
v_mul_f32 v120, v120, v121
v_fmac_f32 v120, v124, v125
v_mfma_f32_16x16x32_bf16 v[16:19], a[0:3], v[40:43], 0
v_add_f32 v120, 0x358637bd, v120
v_mfma_f32_16x16x32_bf16 v[176:179], a[56:59], a[84:87], v[176:179]
s_waitcnt lgkmcnt(4)
v_rcp_f32 v120, v120
v_mfma_f32_16x16x32_bf16 v[24:27], a[12:15], v[72:75], 0
v_mul_f32 v121, v121, v120
v_mul_f32 v125, v125, v120
v_mfma_f32_16x16x32_bf16 v[20:23], a[4:7], v[40:43], 0
v_mul_f32 v48, v48, v121
v_mul_f32 v49, v49, v121
v_mfma_f32_16x16x32_bf16 v[28:31], a[16:19], v[72:75], 0
v_mul_f32 v50, v50, v121
v_mul_f32 v51, v51, v121
v_mfma_f32_16x16x32_bf16 v[192:195], a[32:35], a[84:87], v[192:195]
ds_read_b64_tr_b16 a[48:49], v1 offset:16384
buffer_load_dwordx4 a[116:119], v104, s[36:39], s53 offen offset:1024 sc1
v_mul_f32 v52, v52, v121
v_mfma_f32_16x16x32_bf16 v[192:195], a[36:39], a[128:131], v[192:195]
v_mul_f32 v53, v53, v121
v_mul_f32 v54, v54, v121
v_mfma_f32_16x16x32_bf16 v[196:199], a[36:39], a[132:135], v[196:199]
ds_read_b64_tr_b16 a[50:51], v1 offset:20480
ds_read_b64_tr_b16 a[52:53], v1 offset:24576
v_mfma_f32_16x16x32_bf16 v[196:199], a[32:35], a[88:91], v[196:199]
v_mul_f32 v55, v55, v121
v_fmac_f32 v48, v56, v125
v_mfma_f32_16x16x32_bf16 v[200:203], a[32:35], a[120:123], v[200:203]
ds_read_b64_tr_b16 a[54:55], v1 offset:28672
buffer_load_dwordx4 a[112:115], v105, s[36:39], s53 offen offset:0 sc1
v_fmac_f32 v49, v57, v125
v_mfma_f32_16x16x32_bf16 v[200:203], a[36:39], a[136:139], v[200:203]
v_fmac_f32 v50, v58, v125
v_fmac_f32 v51, v59, v125
v_mfma_f32_16x16x32_bf16 v[204:207], a[36:39], a[140:143], v[204:207]
v_fmac_f32 v52, v60, v125
v_fmac_f32 v53, v61, v125
v_mfma_f32_16x16x32_bf16 v[204:207], a[32:35], a[124:127], v[204:207]
s_waitcnt lgkmcnt(4)
v_fmac_f32 v54, v62, v125
v_fmac_f32 v55, v63, v125
v_mfma_f32_16x16x32_bf16 v[220:223], a[40:43], a[124:127], v[220:223]
ds_read_b64_tr_b16 a[56:57], v9 offset:16384
buffer_load_dwordx4 a[108:111], v105, s[36:39], s53 offen offset:1024 sc1
v_cvt_pk_bf16_f32 v36, v48, v49
v_mfma_f32_16x16x32_bf16 v[220:223], a[44:47], a[140:143], v[220:223]
s_add_u32 s53, s82, 32768
v_cvt_pk_bf16_f32 v37, v50, v51
v_cvt_pk_bf16_f32 v38, v52, v53
v_mfma_f32_16x16x32_bf16 v[216:219], a[44:47], a[136:139], v[216:219]
ds_read_b64_tr_b16 a[58:59], v9 offset:20480
ds_read_b64_tr_b16 a[60:61], v9 offset:24576
v_mfma_f32_16x16x32_bf16 v[216:219], a[40:43], a[120:123], v[216:219]
v_cvt_pk_bf16_f32 v39, v54, v55
v_mfma_f32_16x16x32_bf16 v[120:123], a[8:11], v[44:47], 0
v_rcp_f32 v113, v113
v_mfma_f32_16x16x32_bf16 v[212:215], a[40:43], a[88:91], v[212:215]
ds_read_b64_tr_b16 a[62:63], v9 offset:28672
buffer_load_dwordx4 a[68:71], v104, s[36:39], s53 offen offset:0 sc1
v_mfma_f32_16x16x32_bf16 v[212:215], a[44:47], a[132:135], v[212:215]
v_rcp_f32 v117, v117
v_mfma_f32_16x16x32_bf16 v[124:127], a[20:23], v[76:79], 0
v_mul_f32 v112, v112, v113
v_fmac_f32 v112, v116, v117
v_mfma_f32_16x16x32_bf16 v[48:51], a[0:3], v[44:47], 0
v_add_f32 v112, 0x358637bd, v112
v_mfma_f32_16x16x32_bf16 v[208:211], a[44:47], a[128:131], v[208:211]
v_rcp_f32 v112, v112
v_mfma_f32_16x16x32_bf16 v[56:59], a[12:15], v[76:79], 0
v_mul_f32 v113, v113, v112
v_mul_f32 v117, v117, v112
v_mfma_f32_16x16x32_bf16 v[52:55], a[4:7], v[44:47], 0
v_mul_f32 v16, v16, v113
v_mul_f32 v17, v17, v113
v_mfma_f32_16x16x32_bf16 v[60:63], a[16:19], v[76:79], 0
v_mul_f32 v18, v18, v113
v_mul_f32 v19, v19, v113
v_mfma_f32_16x16x32_bf16 v[208:211], a[40:43], a[84:87], v[208:211]
s_waitcnt lgkmcnt(4)
v_mul_f32 v20, v20, v113
v_mul_f32 v21, v21, v113
v_mfma_f32_16x16x32_bf16 v[224:227], a[48:51], a[84:87], v[224:227]
buffer_load_dwordx4 a[72:75], v104, s[36:39], s53 offen offset:1024 sc1
v_mul_f32 v22, v22, v113
v_mul_f32 v23, v23, v113
v_mfma_f32_16x16x32_bf16 v[224:227], a[52:55], a[128:131], v[224:227]
v_fmac_f32 v16, v24, v117
v_fmac_f32 v17, v25, v117
v_mfma_f32_16x16x32_bf16 v[228:231], a[52:55], a[132:135], v[228:231]
v_fmac_f32 v18, v26, v117
v_fmac_f32 v19, v27, v117
v_mfma_f32_16x16x32_bf16 v[228:231], a[48:51], a[88:91], v[228:231]
s_waitcnt lgkmcnt(0)
s_barrier
v_fmac_f32 v20, v28, v117
v_mfma_f32_16x16x32_bf16 v[232:235], a[48:51], a[120:123], v[232:235]
ds_read_b64_tr_b16 a[32:33], v96 offset:32768
buffer_load_dwordx4 a[76:79], v105, s[36:39], s53 offen offset:0 sc1
v_fmac_f32 v21, v29, v117
v_mfma_f32_16x16x32_bf16 v[232:235], a[52:55], a[136:139], v[232:235]
s_add_u32 m0, s90, 65536
ds_read_b64_tr_b16 a[34:35], v96 offset:36864
ds_read_b64_tr_b16 a[36:37], v96 offset:40960
v_mfma_f32_16x16x32_bf16 v[236:239], a[52:55], a[140:143], v[236:239]
s_add_u32 s54, s85, 131072
ds_read_b64_tr_b16 a[38:39], v96 offset:45056
v_fmac_f32 v22, v30, v117
v_mfma_f32_16x16x32_bf16 v[236:239], a[48:51], a[124:127], v[236:239]
v_fmac_f32 v23, v31, v117
v_cvt_pk_bf16_f32 v40, v16, v17
v_mfma_f32_16x16x32_bf16 v[252:255], a[56:59], a[124:127], v[252:255]
ds_read_b64_tr_b16 a[40:41], v97 offset:32768
buffer_load_dwordx4 v2, s[72:75], s54 offen lds
v_cvt_pk_bf16_f32 v41, v18, v19
v_mfma_f32_16x16x32_bf16 v[252:255], a[60:63], a[140:143], v[252:255]
s_add_u32 m0, s90, 66560
v_cvt_pk_bf16_f32 v42, v20, v21
v_cvt_pk_bf16_f32 v43, v22, v23
v_mfma_f32_16x16x32_bf16 v[248:251], a[60:63], a[136:139], v[248:251]
ds_read_b64_tr_b16 a[42:43], v97 offset:36864
ds_read_b64_tr_b16 a[44:45], v97 offset:40960
v_mfma_f32_16x16x32_bf16 v[248:251], a[56:59], a[120:123], v[248:251]
v_rcp_f32 v121, v121
v_mfma_f32_16x16x32_bf16 v[244:247], a[56:59], a[88:91], v[244:247]
ds_read_b64_tr_b16 a[46:47], v97 offset:45056
buffer_load_dwordx4 v3, s[72:75], s54 offen lds
v_mfma_f32_16x16x32_bf16 v[244:247], a[60:63], a[132:135], v[244:247]
s_add_u32 m0, s90, 67584
v_rcp_f32 v125, v125
v_mfma_f32_16x16x32_bf16 v[240:243], a[60:63], a[128:131], v[240:243]
v_mul_f32 v120, v120, v121
v_fmac_f32 v120, v124, v125
v_mfma_f32_16x16x32_bf16 v[240:243], a[56:59], a[84:87], v[240:243]
s_waitcnt vmcnt(33) lgkmcnt(4)
v_add_f32 v120, 0x358637bd, v120
v_mfma_f32_16x16x32_bf16 v[128:131], a[32:35], a[144:147], v[128:131]
ds_read_b64_tr_b16 a[48:49], v98 offset:32768
buffer_load_dwordx4 v4, s[72:75], s54 offen lds
v_mfma_f32_16x16x32_bf16 v[128:131], a[36:39], a[160:163], v[128:131]
v_rcp_f32 v120, v120
v_mfma_f32_16x16x32_bf16 v[132:135], a[36:39], a[164:167], v[132:135]
s_add_u32 m0, s90, 68608
ds_read_b64_tr_b16 a[50:51], v98 offset:36864
ds_read_b64_tr_b16 a[52:53], v98 offset:40960
v_mfma_f32_16x16x32_bf16 v[132:135], a[32:35], a[148:151], v[132:135]
v_mul_f32 v121, v121, v120
v_mul_f32 v125, v125, v120
v_mfma_f32_16x16x32_bf16 v[136:139], a[32:35], a[152:155], v[136:139]
ds_read_b64_tr_b16 a[54:55], v98 offset:45056
buffer_load_dwordx4 v5, s[72:75], s54 offen lds
v_mul_f32 v48, v48, v121
v_mfma_f32_16x16x32_bf16 v[136:139], a[36:39], a[168:171], v[136:139]
v_mul_f32 v49, v49, v121
v_mul_f32 v50, v50, v121
v_mfma_f32_16x16x32_bf16 v[140:143], a[36:39], a[172:175], v[140:143]
v_mul_f32 v51, v51, v121
v_mul_f32 v52, v52, v121
v_mfma_f32_16x16x32_bf16 v[140:143], a[32:35], a[156:159], v[140:143]
s_waitcnt lgkmcnt(4)
v_mul_f32 v53, v53, v121
v_mul_f32 v54, v54, v121
v_mfma_f32_16x16x32_bf16 v[156:159], a[40:43], a[156:159], v[156:159]
ds_read_b64_tr_b16 a[56:57], v99 offset:32768
buffer_load_dwordx4 a[80:83], v105, s[36:39], s53 offen offset:1024 sc1
v_mul_f32 v55, v55, v121
v_mfma_f32_16x16x32_bf16 v[156:159], a[44:47], a[172:175], v[156:159]
v_fmac_f32 v48, v56, v125
v_fmac_f32 v49, v57, v125
v_mfma_f32_16x16x32_bf16 v[152:155], a[44:47], a[168:171], v[152:155]
s_add_u32 s53, s82, 98304
ds_read_b64_tr_b16 a[58:59], v99 offset:36864
ds_read_b64_tr_b16 a[60:61], v99 offset:40960
v_mfma_f32_16x16x32_bf16 v[152:155], a[40:43], a[152:155], v[152:155]
v_fmac_f32 v50, v58, v125
v_fmac_f32 v51, v59, v125
v_mfma_f32_16x16x32_bf16 v[148:151], a[40:43], a[148:151], v[148:151]
ds_read_b64_tr_b16 a[62:63], v99 offset:45056
buffer_load_dwordx4 a[0:3], v104, s[36:39], s53 offen offset:0 sc1
v_fmac_f32 v52, v60, v125
v_mfma_f32_16x16x32_bf16 v[148:151], a[44:47], a[164:167], v[148:151]
v_fmac_f32 v53, v61, v125
v_fmac_f32 v54, v62, v125
v_mfma_f32_16x16x32_bf16 v[144:147], a[44:47], a[160:163], v[144:147]
v_fmac_f32 v55, v63, v125
v_cvt_pk_bf16_f32 v44, v48, v49
v_mfma_f32_16x16x32_bf16 v[144:147], a[40:43], a[144:147], v[144:147]
s_waitcnt lgkmcnt(4)
v_cvt_pk_bf16_f32 v45, v50, v51
v_cvt_pk_bf16_f32 v46, v52, v53
v_mfma_f32_16x16x32_bf16 v[160:163], a[48:51], a[144:147], v[160:163]
ds_read_b64_tr_b16 a[32:33], v106 offset:32768
v_cvt_pk_bf16_f32 v47, v54, v55
v_mfma_f32_16x16x32_bf16 v[160:163], a[52:55], a[160:163], v[160:163]
buffer_store_dwordx4 v[32:35], v104, s[40:43], s62 offen offset:0 sc1
buffer_store_dwordx4 v[36:39], v104, s[40:43], s62 offen offset:1024 sc1
v_mfma_f32_16x16x32_bf16 v[164:167], a[52:55], a[164:167], v[164:167]
ds_read_b64_tr_b16 a[34:35], v106 offset:36864
ds_read_b64_tr_b16 a[36:37], v106 offset:40960
v_mfma_f32_16x16x32_bf16 v[164:167], a[48:51], a[148:151], v[164:167]
buffer_store_dwordx4 v[40:43], v105, s[40:43], s62 offen offset:0 sc1
buffer_store_dwordx4 v[44:47], v105, s[40:43], s62 offen offset:1024 sc1
v_mfma_f32_16x16x32_bf16 v[168:171], a[48:51], a[152:155], v[168:171]
ds_read_b64_tr_b16 a[38:39], v106 offset:45056
v_lshrrev_b32 v14, 4, v0
v_mfma_f32_16x16x32_bf16 v[168:171], a[52:55], a[168:171], v[168:171]
v_lshrrev_b32 v15, 2, v0
v_and_b32 v13, 3, v0
v_mfma_f32_16x16x32_bf16 v[172:175], a[52:55], a[172:175], v[172:175]
v_lshlrev_b32 v13, 3, v13
v_bfe_u32 v12, v15, 1, 2
v_mfma_f32_16x16x32_bf16 v[172:175], a[48:51], a[156:159], v[172:175]
s_waitcnt lgkmcnt(4)
v_lshl_add_u32 v14, v15, 7, v13
v_lshl_add_u32 v14, v12, 5, v14
v_mfma_f32_16x16x32_bf16 v[188:191], a[56:59], a[156:159], v[188:191]
ds_read_b64_tr_b16 a[40:41], v111 offset:32768
v_add_u32 v88, 0x20000, v14
v_mfma_f32_16x16x32_bf16 v[188:191], a[60:63], a[172:175], v[188:191]
v_xor_b32 v89, 32, v88
v_xor_b32 v90, 64, v88
v_mfma_f32_16x16x32_bf16 v[184:187], a[60:63], a[168:171], v[184:187]
ds_read_b64_tr_b16 a[42:43], v111 offset:36864
ds_read_b64_tr_b16 a[44:45], v111 offset:40960
v_mfma_f32_16x16x32_bf16 v[184:187], a[56:59], a[152:155], v[184:187]
v_xor_b32 v91, 96, v88
v_min_u32 v12, 2, v0
v_mfma_f32_16x16x32_bf16 v[180:183], a[56:59], a[148:151], v[180:183]
ds_read_b64_tr_b16 a[46:47], v111 offset:45056
v_add_u32 v12, 1, v12
v_mfma_f32_16x16x32_bf16 v[180:183], a[60:63], a[164:167], v[180:183]
v_xor_b32 v12, s17, v12
v_lshlrev_b32 v11, 7, v12
v_mfma_f32_16x16x32_bf16 v[176:179], a[60:63], a[160:163], v[176:179]
v_accvgpr_read_b32 v112, a252
L_pad7:
s_cbranch_execz L_hopret0
v_accvgpr_read_b32 v113, a253
v_mfma_f32_16x16x32_bf16 v[176:179], a[56:59], a[144:147], v[176:179]
s_waitcnt lgkmcnt(4)
v_accvgpr_read_b32 v114, a254
v_accvgpr_read_b32 v115, a255
v_mfma_f32_16x16x32_bf16 v[192:195], a[32:35], a[144:147], v[192:195]
ds_read_b64_tr_b16 a[48:49], v1 offset:32768
v_accvgpr_read_b32 v116, a248
v_mfma_f32_16x16x32_bf16 v[192:195], a[36:39], a[160:163], v[192:195]
v_accvgpr_read_b32 v117, a249
v_accvgpr_read_b32 v118, a250
v_mfma_f32_16x16x32_bf16 v[196:199], a[36:39], a[164:167], v[196:199]
ds_read_b64_tr_b16 a[50:51], v1 offset:36864
ds_read_b64_tr_b16 a[52:53], v1 offset:40960
v_mfma_f32_16x16x32_bf16 v[196:199], a[32:35], a[148:151], v[196:199]
v_accvgpr_read_b32 v119, a251
v_accvgpr_read_b32 v120, a244
v_mfma_f32_16x16x32_bf16 v[200:203], a[32:35], a[152:155], v[200:203]
ds_read_b64_tr_b16 a[54:55], v1 offset:45056
v_accvgpr_read_b32 v121, a245
v_mfma_f32_16x16x32_bf16 v[200:203], a[36:39], a[168:171], v[200:203]
v_accvgpr_read_b32 v122, a246
v_accvgpr_read_b32 v123, a247
v_mfma_f32_16x16x32_bf16 v[204:207], a[36:39], a[172:175], v[204:207]
v_accvgpr_read_b32 v124, a240
v_accvgpr_read_b32 v125, a241
v_mfma_f32_16x16x32_bf16 v[204:207], a[32:35], a[156:159], v[204:207]
s_waitcnt lgkmcnt(4)
v_accvgpr_read_b32 v126, a242
v_accvgpr_read_b32 v127, a243
v_mfma_f32_16x16x32_bf16 v[220:223], a[40:43], a[156:159], v[220:223]
ds_read_b64_tr_b16 a[56:57], v9 offset:32768
v_mfma_f32_16x16x32_bf16 v[220:223], a[44:47], a[172:175], v[220:223]
v_permlane16_swap_b32 v112, v114
v_mfma_f32_16x16x32_bf16 v[216:219], a[44:47], a[168:171], v[216:219]
ds_read_b64_tr_b16 a[58:59], v9 offset:36864
ds_read_b64_tr_b16 a[60:61], v9 offset:40960
v_mfma_f32_16x16x32_bf16 v[216:219], a[40:43], a[152:155], v[216:219]
v_permlane16_swap_b32 v113, v115
v_mfma_f32_16x16x32_bf16 v[212:215], a[40:43], a[148:151], v[212:215]
ds_read_b64_tr_b16 a[62:63], v9 offset:45056
v_mfma_f32_16x16x32_bf16 v[212:215], a[44:47], a[164:167], v[212:215]
v_permlane16_swap_b32 v116, v118
v_mfma_f32_16x16x32_bf16 v[208:211], a[44:47], a[160:163], v[208:211]
v_permlane16_swap_b32 v117, v119
v_mfma_f32_16x16x32_bf16 v[208:211], a[40:43], a[144:147], v[208:211]
s_waitcnt lgkmcnt(4)
v_permlane16_swap_b32 v120, v122
v_mfma_f32_16x16x32_bf16 v[224:227], a[48:51], a[144:147], v[224:227]
v_permlane16_swap_b32 v121, v123
v_mfma_f32_16x16x32_bf16 v[224:227], a[52:55], a[160:163], v[224:227]
v_permlane16_swap_b32 v124, v126
v_mfma_f32_16x16x32_bf16 v[228:231], a[52:55], a[164:167], v[228:231]
v_permlane16_swap_b32 v125, v127
v_mfma_f32_16x16x32_bf16 v[228:231], a[48:51], a[148:151], v[228:231]
s_waitcnt vmcnt(36) lgkmcnt(0)
s_barrier
v_lshlrev_b32 v48, 16, v112
v_mfma_f32_16x16x32_bf16 v[232:235], a[48:51], a[152:155], v[232:235]
ds_read_b64_tr_b16 a[32:33], v96 offset:49152
v_and_b32 v49, 0xffff0000, v112
v_mfma_f32_16x16x32_bf16 v[232:235], a[52:55], a[168:171], v[232:235]
ds_read_b64_tr_b16 a[34:35], v96 offset:53248
ds_read_b64_tr_b16 a[36:37], v96 offset:57344
v_mfma_f32_16x16x32_bf16 v[236:239], a[52:55], a[172:175], v[236:239]
ds_read_b64_tr_b16 a[38:39], v96 offset:61440
v_lshlrev_b32 v50, 16, v113
v_mfma_f32_16x16x32_bf16 v[236:239], a[48:51], a[156:159], v[236:239]
v_and_b32 v51, 0xffff0000, v113
v_lshlrev_b32 v52, 16, v114
v_mfma_f32_16x16x32_bf16 v[252:255], a[56:59], a[156:159], v[252:255]
ds_read_b64_tr_b16 a[40:41], v97 offset:49152
v_and_b32 v53, 0xffff0000, v114
v_mfma_f32_16x16x32_bf16 v[252:255], a[60:63], a[172:175], v[252:255]
v_lshlrev_b32 v54, 16, v115
v_and_b32 v55, 0xffff0000, v115
v_mfma_f32_16x16x32_bf16 v[248:251], a[60:63], a[168:171], v[248:251]
ds_read_b64_tr_b16 a[42:43], v97 offset:53248
ds_read_b64_tr_b16 a[44:45], v97 offset:57344
v_mfma_f32_16x16x32_bf16 v[248:251], a[56:59], a[152:155], v[248:251]
v_lshlrev_b32 v56, 16, v116
v_and_b32 v57, 0xffff0000, v116
v_mfma_f32_16x16x32_bf16 v[244:247], a[56:59], a[148:151], v[244:247]
ds_read_b64_tr_b16 a[46:47], v97 offset:61440
v_lshlrev_b32 v58, 16, v117
v_mfma_f32_16x16x32_bf16 v[244:247], a[60:63], a[164:167], v[244:247]
v_and_b32 v59, 0xffff0000, v117
v_lshlrev_b32 v60, 16, v118
v_mfma_f32_16x16x32_bf16 v[240:243], a[60:63], a[160:163], v[240:243]
v_and_b32 v61, 0xffff0000, v118
v_lshlrev_b32 v62, 16, v119
v_mfma_f32_16x16x32_bf16 v[240:243], a[56:59], a[144:147], v[240:243]
s_waitcnt vmcnt(29) lgkmcnt(4)
v_and_b32 v63, 0xffff0000, v119
v_lshlrev_b32 v64, 16, v120
v_mfma_f32_16x16x32_bf16 v[128:131], a[32:35], a[188:191], v[128:131]
ds_read_b64_tr_b16 a[48:49], v98 offset:49152
v_and_b32 v65, 0xffff0000, v120
v_mfma_f32_16x16x32_bf16 v[128:131], a[36:39], a[204:207], v[128:131]
v_lshlrev_b32 v66, 16, v121
v_and_b32 v67, 0xffff0000, v121
v_mfma_f32_16x16x32_bf16 v[132:135], a[36:39], a[208:211], v[132:135]
ds_read_b64_tr_b16 a[50:51], v98 offset:53248
ds_read_b64_tr_b16 a[52:53], v98 offset:57344
v_mfma_f32_16x16x32_bf16 v[132:135], a[32:35], a[192:195], v[132:135]
v_lshlrev_b32 v68, 16, v122
v_and_b32 v69, 0xffff0000, v122
v_mfma_f32_16x16x32_bf16 v[136:139], a[32:35], a[196:199], v[136:139]
ds_read_b64_tr_b16 a[54:55], v98 offset:61440
buffer_load_dwordx4 a[4:7], v104, s[36:39], s53 offen offset:1024 sc1
v_mfma_f32_16x16x32_bf16 v[136:139], a[36:39], a[212:215], v[136:139]
s_add_u32 m0, s90, 81920
v_lshlrev_b32 v70, 16, v123
v_and_b32 v71, 0xffff0000, v123
v_mfma_f32_16x16x32_bf16 v[140:143], a[36:39], a[216:219], v[140:143]
s_add_u32 s54, s86, 131072
v_lshlrev_b32 v72, 16, v124
v_and_b32 v73, 0xffff0000, v124
v_mfma_f32_16x16x32_bf16 v[140:143], a[32:35], a[200:203], v[140:143]
s_waitcnt lgkmcnt(4)
v_lshlrev_b32 v74, 16, v125
v_and_b32 v75, 0xffff0000, v125
v_mfma_f32_16x16x32_bf16 v[156:159], a[40:43], a[200:203], v[156:159]
ds_read_b64_tr_b16 a[56:57], v99 offset:49152
buffer_load_dwordx4 v2, s[72:75], s54 offen lds
v_mfma_f32_16x16x32_bf16 v[156:159], a[44:47], a[216:219], v[156:159]
s_add_u32 m0, s90, 82944
v_lshlrev_b32 v76, 16, v126
v_and_b32 v77, 0xffff0000, v126
v_mfma_f32_16x16x32_bf16 v[152:155], a[44:47], a[212:215], v[152:155]
ds_read_b64_tr_b16 a[58:59], v99 offset:53248
ds_read_b64_tr_b16 a[60:61], v99 offset:57344
v_mfma_f32_16x16x32_bf16 v[152:155], a[40:43], a[196:199], v[152:155]
v_lshlrev_b32 v78, 16, v127
v_and_b32 v79, 0xffff0000, v127
v_mfma_f32_16x16x32_bf16 v[148:151], a[40:43], a[192:195], v[148:151]
s_xor_b32 s62, s17, 1
ds_read_b64_tr_b16 a[62:63], v99 offset:61440
buffer_load_dwordx4 v3, s[72:75], s54 offen lds
v_mfma_f32_16x16x32_bf16 v[148:151], a[44:47], a[208:211], v[148:151]
s_add_u32 m0, s90, 83968
s_mul_i32 s62, s62, 49152
s_add_u32 s62, s62, s96
v_mfma_f32_16x16x32_bf16 v[144:147], a[44:47], a[204:207], v[144:147]
s_add_u32 s60, s62, 0
s_xor_b32 s62, s17, 2
s_mul_i32 s62, s62, 49152
v_mfma_f32_16x16x32_bf16 v[144:147], a[40:43], a[188:191], v[144:147]
s_waitcnt lgkmcnt(4)
s_add_u32 s62, s62, s96
s_add_u32 s64, s62, 4096
v_mfma_f32_16x16x32_bf16 v[160:163], a[48:51], a[188:191], v[160:163]
s_xor_b32 s62, s17, 3
ds_read_b64_tr_b16 a[32:33], v106 offset:49152
buffer_load_dwordx4 v4, s[72:75], s54 offen lds
v_mfma_f32_16x16x32_bf16 v[160:163], a[52:55], a[204:207], v[160:163]
s_add_u32 m0, s90, 84992
s_mul_i32 s62, s62, 49152
s_add_u32 s62, s62, s96
v_mfma_f32_16x16x32_bf16 v[164:167], a[52:55], a[208:211], v[164:167]
s_waitcnt vmcnt(4)
s_barrier
ds_read_b64_tr_b16 a[34:35], v106 offset:53248
ds_read_b64_tr_b16 a[36:37], v106 offset:57344
v_mfma_f32_16x16x32_bf16 v[164:167], a[48:51], a[192:195], v[164:167]
s_add_u32 s52, s62, 8192
buffer_store_dword v100, v101, s[48:51], s70 offen offset:0 sc1
v_mfma_f32_16x16x32_bf16 v[168:171], a[48:51], a[196:199], v[168:171]
ds_read_b64_tr_b16 a[38:39], v106 offset:61440
buffer_load_dwordx4 v5, s[72:75], s54 offen lds
v_mfma_f32_16x16x32_bf16 v[168:171], a[52:55], a[212:215], v[168:171]
v_mfma_f32_16x16x32_bf16 v[172:175], a[52:55], a[216:219], v[172:175]
v_mfma_f32_16x16x32_bf16 v[172:175], a[48:51], a[200:203], v[172:175]
s_waitcnt lgkmcnt(4)
v_mfma_f32_16x16x32_bf16 v[188:191], a[56:59], a[200:203], v[188:191]
ds_read_b64_tr_b16 a[40:41], v111 offset:49152
v_mfma_f32_16x16x32_bf16 v[188:191], a[60:63], a[216:219], v[188:191]
buffer_load_dwordx4 a[8:11], v105, s[36:39], s53 offen offset:0 sc1
v_mfma_f32_16x16x32_bf16 v[184:187], a[60:63], a[212:215], v[184:187]
ds_read_b64_tr_b16 a[42:43], v111 offset:53248
ds_read_b64_tr_b16 a[44:45], v111 offset:57344
v_mfma_f32_16x16x32_bf16 v[184:187], a[56:59], a[196:199], v[184:187]
v_mfma_f32_16x16x32_bf16 v[180:183], a[56:59], a[192:195], v[180:183]
ds_read_b64_tr_b16 a[46:47], v111 offset:61440
v_mfma_f32_16x16x32_bf16 v[180:183], a[60:63], a[208:211], v[180:183]
buffer_load_dwordx4 a[12:15], v105, s[36:39], s53 offen offset:1024 sc1
v_mfma_f32_16x16x32_bf16 v[176:179], a[60:63], a[204:207], v[176:179]
v_mfma_f32_16x16x32_bf16 v[176:179], a[56:59], a[188:191], v[176:179]
s_waitcnt lgkmcnt(4)
s_add_u32 s53, s83, 32768
v_mfma_f32_16x16x32_bf16 v[192:195], a[32:35], a[188:191], v[192:195]
ds_read_b64_tr_b16 a[48:49], v1 offset:49152
v_mfma_f32_16x16x32_bf16 v[192:195], a[36:39], a[204:207], v[192:195]
buffer_load_dwordx4 a[16:19], v104, s[36:39], s53 offen offset:0 sc1
v_mfma_f32_16x16x32_bf16 v[196:199], a[36:39], a[208:211], v[196:199]
ds_read_b64_tr_b16 a[50:51], v1 offset:53248
ds_read_b64_tr_b16 a[52:53], v1 offset:57344
v_mfma_f32_16x16x32_bf16 v[196:199], a[32:35], a[192:195], v[196:199]
v_mfma_f32_16x16x32_bf16 v[200:203], a[32:35], a[196:199], v[200:203]
ds_read_b64_tr_b16 a[54:55], v1 offset:61440
v_mfma_f32_16x16x32_bf16 v[200:203], a[36:39], a[212:215], v[200:203]
v_mfma_f32_16x16x32_bf16 v[204:207], a[36:39], a[216:219], v[204:207]
buffer_load_dwordx4 a[20:23], v104, s[36:39], s53 offen offset:1024 sc1
v_mfma_f32_16x16x32_bf16 v[204:207], a[32:35], a[200:203], v[204:207]
s_waitcnt lgkmcnt(4)
v_mfma_f32_16x16x32_bf16 v[220:223], a[40:43], a[200:203], v[220:223]
ds_read_b64_tr_b16 a[56:57], v9 offset:49152
v_mfma_f32_16x16x32_bf16 v[220:223], a[44:47], a[216:219], v[220:223]
v_mfma_f32_16x16x32_bf16 v[216:219], a[44:47], a[212:215], v[216:219]
ds_read_b64_tr_b16 a[58:59], v9 offset:53248
ds_read_b64_tr_b16 a[60:61], v9 offset:57344
v_mfma_f32_16x16x32_bf16 v[216:219], a[40:43], a[196:199], v[216:219]
buffer_load_dwordx4 a[84:87], v105, s[36:39], s53 offen offset:0 sc1
v_mfma_f32_16x16x32_bf16 v[212:215], a[40:43], a[192:195], v[212:215]
ds_read_b64_tr_b16 a[62:63], v9 offset:61440
v_mfma_f32_16x16x32_bf16 v[212:215], a[44:47], a[208:211], v[212:215]
v_mfma_f32_16x16x32_bf16 v[208:211], a[44:47], a[204:207], v[208:211]
v_mfma_f32_16x16x32_bf16 v[208:211], a[40:43], a[188:191], v[208:211]
s_waitcnt lgkmcnt(4)
buffer_load_dwordx4 a[88:91], v105, s[36:39], s53 offen offset:1024 sc1
v_mfma_f32_16x16x32_bf16 v[224:227], a[48:51], a[188:191], v[224:227]
v_mfma_f32_16x16x32_bf16 v[224:227], a[52:55], a[204:207], v[224:227]
s_add_u32 s53, s83, 98304
v_mfma_f32_16x16x32_bf16 v[228:231], a[52:55], a[208:211], v[228:231]
v_mfma_f32_16x16x32_bf16 v[228:231], a[48:51], a[192:195], v[228:231]
s_waitcnt lgkmcnt(0)
s_barrier
buffer_load_dwordx4 a[120:123], v104, s[36:39], s53 offen offset:0 sc1
v_mfma_f32_16x16x32_bf16 v[232:235], a[48:51], a[196:199], v[232:235]
ds_read_b64_tr_b16 a[32:33], v96 offset:0
v_mfma_f32_16x16x32_bf16 v[232:235], a[52:55], a[212:215], v[232:235]
s_add_u32 m0, s90, 98304
ds_read_b64_tr_b16 a[34:35], v96 offset:4096
ds_read_b64_tr_b16 a[36:37], v96 offset:8192
v_mfma_f32_16x16x32_bf16 v[236:239], a[52:55], a[216:219], v[236:239]
s_add_u32 s54, s87, 131072
ds_read_b64_tr_b16 a[38:39], v96 offset:12288
v_mfma_f32_16x16x32_bf16 v[236:239], a[48:51], a[200:203], v[236:239]
buffer_load_dwordx4 v2, s[72:75], s54 offen lds
v_mfma_f32_16x16x32_bf16 v[252:255], a[56:59], a[200:203], v[252:255]
ds_read_b64_tr_b16 a[40:41], v97 offset:0
v_mfma_f32_16x16x32_bf16 v[252:255], a[60:63], a[216:219], v[252:255]
v_mfma_f32_16x16x32_bf16 v[248:251], a[60:63], a[212:215], v[248:251]
s_add_u32 m0, s90, 99328
ds_read_b64_tr_b16 a[42:43], v97 offset:4096
ds_read_b64_tr_b16 a[44:45], v97 offset:8192
v_mfma_f32_16x16x32_bf16 v[248:251], a[56:59], a[196:199], v[248:251]
v_mfma_f32_16x16x32_bf16 v[244:247], a[56:59], a[192:195], v[244:247]
ds_read_b64_tr_b16 a[46:47], v97 offset:12288
buffer_load_dwordx4 v3, s[72:75], s54 offen lds
v_mfma_f32_16x16x32_bf16 v[244:247], a[60:63], a[208:211], v[244:247]
v_mfma_f32_16x16x32_bf16 v[240:243], a[60:63], a[204:207], v[240:243]
s_add_u32 m0, s90, 100352
v_mfma_f32_16x16x32_bf16 v[240:243], a[56:59], a[188:191], v[240:243]
s_waitcnt lgkmcnt(4)
v_mfma_f32_16x16x32_bf16 v[128:131], a[32:35], a[104:107], v[128:131]
ds_read_b64_tr_b16 a[48:49], v98 offset:0
buffer_load_dwordx4 v4, s[72:75], s54 offen lds
v_mfma_f32_16x16x32_bf16 v[128:131], a[36:39], a[220:223], v[128:131]
v_mfma_f32_16x16x32_bf16 v[132:135], a[36:39], a[224:227], v[132:135]
ds_read_b64_tr_b16 a[50:51], v98 offset:4096
ds_read_b64_tr_b16 a[52:53], v98 offset:8192
v_mfma_f32_16x16x32_bf16 v[132:135], a[32:35], a[100:103], v[132:135]
s_add_u32 m0, s90, 101376
v_mfma_f32_16x16x32_bf16 v[136:139], a[32:35], a[96:99], v[136:139]
ds_read_b64_tr_b16 a[54:55], v98 offset:12288
v_mfma_f32_16x16x32_bf16 v[136:139], a[36:39], a[228:231], v[136:139]
buffer_load_dwordx4 v5, s[72:75], s54 offen lds
buffer_load_dword v103, v102, s[48:51], s69 offen offset:0 sc1
v_mfma_f32_16x16x32_bf16 v[140:143], a[36:39], a[232:235], v[140:143]
v_mfma_f32_16x16x32_bf16 v[140:143], a[32:35], a[92:95], v[140:143]
s_waitcnt lgkmcnt(4)
v_mfma_f32_16x16x32_bf16 v[156:159], a[40:43], a[92:95], v[156:159]
ds_read_b64_tr_b16 a[56:57], v99 offset:0
v_mfma_f32_16x16x32_bf16 v[156:159], a[44:47], a[232:235], v[156:159]
v_mfma_f32_16x16x32_bf16 v[152:155], a[44:47], a[228:231], v[152:155]
ds_read_b64_tr_b16 a[58:59], v99 offset:4096
ds_read_b64_tr_b16 a[60:61], v99 offset:8192
v_mfma_f32_16x16x32_bf16 v[152:155], a[40:43], a[96:99], v[152:155]
v_mfma_f32_16x16x32_bf16 v[148:151], a[40:43], a[100:103], v[148:151]
ds_read_b64_tr_b16 a[62:63], v99 offset:12288
v_mfma_f32_16x16x32_bf16 v[148:151], a[44:47], a[224:227], v[148:151]
buffer_load_dwordx4 a[124:127], v104, s[36:39], s53 offen offset:1024 sc1
v_mfma_f32_16x16x32_bf16 v[144:147], a[44:47], a[220:223], v[144:147]
v_mfma_f32_16x16x32_bf16 v[144:147], a[40:43], a[104:107], v[144:147]
s_waitcnt lgkmcnt(4)
v_mfma_f32_16x16x32_bf16 v[160:163], a[48:51], a[104:107], v[160:163]
ds_read_b64_tr_b16 a[32:33], v106 offset:0
v_mfma_f32_16x16x32_bf16 v[160:163], a[52:55], a[220:223], v[160:163]
v_mfma_f32_16x16x32_bf16 v[164:167], a[52:55], a[224:227], v[164:167]
ds_read_b64_tr_b16 a[34:35], v106 offset:4096
ds_read_b64_tr_b16 a[36:37], v106 offset:8192
v_mfma_f32_16x16x32_bf16 v[164:167], a[48:51], a[100:103], v[164:167]
buffer_load_dwordx4 a[128:131], v105, s[36:39], s53 offen offset:0 sc1
v_mfma_f32_16x16x32_bf16 v[168:171], a[48:51], a[96:99], v[168:171]
ds_read_b64_tr_b16 a[38:39], v106 offset:12288
v_mfma_f32_16x16x32_bf16 v[168:171], a[52:55], a[228:231], v[168:171]
v_mfma_f32_16x16x32_bf16 v[172:175], a[52:55], a[232:235], v[172:175]
buffer_load_dwordx4 a[132:135], v105, s[36:39], s53 offen offset:1024 sc1
v_mfma_f32_16x16x32_bf16 v[172:175], a[48:51], a[92:95], v[172:175]
s_waitcnt lgkmcnt(4)
v_mfma_f32_16x16x32_bf16 v[188:191], a[56:59], a[92:95], v[188:191]
ds_read_b64_tr_b16 a[40:41], v111 offset:0
v_mfma_f32_16x16x32_bf16 v[188:191], a[60:63], a[232:235], v[188:191]
s_add_u32 s53, s80, 49152
v_mfma_f32_16x16x32_bf16 v[184:187], a[60:63], a[228:231], v[184:187]
ds_read_b64_tr_b16 a[42:43], v111 offset:4096
ds_read_b64_tr_b16 a[44:45], v111 offset:8192
v_mfma_f32_16x16x32_bf16 v[184:187], a[56:59], a[96:99], v[184:187]
buffer_load_dwordx4 a[136:139], v104, s[36:39], s53 offen offset:0 sc1
v_mfma_f32_16x16x32_bf16 v[180:183], a[56:59], a[100:103], v[180:183]
ds_read_b64_tr_b16 a[46:47], v111 offset:12288
v_mfma_f32_16x16x32_bf16 v[180:183], a[60:63], a[224:227], v[180:183]
v_mfma_f32_16x16x32_bf16 v[176:179], a[60:63], a[220:223], v[176:179]
v_mfma_f32_16x16x32_bf16 v[176:179], a[56:59], a[104:107], v[176:179]
s_waitcnt lgkmcnt(4)
buffer_load_dwordx4 a[140:143], v104, s[36:39], s53 offen offset:1024 sc1
v_mfma_f32_16x16x32_bf16 v[192:195], a[32:35], a[104:107], v[192:195]
ds_read_b64_tr_b16 a[48:49], v1 offset:0
v_mfma_f32_16x16x32_bf16 v[192:195], a[36:39], a[220:223], v[192:195]
v_mfma_f32_16x16x32_bf16 v[196:199], a[36:39], a[224:227], v[196:199]
ds_read_b64_tr_b16 a[50:51], v1 offset:4096
ds_read_b64_tr_b16 a[52:53], v1 offset:8192
v_mfma_f32_16x16x32_bf16 v[196:199], a[32:35], a[100:103], v[196:199]
buffer_load_dwordx4 a[252:255], v105, s[36:39], s53 offen offset:0 sc1
v_mfma_f32_16x16x32_bf16 v[200:203], a[32:35], a[96:99], v[200:203]
ds_read_b64_tr_b16 a[54:55], v1 offset:12288
v_mfma_f32_16x16x32_bf16 v[200:203], a[36:39], a[228:231], v[200:203]
v_mfma_f32_16x16x32_bf16 v[204:207], a[36:39], a[232:235], v[204:207]
v_mfma_f32_16x16x32_bf16 v[204:207], a[32:35], a[92:95], v[204:207]
s_waitcnt lgkmcnt(4)
v_mfma_f32_16x16x32_bf16 v[220:223], a[40:43], a[92:95], v[220:223]
ds_read_b64_tr_b16 a[56:57], v9 offset:0
buffer_load_dwordx4 a[248:251], v105, s[36:39], s53 offen offset:1024 sc1
v_mfma_f32_16x16x32_bf16 v[220:223], a[44:47], a[232:235], v[220:223]
v_mfma_f32_16x16x32_bf16 v[216:219], a[44:47], a[228:231], v[216:219]
s_add_u32 s53, s81, 49152
ds_read_b64_tr_b16 a[58:59], v9 offset:4096
ds_read_b64_tr_b16 a[60:61], v9 offset:8192
v_mfma_f32_16x16x32_bf16 v[216:219], a[40:43], a[96:99], v[216:219]
v_mfma_f32_16x16x32_bf16 v[212:215], a[40:43], a[100:103], v[212:215]
ds_read_b64_tr_b16 a[62:63], v9 offset:12288
buffer_load_dwordx4 a[244:247], v104, s[36:39], s53 offen offset:0 sc1
v_mfma_f32_16x16x32_bf16 v[212:215], a[44:47], a[224:227], v[212:215]
v_mfma_f32_16x16x32_bf16 v[208:211], a[44:47], a[220:223], v[208:211]
v_mfma_f32_16x16x32_bf16 v[208:211], a[40:43], a[104:107], v[208:211]
s_waitcnt lgkmcnt(4)
v_mfma_f32_16x16x32_bf16 v[224:227], a[48:51], a[104:107], v[224:227]
v_mfma_f32_16x16x32_bf16 v[224:227], a[52:55], a[220:223], v[224:227]
buffer_load_dwordx4 a[240:243], v104, s[36:39], s53 offen offset:1024 sc1
v_mfma_f32_16x16x32_bf16 v[228:231], a[52:55], a[224:227], v[228:231]
v_mfma_f32_16x16x32_bf16 v[228:231], a[48:51], a[100:103], v[228:231]
s_waitcnt lgkmcnt(0)
s_barrier
v_mfma_f32_16x16x32_bf16 v[232:235], a[48:51], a[96:99], v[232:235]
ds_read_b64_tr_b16 a[32:33], v96 offset:16384
v_mfma_f32_16x16x32_bf16 v[232:235], a[52:55], a[228:231], v[232:235]
s_waitcnt vmcnt(9)
ds_read_b64_tr_b16 a[34:35], v96 offset:20480
ds_read_b64_tr_b16 a[36:37], v96 offset:24576
v_mfma_f32_16x16x32_bf16 v[236:239], a[52:55], a[232:235], v[236:239]
ds_read_b64_tr_b16 a[38:39], v96 offset:28672
buffer_load_dwordx4 a[144:147], v105, s[36:39], s53 offen offset:0 sc1
v_mfma_f32_16x16x32_bf16 v[236:239], a[48:51], a[92:95], v[236:239]
v_cmp_ne_u32 vcc, s9, v103
s_mov_b32 s16, 0
s_nop 0
s_cbranch_vccz L_po_ok
L_po:
buffer_load_dword v103, v102, s[48:51], s69 offen offset:0 sc1
s_waitcnt vmcnt(0)
v_cmp_ne_u32 vcc, s9, v103
s_add_u32 s16, s16, 1
s_nop 0
s_cbranch_vccz L_po_ok
s_cmp_lt_u32 s16, 0x100000
s_cbranch_scc1 L_po
L_po_ok:
v_mfma_f32_16x16x32_bf16 v[252:255], a[56:59], a[92:95], v[252:255]
s_add_u32 m0, s90, 49152
ds_read_b64_tr_b16 a[40:41], v97 offset:16384
s_add_u32 s54, s88, 0
v_mfma_f32_16x16x32_bf16 v[252:255], a[60:63], a[232:235], v[252:255]
s_barrier
buffer_load_dwordx4 v2, s[72:75], s54 offen lds
s_mov_b32 s76, s10
v_mfma_f32_16x16x32_bf16 v[248:251], a[60:63], a[228:231], v[248:251]
s_mov_b32 s77, s11
ds_read_b64_tr_b16 a[42:43], v97 offset:20480
ds_read_b64_tr_b16 a[44:45], v97 offset:24576
v_mfma_f32_16x16x32_bf16 v[248:251], a[56:59], a[96:99], v[248:251]
s_mov_b32 s78, 4194304
s_mov_b32 s79, 0x20000
s_lshl_b32 s61, s17, 7
v_mfma_f32_16x16x32_bf16 v[244:247], a[56:59], a[100:103], v[244:247]
s_add_u32 m0, s90, 50176
ds_read_b64_tr_b16 a[46:47], v97 offset:28672
s_add_u32 s54, s88, 8192
v_mfma_f32_16x16x32_bf16 v[244:247], a[60:63], a[224:227], v[244:247]
s_add_u32 s61, s61, s71
v_mfma_f32_16x16x32_bf16 v[240:243], a[60:63], a[220:223], v[240:243]
buffer_load_dwordx4 v3, s[72:75], s54 offen lds
v_mfma_f32_16x16x32_bf16 v[240:243], a[56:59], a[104:107], v[240:243]
s_waitcnt lgkmcnt(4)
v_mfma_f32_16x16x32_bf16 v[128:131], a[32:35], a[236:239], v[128:131]
s_add_u32 m0, s90, 51200
ds_read_b64_tr_b16 a[48:49], v98 offset:16384
s_add_u32 s54, s88, 212992
v_mfma_f32_16x16x32_bf16 v[128:131], a[36:39], a[184:187], v[128:131]
v_mfma_f32_16x16x32_bf16 v[132:135], a[36:39], a[116:119], v[132:135]
ds_read_b64_tr_b16 a[50:51], v98 offset:20480
ds_read_b64_tr_b16 a[52:53], v98 offset:24576
v_mfma_f32_16x16x32_bf16 v[132:135], a[32:35], a[64:67], v[132:135]
buffer_load_dwordx4 v4, s[72:75], s54 offen lds
v_mfma_f32_16x16x32_bf16 v[136:139], a[32:35], a[24:27], v[136:139]
ds_read_b64_tr_b16 a[54:55], v98 offset:28672
v_mfma_f32_16x16x32_bf16 v[136:139], a[36:39], a[112:115], v[136:139]
s_add_u32 m0, s90, 52224
s_add_u32 s54, s88, 221184
v_mfma_f32_16x16x32_bf16 v[140:143], a[36:39], a[108:111], v[140:143]
v_mfma_f32_16x16x32_bf16 v[140:143], a[32:35], a[28:31], v[140:143]
s_waitcnt lgkmcnt(4)
buffer_load_dwordx4 v5, s[72:75], s54 offen lds
v_mfma_f32_16x16x32_bf16 v[156:159], a[40:43], a[28:31], v[156:159]
ds_read_b64_tr_b16 a[56:57], v99 offset:16384
v_mfma_f32_16x16x32_bf16 v[156:159], a[44:47], a[108:111], v[156:159]
v_mfma_f32_16x16x32_bf16 v[152:155], a[44:47], a[112:115], v[152:155]
ds_read_b64_tr_b16 a[58:59], v99 offset:20480
ds_read_b64_tr_b16 a[60:61], v99 offset:24576
v_mfma_f32_16x16x32_bf16 v[152:155], a[40:43], a[24:27], v[152:155]
buffer_load_dwordx4 a[148:151], v105, s[36:39], s53 offen offset:1024 sc1
v_mfma_f32_16x16x32_bf16 v[148:151], a[40:43], a[64:67], v[148:151]
ds_read_b64_tr_b16 a[62:63], v99 offset:28672
v_mfma_f32_16x16x32_bf16 v[148:151], a[44:47], a[116:119], v[148:151]
s_add_u32 s53, s82, 49152
v_mfma_f32_16x16x32_bf16 v[144:147], a[44:47], a[184:187], v[144:147]
v_mfma_f32_16x16x32_bf16 v[144:147], a[40:43], a[236:239], v[144:147]
s_waitcnt lgkmcnt(4)
buffer_load_dwordx4 a[152:155], v104, s[36:39], s53 offen offset:0 sc1
v_mfma_f32_16x16x32_bf16 v[160:163], a[48:51], a[236:239], v[160:163]
ds_read_b64_tr_b16 a[32:33], v106 offset:16384
v_mfma_f32_16x16x32_bf16 v[160:163], a[52:55], a[184:187], v[160:163]
v_mfma_f32_16x16x32_bf16 v[164:167], a[52:55], a[116:119], v[164:167]
ds_read_b64_tr_b16 a[34:35], v106 offset:20480
ds_read_b64_tr_b16 a[36:37], v106 offset:24576
v_mfma_f32_16x16x32_bf16 v[164:167], a[48:51], a[64:67], v[164:167]
v_mfma_f32_16x16x32_bf16 v[168:171], a[48:51], a[24:27], v[168:171]
ds_read_b64_tr_b16 a[38:39], v106 offset:28672
buffer_load_dwordx4 a[156:159], v104, s[36:39], s53 offen offset:1024 sc1
v_mfma_f32_16x16x32_bf16 v[168:171], a[52:55], a[112:115], v[168:171]
v_mfma_f32_16x16x32_bf16 v[172:175], a[52:55], a[108:111], v[172:175]
v_mfma_f32_16x16x32_bf16 v[172:175], a[48:51], a[28:31], v[172:175]
s_waitcnt lgkmcnt(4)
v_mfma_f32_16x16x32_bf16 v[188:191], a[56:59], a[28:31], v[188:191]
ds_read_b64_tr_b16 a[40:41], v111 offset:16384
buffer_load_dwordx4 a[160:163], v105, s[36:39], s53 offen offset:0 sc1
v_mfma_f32_16x16x32_bf16 v[188:191], a[60:63], a[108:111], v[188:191]
v_mfma_f32_16x16x32_bf16 v[184:187], a[60:63], a[112:115], v[184:187]
ds_read_b64_tr_b16 a[42:43], v111 offset:20480
ds_read_b64_tr_b16 a[44:45], v111 offset:24576
v_mfma_f32_16x16x32_bf16 v[184:187], a[56:59], a[24:27], v[184:187]
v_mfma_f32_16x16x32_bf16 v[180:183], a[56:59], a[64:67], v[180:183]
ds_read_b64_tr_b16 a[46:47], v111 offset:28672
v_mfma_f32_16x16x32_bf16 v[180:183], a[60:63], a[116:119], v[180:183]
buffer_load_dwordx4 a[164:167], v105, s[36:39], s53 offen offset:1024 sc1
v_mfma_f32_16x16x32_bf16 v[176:179], a[60:63], a[184:187], v[176:179]
v_mfma_f32_16x16x32_bf16 v[176:179], a[56:59], a[236:239], v[176:179]
s_waitcnt lgkmcnt(4)
s_add_u32 s53, s83, 49152
v_mfma_f32_16x16x32_bf16 v[192:195], a[32:35], a[236:239], v[192:195]
ds_read_b64_tr_b16 a[48:49], v1 offset:16384
v_mfma_f32_16x16x32_bf16 v[192:195], a[36:39], a[184:187], v[192:195]
buffer_load_dwordx4 a[168:171], v104, s[36:39], s53 offen offset:0 sc1
v_mfma_f32_16x16x32_bf16 v[196:199], a[36:39], a[116:119], v[196:199]
ds_read_b64_tr_b16 a[50:51], v1 offset:20480
ds_read_b64_tr_b16 a[52:53], v1 offset:24576
v_mfma_f32_16x16x32_bf16 v[196:199], a[32:35], a[64:67], v[196:199]
v_mfma_f32_16x16x32_bf16 v[200:203], a[32:35], a[24:27], v[200:203]
ds_read_b64_tr_b16 a[54:55], v1 offset:28672
v_mfma_f32_16x16x32_bf16 v[200:203], a[36:39], a[112:115], v[200:203]
buffer_load_dwordx4 a[172:175], v104, s[36:39], s53 offen offset:1024 sc1
v_mfma_f32_16x16x32_bf16 v[204:207], a[36:39], a[108:111], v[204:207]
v_mfma_f32_16x16x32_bf16 v[204:207], a[32:35], a[28:31], v[204:207]
s_waitcnt lgkmcnt(4)
v_mfma_f32_16x16x32_bf16 v[220:223], a[40:43], a[28:31], v[220:223]
ds_read_b64_tr_b16 a[56:57], v9 offset:16384
v_mfma_f32_16x16x32_bf16 v[220:223], a[44:47], a[108:111], v[220:223]
v_mfma_f32_16x16x32_bf16 v[216:219], a[44:47], a[112:115], v[216:219]
ds_read_b64_tr_b16 a[58:59], v9 offset:20480
ds_read_b64_tr_b16 a[60:61], v9 offset:24576
v_mfma_f32_16x16x32_bf16 v[216:219], a[40:43], a[24:27], v[216:219]
buffer_load_dwordx4 a[188:191], v105, s[36:39], s53 offen offset:0 sc1
v_mfma_f32_16x16x32_bf16 v[212:215], a[40:43], a[64:67], v[212:215]
ds_read_b64_tr_b16 a[62:63], v9 offset:28672
v_mfma_f32_16x16x32_bf16 v[212:215], a[44:47], a[116:119], v[212:215]
v_mfma_f32_16x16x32_bf16 v[208:211], a[44:47], a[184:187], v[208:211]
buffer_load_dwordx4 a[192:195], v105, s[36:39], s53 offen offset:1024 sc1
v_mfma_f32_16x16x32_bf16 v[208:211], a[40:43], a[236:239], v[208:211]
s_waitcnt lgkmcnt(4)
v_mfma_f32_16x16x32_bf16 v[224:227], a[48:51], a[236:239], v[224:227]
v_mfma_f32_16x16x32_bf16 v[224:227], a[52:55], a[184:187], v[224:227]
s_add_u32 m0, s91, 122880
s_add_u32 s55, s93, 1441792
s_and_b32 s55, s55, 0x1fffff
v_mfma_f32_16x16x32_bf16 v[228:231], a[52:55], a[116:119], v[228:231]
v_mfma_f32_16x16x32_bf16 v[228:231], a[48:51], a[64:67], v[228:231]
s_waitcnt lgkmcnt(0)
s_barrier
buffer_load_dwordx4 v6, s[32:35], s55 offen lds
v_mfma_f32_16x16x32_bf16 v[232:235], a[48:51], a[24:27], v[232:235]
ds_read_b64_tr_b16 a[32:33], v96 offset:32768
v_mfma_f32_16x16x32_bf16 v[232:235], a[52:55], a[112:115], v[232:235]
s_add_u32 m0, s90, 65536
ds_read_b64_tr_b16 a[34:35], v96 offset:36864
ds_read_b64_tr_b16 a[36:37], v96 offset:40960
v_mfma_f32_16x16x32_bf16 v[236:239], a[52:55], a[108:111], v[236:239]
s_add_u32 s54, s89, 0
ds_read_b64_tr_b16 a[38:39], v96 offset:45056
v_mfma_f32_16x16x32_bf16 v[236:239], a[48:51], a[28:31], v[236:239]
buffer_load_dwordx4 v2, s[72:75], s54 offen lds
v_mfma_f32_16x16x32_bf16 v[252:255], a[56:59], a[28:31], v[252:255]
ds_read_b64_tr_b16 a[40:41], v97 offset:32768
v_mfma_f32_16x16x32_bf16 v[252:255], a[60:63], a[108:111], v[252:255]
s_add_u32 m0, s90, 66560
s_add_u32 s54, s89, 8192
v_mfma_f32_16x16x32_bf16 v[248:251], a[60:63], a[112:115], v[248:251]
ds_read_b64_tr_b16 a[42:43], v97 offset:36864
ds_read_b64_tr_b16 a[44:45], v97 offset:40960
v_mfma_f32_16x16x32_bf16 v[248:251], a[56:59], a[24:27], v[248:251]
buffer_load_dwordx4 v3, s[72:75], s54 offen lds
v_mfma_f32_16x16x32_bf16 v[244:247], a[56:59], a[64:67], v[244:247]
ds_read_b64_tr_b16 a[46:47], v97 offset:45056
v_mfma_f32_16x16x32_bf16 v[244:247], a[60:63], a[116:119], v[244:247]
v_mfma_f32_16x16x32_bf16 v[240:243], a[60:63], a[184:187], v[240:243]
s_add_u32 m0, s90, 67584
s_add_u32 s54, s89, 212992
v_mfma_f32_16x16x32_bf16 v[240:243], a[56:59], a[236:239], v[240:243]
s_waitcnt lgkmcnt(4)
v_mfma_f32_16x16x32_bf16 v[128:131], a[32:35], a[68:71], v[128:131]
ds_read_b64_tr_b16 a[48:49], v98 offset:32768
buffer_load_dwordx4 v4, s[72:75], s54 offen lds
v_mfma_f32_16x16x32_bf16 v[128:131], a[36:39], a[0:3], v[128:131]
v_mfma_f32_16x16x32_bf16 v[132:135], a[36:39], a[4:7], v[132:135]
s_add_u32 m0, s90, 68608
ds_read_b64_tr_b16 a[50:51], v98 offset:36864
ds_read_b64_tr_b16 a[52:53], v98 offset:40960
v_mfma_f32_16x16x32_bf16 v[132:135], a[32:35], a[72:75], v[132:135]
s_add_u32 s54, s89, 221184
v_mfma_f32_16x16x32_bf16 v[136:139], a[32:35], a[76:79], v[136:139]
ds_read_b64_tr_b16 a[54:55], v98 offset:45056
buffer_load_dwordx4 v5, s[72:75], s54 offen lds
v_mfma_f32_16x16x32_bf16 v[136:139], a[36:39], a[8:11], v[136:139]
v_mfma_f32_16x16x32_bf16 v[140:143], a[36:39], a[12:15], v[140:143]
v_mfma_f32_16x16x32_bf16 v[140:143], a[32:35], a[80:83], v[140:143]
s_waitcnt lgkmcnt(4)
s_add_u32 m0, s91, 123904
L_pad8:
s_cbranch_execz L_hopret0
v_mfma_f32_16x16x32_bf16 v[156:159], a[40:43], a[80:83], v[156:159]
ds_read_b64_tr_b16 a[56:57], v99 offset:32768
v_mfma_f32_16x16x32_bf16 v[156:159], a[44:47], a[12:15], v[156:159]
buffer_load_dwordx4 v7, s[32:35], s55 offen lds
v_mfma_f32_16x16x32_bf16 v[152:155], a[44:47], a[8:11], v[152:155]
ds_read_b64_tr_b16 a[58:59], v99 offset:36864
ds_read_b64_tr_b16 a[60:61], v99 offset:40960
v_mfma_f32_16x16x32_bf16 v[152:155], a[40:43], a[76:79], v[152:155]
s_add_u32 s56, s94, 0
s_and_b32 s56, s56, 0x7ffff
v_mfma_f32_16x16x32_bf16 v[148:151], a[40:43], a[72:75], v[148:151]
ds_read_b64_tr_b16 a[62:63], v99 offset:45056
v_mfma_f32_16x16x32_bf16 v[148:151], a[44:47], a[4:7], v[148:151]
buffer_load_dwordx4 a[196:199], v83, s[40:43], s56 offen offset:0 sc1
v_mfma_f32_16x16x32_bf16 v[144:147], a[44:47], a[0:3], v[144:147]
v_mfma_f32_16x16x32_bf16 v[144:147], a[40:43], a[68:71], v[144:147]
s_waitcnt lgkmcnt(4)
v_mfma_f32_16x16x32_bf16 v[160:163], a[48:51], a[68:71], v[160:163]
ds_read_b64_tr_b16 a[32:33], v106 offset:32768
v_mfma_f32_16x16x32_bf16 v[160:163], a[52:55], a[0:3], v[160:163]
buffer_load_dwordx4 a[200:203], v83, s[40:43], s56 offen offset:1024 sc1
v_mfma_f32_16x16x32_bf16 v[164:167], a[52:55], a[4:7], v[164:167]
ds_read_b64_tr_b16 a[34:35], v106 offset:36864
ds_read_b64_tr_b16 a[36:37], v106 offset:40960
v_mfma_f32_16x16x32_bf16 v[164:167], a[48:51], a[72:75], v[164:167]
v_mfma_f32_16x16x32_bf16 v[168:171], a[48:51], a[76:79], v[168:171]
s_add_u32 s56, s94, 16384
ds_read_b64_tr_b16 a[38:39], v106 offset:45056
s_and_b32 s56, s56, 0x7ffff
v_mfma_f32_16x16x32_bf16 v[168:171], a[52:55], a[8:11], v[168:171]
v_mfma_f32_16x16x32_bf16 v[172:175], a[52:55], a[12:15], v[172:175]
buffer_load_dwordx4 a[204:207], v83, s[40:43], s56 offen offset:0 sc1
v_mfma_f32_16x16x32_bf16 v[172:175], a[48:51], a[80:83], v[172:175]
s_waitcnt lgkmcnt(4)
v_mfma_f32_16x16x32_bf16 v[188:191], a[56:59], a[80:83], v[188:191]
ds_read_b64_tr_b16 a[40:41], v111 offset:32768
v_mfma_f32_16x16x32_bf16 v[188:191], a[60:63], a[12:15], v[188:191]
v_mfma_f32_16x16x32_bf16 v[184:187], a[60:63], a[8:11], v[184:187]
ds_read_b64_tr_b16 a[42:43], v111 offset:36864
ds_read_b64_tr_b16 a[44:45], v111 offset:40960
v_mfma_f32_16x16x32_bf16 v[184:187], a[56:59], a[76:79], v[184:187]
buffer_load_dwordx4 a[208:211], v83, s[40:43], s56 offen offset:1024 sc1
v_mfma_f32_16x16x32_bf16 v[180:183], a[56:59], a[72:75], v[180:183]
ds_read_b64_tr_b16 a[46:47], v111 offset:45056
v_mfma_f32_16x16x32_bf16 v[180:183], a[60:63], a[4:7], v[180:183]
s_add_u32 s56, s94, 32768
s_and_b32 s56, s56, 0x7ffff
v_mfma_f32_16x16x32_bf16 v[176:179], a[60:63], a[0:3], v[176:179]
v_mfma_f32_16x16x32_bf16 v[176:179], a[56:59], a[68:71], v[176:179]
s_waitcnt lgkmcnt(4)
buffer_load_dwordx4 a[212:215], v83, s[40:43], s56 offen offset:0 sc1
v_mfma_f32_16x16x32_bf16 v[192:195], a[32:35], a[68:71], v[192:195]
ds_read_b64_tr_b16 a[48:49], v1 offset:32768
v_mfma_f32_16x16x32_bf16 v[192:195], a[36:39], a[0:3], v[192:195]
v_mfma_f32_16x16x32_bf16 v[196:199], a[36:39], a[4:7], v[196:199]
ds_read_b64_tr_b16 a[50:51], v1 offset:36864
ds_read_b64_tr_b16 a[52:53], v1 offset:40960
v_mfma_f32_16x16x32_bf16 v[196:199], a[32:35], a[72:75], v[196:199]
buffer_load_dwordx4 a[216:219], v83, s[40:43], s56 offen offset:1024 sc1
v_mfma_f32_16x16x32_bf16 v[200:203], a[32:35], a[76:79], v[200:203]
ds_read_b64_tr_b16 a[54:55], v1 offset:45056
v_mfma_f32_16x16x32_bf16 v[200:203], a[36:39], a[8:11], v[200:203]
s_add_u32 s56, s94, 49152
s_and_b32 s56, s56, 0x7ffff
v_mfma_f32_16x16x32_bf16 v[204:207], a[36:39], a[12:15], v[204:207]
v_mfma_f32_16x16x32_bf16 v[204:207], a[32:35], a[80:83], v[204:207]
s_waitcnt lgkmcnt(4)
buffer_load_dwordx4 a[104:107], v83, s[40:43], s56 offen offset:0 sc1
v_mfma_f32_16x16x32_bf16 v[220:223], a[40:43], a[80:83], v[220:223]
ds_read_b64_tr_b16 a[56:57], v9 offset:32768
v_mfma_f32_16x16x32_bf16 v[220:223], a[44:47], a[12:15], v[220:223]
v_mfma_f32_16x16x32_bf16 v[216:219], a[44:47], a[8:11], v[216:219]
ds_read_b64_tr_b16 a[58:59], v9 offset:36864
ds_read_b64_tr_b16 a[60:61], v9 offset:40960
v_mfma_f32_16x16x32_bf16 v[216:219], a[40:43], a[76:79], v[216:219]
v_mfma_f32_16x16x32_bf16 v[212:215], a[40:43], a[72:75], v[212:215]
ds_read_b64_tr_b16 a[62:63], v9 offset:45056
buffer_load_dwordx4 a[100:103], v83, s[40:43], s56 offen offset:1024 sc1
v_mfma_f32_16x16x32_bf16 v[212:215], a[44:47], a[4:7], v[212:215]
v_mfma_f32_16x16x32_bf16 v[208:211], a[44:47], a[0:3], v[208:211]
s_add_u32 s56, s94, 65536
s_and_b32 s56, s56, 0x7ffff
v_mfma_f32_16x16x32_bf16 v[208:211], a[40:43], a[68:71], v[208:211]
s_waitcnt lgkmcnt(4)
v_mfma_f32_16x16x32_bf16 v[224:227], a[48:51], a[68:71], v[224:227]
buffer_load_dwordx4 a[96:99], v83, s[40:43], s56 offen offset:0 sc1
v_mfma_f32_16x16x32_bf16 v[224:227], a[52:55], a[0:3], v[224:227]
v_mfma_f32_16x16x32_bf16 v[228:231], a[52:55], a[4:7], v[228:231]
v_mfma_f32_16x16x32_bf16 v[228:231], a[48:51], a[72:75], v[228:231]
s_waitcnt vmcnt(10) lgkmcnt(0)
s_barrier
v_mfma_f32_16x16x32_bf16 v[232:235], a[48:51], a[76:79], v[232:235]
ds_read_b64_tr_b16 a[32:33], v106 offset:49152
v_mfma_f32_16x16x32_bf16 v[232:235], a[52:55], a[8:11], v[232:235]
ds_read_b64_tr_b16 a[34:35], v106 offset:53248
ds_read_b64_tr_b16 a[36:37], v106 offset:57344
v_mfma_f32_16x16x32_bf16 v[236:239], a[52:55], a[12:15], v[236:239]
ds_read_b64_tr_b16 a[38:39], v106 offset:61440
buffer_load_dwordx4 a[92:95], v83, s[40:43], s56 offen offset:1024 sc1
v_mfma_f32_16x16x32_bf16 v[236:239], a[48:51], a[80:83], v[236:239]
s_add_u32 m0, s91, 81920
s_add_u32 s55, s93, 1572864
s_and_b32 s55, s55, 0x1fffff
v_mfma_f32_16x16x32_bf16 v[252:255], a[56:59], a[80:83], v[252:255]
ds_read_b64_tr_b16 a[40:41], v106 offset:0
v_mfma_f32_16x16x32_bf16 v[252:255], a[60:63], a[12:15], v[252:255]
buffer_load_dwordx4 v6, s[32:35], s55 offen lds
v_mfma_f32_16x16x32_bf16 v[248:251], a[60:63], a[8:11], v[248:251]
ds_read_b64_tr_b16 a[42:43], v106 offset:4096
ds_read_b64_tr_b16 a[44:45], v106 offset:8192
v_mfma_f32_16x16x32_bf16 v[248:251], a[56:59], a[76:79], v[248:251]
s_add_u32 m0, s91, 82944
v_mfma_f32_16x16x32_bf16 v[244:247], a[56:59], a[72:75], v[244:247]
ds_read_b64_tr_b16 a[46:47], v106 offset:12288
v_mfma_f32_16x16x32_bf16 v[244:247], a[60:63], a[4:7], v[244:247]
buffer_load_dwordx4 v7, s[32:35], s55 offen lds
v_mfma_f32_16x16x32_bf16 v[240:243], a[60:63], a[0:3], v[240:243]
v_mfma_f32_16x16x32_bf16 v[240:243], a[56:59], a[68:71], v[240:243]
s_waitcnt lgkmcnt(4)
v_mfma_f32_16x16x32_bf16 v[192:195], a[32:35], a[16:19], v[192:195]
s_add_u32 m0, s91, 90112
ds_read_b64_tr_b16 a[48:49], v106 offset:16384
s_add_u32 s55, s93, 1703936
v_mfma_f32_16x16x32_bf16 v[192:195], a[36:39], a[120:123], v[192:195]
s_and_b32 s55, s55, 0x1fffff
v_mfma_f32_16x16x32_bf16 v[196:199], a[36:39], a[124:127], v[196:199]
ds_read_b64_tr_b16 a[50:51], v106 offset:20480
ds_read_b64_tr_b16 a[52:53], v106 offset:24576
v_mfma_f32_16x16x32_bf16 v[196:199], a[32:35], a[20:23], v[196:199]
buffer_load_dwordx4 v6, s[32:35], s55 offen lds
v_mfma_f32_16x16x32_bf16 v[200:203], a[32:35], a[84:87], v[200:203]
s_add_u32 m0, s91, 91136
ds_read_b64_tr_b16 a[54:55], v106 offset:28672
v_mfma_f32_16x16x32_bf16 v[200:203], a[36:39], a[128:131], v[200:203]
v_mfma_f32_16x16x32_bf16 v[204:207], a[36:39], a[132:135], v[204:207]
buffer_load_dwordx4 v7, s[32:35], s55 offen lds
v_mfma_f32_16x16x32_bf16 v[204:207], a[32:35], a[88:91], v[204:207]
s_waitcnt lgkmcnt(4)
v_mfma_f32_16x16x32_bf16 v[204:207], a[40:43], a[248:251], v[204:207]
ds_read_b64_tr_b16 a[56:57], v96 offset:49152
v_mfma_f32_16x16x32_bf16 v[204:207], a[44:47], a[148:151], v[204:207]
s_add_u32 s56, s94, 81920
s_and_b32 s56, s56, 0x7ffff
v_mfma_f32_16x16x32_bf16 v[200:203], a[44:47], a[144:147], v[200:203]
ds_read_b64_tr_b16 a[58:59], v96 offset:53248
ds_read_b64_tr_b16 a[60:61], v96 offset:57344
v_mfma_f32_16x16x32_bf16 v[200:203], a[40:43], a[252:255], v[200:203]
buffer_load_dwordx4 a[220:223], v83, s[40:43], s56 offen offset:0 sc1
v_mfma_f32_16x16x32_bf16 v[196:199], a[40:43], a[140:143], v[196:199]
ds_read_b64_tr_b16 a[62:63], v96 offset:61440
v_mfma_f32_16x16x32_bf16 v[196:199], a[44:47], a[240:243], v[196:199]
v_mfma_f32_16x16x32_bf16 v[192:195], a[44:47], a[244:247], v[192:195]
v_mfma_f32_16x16x32_bf16 v[192:195], a[40:43], a[136:139], v[192:195]
s_waitcnt lgkmcnt(4)
buffer_load_dwordx4 a[224:227], v83, s[40:43], s56 offen offset:1024 sc1
v_mfma_f32_16x16x32_bf16 v[192:195], a[48:51], a[152:155], v[192:195]
ds_read_b64_tr_b16 a[32:33], v96 offset:0
v_mfma_f32_16x16x32_bf16 v[192:195], a[52:55], a[168:171], v[192:195]
s_add_u32 s56, s94, 98304
s_and_b32 s56, s56, 0x7ffff
v_mfma_f32_16x16x32_bf16 v[196:199], a[52:55], a[172:175], v[196:199]
ds_read_b64_tr_b16 a[34:35], v96 offset:4096
ds_read_b64_tr_b16 a[36:37], v96 offset:8192
v_mfma_f32_16x16x32_bf16 v[196:199], a[48:51], a[156:159], v[196:199]
buffer_load_dwordx4 a[228:231], v83, s[40:43], s56 offen offset:0 sc1
v_mfma_f32_16x16x32_bf16 v[200:203], a[48:51], a[160:163], v[200:203]
ds_read_b64_tr_b16 a[38:39], v96 offset:12288
v_mfma_f32_16x16x32_bf16 v[200:203], a[52:55], a[188:191], v[200:203]
v_mfma_f32_16x16x32_bf16 v[204:207], a[52:55], a[192:195], v[204:207]
v_mfma_f32_16x16x32_bf16 v[204:207], a[48:51], a[164:167], v[204:207]
s_waitcnt lgkmcnt(4)
v_cvt_pk_bf16_f32 v192, v192, v193
v_cvt_pk_bf16_f32 v193, v194, v195
v_mfma_f32_16x16x32_bf16 v[140:143], a[56:59], a[88:91], v[140:143]
ds_read_b64_tr_b16 a[40:41], v96 offset:16384
buffer_load_dwordx4 a[232:235], v83, s[40:43], s56 offen offset:1024 sc1
v_mfma_f32_16x16x32_bf16 v[140:143], a[60:63], a[132:135], v[140:143]
v_cvt_pk_bf16_f32 v194, v196, v197
v_cvt_pk_bf16_f32 v195, v198, v199
v_mfma_f32_16x16x32_bf16 v[136:139], a[60:63], a[128:131], v[136:139]
s_add_u32 s56, s94, 114688
ds_read_b64_tr_b16 a[42:43], v96 offset:20480
ds_read_b64_tr_b16 a[44:45], v96 offset:24576
v_mfma_f32_16x16x32_bf16 v[136:139], a[56:59], a[84:87], v[136:139]
s_and_b32 s56, s56, 0x7ffff
buffer_store_dwordx4 v[192:195], v107, s[20:23], s60 offen offset:0 sc1
v_cvt_pk_bf16_f32 v200, v200, v201
v_mfma_f32_16x16x32_bf16 v[132:135], a[56:59], a[20:23], v[132:135]
ds_read_b64_tr_b16 a[46:47], v96 offset:28672
v_cvt_pk_bf16_f32 v201, v202, v203
v_mfma_f32_16x16x32_bf16 v[132:135], a[60:63], a[124:127], v[132:135]
v_cvt_pk_bf16_f32 v202, v204, v205
v_cvt_pk_bf16_f32 v203, v206, v207
v_mfma_f32_16x16x32_bf16 v[128:131], a[60:63], a[120:123], v[128:131]
v_mfma_f32_16x16x32_bf16 v[128:131], a[56:59], a[16:19], v[128:131]
s_waitcnt lgkmcnt(4)
v_mfma_f32_16x16x32_bf16 v[128:131], a[32:35], a[136:139], v[128:131]
ds_read_b64_tr_b16 a[48:49], v111 offset:49152
v_mfma_f32_16x16x32_bf16 v[128:131], a[36:39], a[244:247], v[128:131]
v_mfma_f32_16x16x32_bf16 v[132:135], a[36:39], a[240:243], v[132:135]
ds_read_b64_tr_b16 a[50:51], v111 offset:53248
ds_read_b64_tr_b16 a[52:53], v111 offset:57344
v_mfma_f32_16x16x32_bf16 v[132:135], a[32:35], a[140:143], v[132:135]
v_mfma_f32_16x16x32_bf16 v[136:139], a[32:35], a[252:255], v[136:139]
ds_read_b64_tr_b16 a[54:55], v111 offset:61440
buffer_load_dwordx4 a[236:239], v83, s[40:43], s56 offen offset:0 sc1
v_mfma_f32_16x16x32_bf16 v[136:139], a[36:39], a[144:147], v[136:139]
v_mfma_f32_16x16x32_bf16 v[140:143], a[36:39], a[148:151], v[140:143]
v_mfma_f32_16x16x32_bf16 v[140:143], a[32:35], a[248:251], v[140:143]
s_waitcnt lgkmcnt(4)
v_mfma_f32_16x16x32_bf16 v[140:143], a[40:43], a[164:167], v[140:143]
ds_read_b64_tr_b16 a[56:57], v111 offset:0
v_mfma_f32_16x16x32_bf16 v[140:143], a[44:47], a[192:195], v[140:143]
buffer_store_dwordx4 v[200:203], v107, s[20:23], s52 offen offset:0 sc1
buffer_load_dwordx4 a[64:67], v83, s[40:43], s56 offen offset:1024 sc1
v_mfma_f32_16x16x32_bf16 v[136:139], a[44:47], a[188:191], v[136:139]
ds_read_b64_tr_b16 a[58:59], v111 offset:4096
ds_read_b64_tr_b16 a[60:61], v111 offset:8192
v_mfma_f32_16x16x32_bf16 v[136:139], a[40:43], a[160:163], v[136:139]
v_mfma_f32_16x16x32_bf16 v[132:135], a[40:43], a[156:159], v[132:135]
ds_read_b64_tr_b16 a[62:63], v111 offset:12288
v_mfma_f32_16x16x32_bf16 v[132:135], a[44:47], a[172:175], v[132:135]
v_mfma_f32_16x16x32_bf16 v[128:131], a[44:47], a[168:171], v[128:131]
v_mfma_f32_16x16x32_bf16 v[128:131], a[40:43], a[152:155], v[128:131]
s_waitcnt lgkmcnt(4)
v_mfma_f32_16x16x32_bf16 v[208:211], a[48:51], a[16:19], v[208:211]
ds_read_b64_tr_b16 a[32:33], v111 offset:16384
v_cvt_pk_bf16_f32 v136, v136, v137
v_mfma_f32_16x16x32_bf16 v[208:211], a[52:55], a[120:123], v[208:211]
v_cvt_pk_bf16_f32 v137, v138, v139
v_cvt_pk_bf16_f32 v138, v140, v141
v_mfma_f32_16x16x32_bf16 v[212:215], a[52:55], a[124:127], v[212:215]
ds_read_b64_tr_b16 a[34:35], v111 offset:20480
ds_read_b64_tr_b16 a[36:37], v111 offset:24576
v_mfma_f32_16x16x32_bf16 v[212:215], a[48:51], a[20:23], v[212:215]
s_add_u32 s56, s94, 131072
v_cvt_pk_bf16_f32 v139, v142, v143
s_and_b32 s56, s56, 0x7ffff
v_mfma_f32_16x16x32_bf16 v[216:219], a[48:51], a[84:87], v[216:219]
ds_read_b64_tr_b16 a[38:39], v111 offset:28672
v_mfma_f32_16x16x32_bf16 v[216:219], a[52:55], a[128:131], v[216:219]
buffer_load_dwordx4 a[24:27], v83, s[40:43], s56 offen offset:0 sc1
v_mfma_f32_16x16x32_bf16 v[220:223], a[52:55], a[132:135], v[220:223]
v_mfma_f32_16x16x32_bf16 v[220:223], a[48:51], a[88:91], v[220:223]
s_waitcnt lgkmcnt(4)
v_mfma_f32_16x16x32_bf16 v[220:223], a[56:59], a[248:251], v[220:223]
ds_read_b64_tr_b16 a[40:41], v97 offset:49152
v_mfma_f32_16x16x32_bf16 v[220:223], a[60:63], a[148:151], v[220:223]
buffer_store_dwordx4 v[136:139], v107, s[20:23], s64 offen offset:0 sc1
buffer_load_dwordx4 a[28:31], v83, s[40:43], s56 offen offset:1024 sc1
v_mfma_f32_16x16x32_bf16 v[216:219], a[60:63], a[144:147], v[216:219]
ds_read_b64_tr_b16 a[42:43], v97 offset:53248
ds_read_b64_tr_b16 a[44:45], v97 offset:57344
v_mfma_f32_16x16x32_bf16 v[216:219], a[56:59], a[252:255], v[216:219]
v_mfma_f32_16x16x32_bf16 v[212:215], a[56:59], a[140:143], v[212:215]
ds_read_b64_tr_b16 a[46:47], v97 offset:61440
v_mfma_f32_16x16x32_bf16 v[212:215], a[60:63], a[240:243], v[212:215]
v_mfma_f32_16x16x32_bf16 v[208:211], a[60:63], a[244:247], v[208:211]
v_mfma_f32_16x16x32_bf16 v[208:211], a[56:59], a[136:139], v[208:211]
s_waitcnt lgkmcnt(4)
v_mfma_f32_16x16x32_bf16 v[208:211], a[32:35], a[152:155], v[208:211]
ds_read_b64_tr_b16 a[48:49], v97 offset:0
v_mfma_f32_16x16x32_bf16 v[208:211], a[36:39], a[168:171], v[208:211]
v_mfma_f32_16x16x32_bf16 v[212:215], a[36:39], a[172:175], v[212:215]
ds_read_b64_tr_b16 a[50:51], v97 offset:4096
ds_read_b64_tr_b16 a[52:53], v97 offset:8192
v_mfma_f32_16x16x32_bf16 v[212:215], a[32:35], a[156:159], v[212:215]
v_mfma_f32_16x16x32_bf16 v[216:219], a[32:35], a[160:163], v[216:219]
s_add_u32 s56, s94, 147456
ds_read_b64_tr_b16 a[54:55], v97 offset:12288
s_and_b32 s56, s56, 0x7ffff
v_mfma_f32_16x16x32_bf16 v[216:219], a[36:39], a[188:191], v[216:219]
v_mfma_f32_16x16x32_bf16 v[220:223], a[36:39], a[192:195], v[220:223]
buffer_load_dwordx4 a[184:187], v83, s[40:43], s56 offen offset:0 sc1
v_mfma_f32_16x16x32_bf16 v[220:223], a[32:35], a[164:167], v[220:223]
s_waitcnt lgkmcnt(4)
v_cvt_pk_bf16_f32 v208, v208, v209
v_cvt_pk_bf16_f32 v209, v210, v211
v_mfma_f32_16x16x32_bf16 v[156:159], a[40:43], a[88:91], v[156:159]
ds_read_b64_tr_b16 a[56:57], v97 offset:16384
v_cvt_pk_bf16_f32 v210, v212, v213
v_mfma_f32_16x16x32_bf16 v[156:159], a[44:47], a[132:135], v[156:159]
v_cvt_pk_bf16_f32 v211, v214, v215
v_cvt_pk_bf16_f32 v216, v216, v217
v_mfma_f32_16x16x32_bf16 v[152:155], a[44:47], a[128:131], v[152:155]
ds_read_b64_tr_b16 a[58:59], v97 offset:20480
ds_read_b64_tr_b16 a[60:61], v97 offset:24576
v_mfma_f32_16x16x32_bf16 v[152:155], a[40:43], a[84:87], v[152:155]
buffer_store_dwordx4 v[208:211], v107, s[20:23], s60 offen offset:1024 sc1
v_cvt_pk_bf16_f32 v217, v218, v219
v_mfma_f32_16x16x32_bf16 v[148:151], a[40:43], a[20:23], v[148:151]
ds_read_b64_tr_b16 a[62:63], v97 offset:28672
v_cvt_pk_bf16_f32 v218, v220, v221
v_mfma_f32_16x16x32_bf16 v[148:151], a[44:47], a[124:127], v[148:151]
v_cvt_pk_bf16_f32 v219, v222, v223
v_mfma_f32_16x16x32_bf16 v[144:147], a[44:47], a[120:123], v[144:147]
v_mfma_f32_16x16x32_bf16 v[144:147], a[40:43], a[16:19], v[144:147]
s_waitcnt lgkmcnt(4)
v_mfma_f32_16x16x32_bf16 v[144:147], a[48:51], a[136:139], v[144:147]
ds_read_b64_tr_b16 a[32:33], v1 offset:49152
v_mfma_f32_16x16x32_bf16 v[144:147], a[52:55], a[244:247], v[144:147]
v_mfma_f32_16x16x32_bf16 v[148:151], a[52:55], a[240:243], v[148:151]
ds_read_b64_tr_b16 a[34:35], v1 offset:53248
ds_read_b64_tr_b16 a[36:37], v1 offset:57344
v_mfma_f32_16x16x32_bf16 v[148:151], a[48:51], a[140:143], v[148:151]
buffer_load_dwordx4 a[116:119], v83, s[40:43], s56 offen offset:1024 sc1
v_mfma_f32_16x16x32_bf16 v[152:155], a[48:51], a[252:255], v[152:155]
ds_read_b64_tr_b16 a[38:39], v1 offset:61440
v_mfma_f32_16x16x32_bf16 v[152:155], a[52:55], a[144:147], v[152:155]
s_add_u32 s56, s94, 163840
s_and_b32 s56, s56, 0x7ffff
v_mfma_f32_16x16x32_bf16 v[156:159], a[52:55], a[148:151], v[156:159]
v_mfma_f32_16x16x32_bf16 v[156:159], a[48:51], a[248:251], v[156:159]
s_waitcnt lgkmcnt(4)
buffer_load_dwordx4 a[112:115], v83, s[40:43], s56 offen offset:0 sc1
v_mfma_f32_16x16x32_bf16 v[156:159], a[56:59], a[164:167], v[156:159]
ds_read_b64_tr_b16 a[40:41], v1 offset:0
v_mfma_f32_16x16x32_bf16 v[156:159], a[60:63], a[192:195], v[156:159]
buffer_store_dwordx4 v[216:219], v107, s[20:23], s52 offen offset:1024 sc1
v_mfma_f32_16x16x32_bf16 v[152:155], a[60:63], a[188:191], v[152:155]
ds_read_b64_tr_b16 a[42:43], v1 offset:4096
ds_read_b64_tr_b16 a[44:45], v1 offset:8192
v_mfma_f32_16x16x32_bf16 v[152:155], a[56:59], a[160:163], v[152:155]
v_mfma_f32_16x16x32_bf16 v[148:151], a[56:59], a[156:159], v[148:151]
ds_read_b64_tr_b16 a[46:47], v1 offset:12288
v_mfma_f32_16x16x32_bf16 v[148:151], a[60:63], a[172:175], v[148:151]
v_mfma_f32_16x16x32_bf16 v[144:147], a[60:63], a[168:171], v[144:147]
v_mfma_f32_16x16x32_bf16 v[144:147], a[56:59], a[152:155], v[144:147]
s_waitcnt lgkmcnt(4)
v_mfma_f32_16x16x32_bf16 v[224:227], a[32:35], a[16:19], v[224:227]
ds_read_b64_tr_b16 a[48:49], v1 offset:16384
v_cvt_pk_bf16_f32 v152, v152, v153
v_mfma_f32_16x16x32_bf16 v[224:227], a[36:39], a[120:123], v[224:227]
v_cvt_pk_bf16_f32 v153, v154, v155
v_cvt_pk_bf16_f32 v154, v156, v157
v_mfma_f32_16x16x32_bf16 v[228:231], a[36:39], a[124:127], v[228:231]
ds_read_b64_tr_b16 a[50:51], v1 offset:20480
ds_read_b64_tr_b16 a[52:53], v1 offset:24576
v_mfma_f32_16x16x32_bf16 v[228:231], a[32:35], a[20:23], v[228:231]
v_cvt_pk_bf16_f32 v155, v158, v159
v_mfma_f32_16x16x32_bf16 v[232:235], a[32:35], a[84:87], v[232:235]
ds_read_b64_tr_b16 a[54:55], v1 offset:28672
buffer_load_dwordx4 a[108:111], v83, s[40:43], s56 offen offset:1024 sc1
v_mfma_f32_16x16x32_bf16 v[232:235], a[36:39], a[128:131], v[232:235]
s_add_u32 s56, s94, 180224
s_and_b32 s56, s56, 0x7ffff
v_mfma_f32_16x16x32_bf16 v[236:239], a[36:39], a[132:135], v[236:239]
v_mfma_f32_16x16x32_bf16 v[236:239], a[32:35], a[88:91], v[236:239]
s_waitcnt lgkmcnt(4)
buffer_load_dwordx4 a[68:71], v83, s[40:43], s56 offen offset:0 sc1
v_mfma_f32_16x16x32_bf16 v[236:239], a[40:43], a[248:251], v[236:239]
ds_read_b64_tr_b16 a[56:57], v98 offset:49152
v_mfma_f32_16x16x32_bf16 v[236:239], a[44:47], a[148:151], v[236:239]
buffer_store_dwordx4 v[152:155], v107, s[20:23], s64 offen offset:1024 sc1
s_mul_i32 s58, s17, 49152
v_mfma_f32_16x16x32_bf16 v[232:235], a[44:47], a[144:147], v[232:235]
s_add_u32 s58, s58, s96
ds_read_b64_tr_b16 a[58:59], v98 offset:53248
ds_read_b64_tr_b16 a[60:61], v98 offset:57344
v_mfma_f32_16x16x32_bf16 v[232:235], a[40:43], a[252:255], v[232:235]
s_add_u32 s59, s58, 4096
s_add_u32 s57, s58, 8192
v_mfma_f32_16x16x32_bf16 v[228:231], a[40:43], a[140:143], v[228:231]
ds_read_b64_tr_b16 a[62:63], v98 offset:61440
v_mfma_f32_16x16x32_bf16 v[228:231], a[44:47], a[240:243], v[228:231]
v_mfma_f32_16x16x32_bf16 v[224:227], a[44:47], a[244:247], v[224:227]
v_mfma_f32_16x16x32_bf16 v[224:227], a[40:43], a[136:139], v[224:227]
s_waitcnt lgkmcnt(4)
v_mfma_f32_16x16x32_bf16 v[224:227], a[48:51], a[152:155], v[224:227]
ds_read_b64_tr_b16 a[32:33], v98 offset:0
v_mfma_f32_16x16x32_bf16 v[224:227], a[52:55], a[168:171], v[224:227]
v_mfma_f32_16x16x32_bf16 v[228:231], a[52:55], a[172:175], v[228:231]
ds_read_b64_tr_b16 a[34:35], v98 offset:4096
ds_read_b64_tr_b16 a[36:37], v98 offset:8192
v_mfma_f32_16x16x32_bf16 v[228:231], a[48:51], a[156:159], v[228:231]
v_mfma_f32_16x16x32_bf16 v[232:235], a[48:51], a[160:163], v[232:235]
ds_read_b64_tr_b16 a[38:39], v98 offset:12288
buffer_load_dwordx4 a[72:75], v83, s[40:43], s56 offen offset:1024 sc1
v_mfma_f32_16x16x32_bf16 v[232:235], a[52:55], a[188:191], v[232:235]
v_mfma_f32_16x16x32_bf16 v[236:239], a[52:55], a[192:195], v[236:239]
s_add_u32 s56, s94, 196608
s_and_b32 s56, s56, 0x7ffff
v_mfma_f32_16x16x32_bf16 v[236:239], a[48:51], a[164:167], v[236:239]
s_waitcnt lgkmcnt(4)
v_cvt_pk_bf16_f32 v224, v224, v225
v_cvt_pk_bf16_f32 v225, v226, v227
v_mfma_f32_16x16x32_bf16 v[172:175], a[56:59], a[88:91], v[172:175]
ds_read_b64_tr_b16 a[40:41], v98 offset:16384
buffer_load_dwordx4 a[76:79], v83, s[40:43], s56 offen offset:0 sc1
v_mfma_f32_16x16x32_bf16 v[172:175], a[60:63], a[132:135], v[172:175]
v_cvt_pk_bf16_f32 v226, v228, v229
v_cvt_pk_bf16_f32 v227, v230, v231
v_mfma_f32_16x16x32_bf16 v[168:171], a[60:63], a[128:131], v[168:171]
ds_read_b64_tr_b16 a[42:43], v98 offset:20480
ds_read_b64_tr_b16 a[44:45], v98 offset:24576
v_mfma_f32_16x16x32_bf16 v[168:171], a[56:59], a[84:87], v[168:171]
buffer_store_dwordx4 v[224:227], v107, s[20:23], s60 offen offset:2048 sc1
v_cvt_pk_bf16_f32 v232, v232, v233
v_mfma_f32_16x16x32_bf16 v[164:167], a[56:59], a[20:23], v[164:167]
ds_read_b64_tr_b16 a[46:47], v98 offset:28672
v_cvt_pk_bf16_f32 v233, v234, v235
v_mfma_f32_16x16x32_bf16 v[164:167], a[60:63], a[124:127], v[164:167]
v_cvt_pk_bf16_f32 v234, v236, v237
v_cvt_pk_bf16_f32 v235, v238, v239
v_mfma_f32_16x16x32_bf16 v[160:163], a[60:63], a[120:123], v[160:163]
v_mfma_f32_16x16x32_bf16 v[160:163], a[56:59], a[16:19], v[160:163]
s_waitcnt lgkmcnt(4)
v_mfma_f32_16x16x32_bf16 v[160:163], a[32:35], a[136:139], v[160:163]
ds_read_b64_tr_b16 a[48:49], v9 offset:49152
v_mfma_f32_16x16x32_bf16 v[160:163], a[36:39], a[244:247], v[160:163]
v_mfma_f32_16x16x32_bf16 v[164:167], a[36:39], a[240:243], v[164:167]
ds_read_b64_tr_b16 a[50:51], v9 offset:53248
ds_read_b64_tr_b16 a[52:53], v9 offset:57344
v_mfma_f32_16x16x32_bf16 v[164:167], a[32:35], a[140:143], v[164:167]
v_mfma_f32_16x16x32_bf16 v[168:171], a[32:35], a[252:255], v[168:171]
ds_read_b64_tr_b16 a[54:55], v9 offset:61440
v_mfma_f32_16x16x32_bf16 v[168:171], a[36:39], a[144:147], v[168:171]
buffer_load_dwordx4 a[80:83], v83, s[40:43], s56 offen offset:1024 sc1
v_mfma_f32_16x16x32_bf16 v[172:175], a[36:39], a[148:151], v[172:175]
v_mfma_f32_16x16x32_bf16 v[172:175], a[32:35], a[248:251], v[172:175]
s_waitcnt lgkmcnt(4)
s_add_u32 s56, s94, 212992
s_and_b32 s56, s56, 0x7ffff
v_mfma_f32_16x16x32_bf16 v[172:175], a[40:43], a[164:167], v[172:175]
ds_read_b64_tr_b16 a[56:57], v9 offset:0
v_mfma_f32_16x16x32_bf16 v[172:175], a[44:47], a[192:195], v[172:175]
buffer_store_dwordx4 v[232:235], v107, s[20:23], s52 offen offset:2048 sc1
buffer_load_dwordx4 a[0:3], v83, s[40:43], s56 offen offset:0 sc1
v_mfma_f32_16x16x32_bf16 v[168:171], a[44:47], a[188:191], v[168:171]
ds_read_b64_tr_b16 a[58:59], v9 offset:4096
ds_read_b64_tr_b16 a[60:61], v9 offset:8192
v_mfma_f32_16x16x32_bf16 v[168:171], a[40:43], a[160:163], v[168:171]
v_mfma_f32_16x16x32_bf16 v[164:167], a[40:43], a[156:159], v[164:167]
ds_read_b64_tr_b16 a[62:63], v9 offset:12288
v_mfma_f32_16x16x32_bf16 v[164:167], a[44:47], a[172:175], v[164:167]
v_mfma_f32_16x16x32_bf16 v[160:163], a[44:47], a[168:171], v[160:163]
v_mfma_f32_16x16x32_bf16 v[160:163], a[40:43], a[152:155], v[160:163]
s_waitcnt lgkmcnt(4)
v_mfma_f32_16x16x32_bf16 v[240:243], a[48:51], a[16:19], v[240:243]
ds_read_b64_tr_b16 a[32:33], v9 offset:16384
v_cvt_pk_bf16_f32 v168, v168, v169
v_mfma_f32_16x16x32_bf16 v[240:243], a[52:55], a[120:123], v[240:243]
v_cvt_pk_bf16_f32 v169, v170, v171
v_cvt_pk_bf16_f32 v170, v172, v173
v_mfma_f32_16x16x32_bf16 v[244:247], a[52:55], a[124:127], v[244:247]
ds_read_b64_tr_b16 a[34:35], v9 offset:20480
ds_read_b64_tr_b16 a[36:37], v9 offset:24576
v_mfma_f32_16x16x32_bf16 v[244:247], a[48:51], a[20:23], v[244:247]
v_cvt_pk_bf16_f32 v171, v174, v175
v_mfma_f32_16x16x32_bf16 v[248:251], a[48:51], a[84:87], v[248:251]
ds_read_b64_tr_b16 a[38:39], v9 offset:28672
v_mfma_f32_16x16x32_bf16 v[248:251], a[52:55], a[128:131], v[248:251]
buffer_load_dwordx4 a[4:7], v83, s[40:43], s56 offen offset:1024 sc1
v_mfma_f32_16x16x32_bf16 v[252:255], a[52:55], a[132:135], v[252:255]
v_mfma_f32_16x16x32_bf16 v[252:255], a[48:51], a[88:91], v[252:255]
s_waitcnt lgkmcnt(4)
v_mfma_f32_16x16x32_bf16 v[252:255], a[56:59], a[248:251], v[252:255]
s_add_u32 s56, s94, 229376
ds_read_b64_tr_b16 a[40:41], v99 offset:49152
s_and_b32 s56, s56, 0x7ffff
v_mfma_f32_16x16x32_bf16 v[252:255], a[60:63], a[148:151], v[252:255]
buffer_store_dwordx4 v[168:171], v107, s[20:23], s64 offen offset:2048 sc1
v_mfma_f32_16x16x32_bf16 v[248:251], a[60:63], a[144:147], v[248:251]
ds_read_b64_tr_b16 a[42:43], v99 offset:53248
ds_read_b64_tr_b16 a[44:45], v99 offset:57344
v_mfma_f32_16x16x32_bf16 v[248:251], a[56:59], a[252:255], v[248:251]
v_mfma_f32_16x16x32_bf16 v[244:247], a[56:59], a[140:143], v[244:247]
ds_read_b64_tr_b16 a[46:47], v99 offset:61440
v_mfma_f32_16x16x32_bf16 v[244:247], a[60:63], a[240:243], v[244:247]
v_mfma_f32_16x16x32_bf16 v[240:243], a[60:63], a[244:247], v[240:243]
v_mfma_f32_16x16x32_bf16 v[240:243], a[56:59], a[136:139], v[240:243]
s_waitcnt lgkmcnt(4)
v_mfma_f32_16x16x32_bf16 v[240:243], a[32:35], a[152:155], v[240:243]
ds_read_b64_tr_b16 a[48:49], v99 offset:0
v_mfma_f32_16x16x32_bf16 v[240:243], a[36:39], a[168:171], v[240:243]
s_waitcnt vmcnt(8)
buffer_store_dword v100, v101, s[48:51], s61 offen offset:0 sc1
v_mfma_f32_16x16x32_bf16 v[244:247], a[36:39], a[172:175], v[244:247]
ds_read_b64_tr_b16 a[50:51], v99 offset:4096
ds_read_b64_tr_b16 a[52:53], v99 offset:8192
v_mfma_f32_16x16x32_bf16 v[244:247], a[32:35], a[156:159], v[244:247]
buffer_load_dwordx4 a[8:11], v83, s[40:43], s56 offen offset:0 sc1
v_mfma_f32_16x16x32_bf16 v[248:251], a[32:35], a[160:163], v[248:251]
ds_read_b64_tr_b16 a[54:55], v99 offset:12288
v_mfma_f32_16x16x32_bf16 v[248:251], a[36:39], a[188:191], v[248:251]
v_mfma_f32_16x16x32_bf16 v[252:255], a[36:39], a[192:195], v[252:255]
v_mfma_f32_16x16x32_bf16 v[252:255], a[32:35], a[164:167], v[252:255]
s_waitcnt lgkmcnt(4)
buffer_load_dwordx4 a[12:15], v83, s[40:43], s56 offen offset:1024 sc1
v_cvt_pk_bf16_f32 v240, v240, v241
v_mfma_f32_16x16x32_bf16 v[188:191], a[40:43], a[88:91], v[188:191]
ds_read_b64_tr_b16 a[56:57], v99 offset:16384
v_cvt_pk_bf16_f32 v241, v242, v243
v_mfma_f32_16x16x32_bf16 v[188:191], a[44:47], a[132:135], v[188:191]
v_cvt_pk_bf16_f32 v242, v244, v245
v_cvt_pk_bf16_f32 v243, v246, v247
v_mfma_f32_16x16x32_bf16 v[184:187], a[44:47], a[128:131], v[184:187]
ds_read_b64_tr_b16 a[58:59], v99 offset:20480
ds_read_b64_tr_b16 a[60:61], v99 offset:24576
v_mfma_f32_16x16x32_bf16 v[184:187], a[40:43], a[84:87], v[184:187]
buffer_store_dwordx4 v[240:243], v107, s[20:23], s60 offen offset:3072 sc1
v_cvt_pk_bf16_f32 v248, v248, v249
v_mfma_f32_16x16x32_bf16 v[180:183], a[40:43], a[20:23], v[180:183]
ds_read_b64_tr_b16 a[62:63], v99 offset:28672
v_cvt_pk_bf16_f32 v249, v250, v251
v_mfma_f32_16x16x32_bf16 v[180:183], a[44:47], a[124:127], v[180:183]
v_cvt_pk_bf16_f32 v250, v252, v253
v_cvt_pk_bf16_f32 v251, v254, v255
v_mfma_f32_16x16x32_bf16 v[176:179], a[44:47], a[120:123], v[176:179]
v_mfma_f32_16x16x32_bf16 v[176:179], a[40:43], a[16:19], v[176:179]
s_waitcnt lgkmcnt(4)
v_mfma_f32_16x16x32_bf16 v[176:179], a[48:51], a[136:139], v[176:179]
v_mfma_f32_16x16x32_bf16 v[176:179], a[52:55], a[244:247], v[176:179]
v_mfma_f32_16x16x32_bf16 v[180:183], a[52:55], a[240:243], v[180:183]
s_add_u32 s56, s94, 245760
s_and_b32 s56, s56, 0x7ffff
v_mfma_f32_16x16x32_bf16 v[180:183], a[48:51], a[140:143], v[180:183]
s_waitcnt lgkmcnt(0)
s_barrier
v_mfma_f32_16x16x32_bf16 v[184:187], a[48:51], a[252:255], v[184:187]
ds_read_b64_tr_b16 a[32:33], v88 offset:0
buffer_load_dwordx4 a[16:19], v83, s[40:43], s56 offen offset:0 sc1
v_mfma_f32_16x16x32_bf16 v[184:187], a[52:55], a[144:147], v[184:187]
ds_read_b64_tr_b16 a[34:35], v88 offset:2048
ds_read_b64_tr_b16 a[36:37], v88 offset:4096
v_mfma_f32_16x16x32_bf16 v[188:191], a[52:55], a[148:151], v[188:191]
s_add_u32 m0, s91, 98304
ds_read_b64_tr_b16 a[38:39], v88 offset:6144
s_add_u32 s55, s93, 1835008
L_pad9:
s_cbranch_execz L_hopret0
v_mfma_f32_16x16x32_bf16 v[188:191], a[48:51], a[248:251], v[188:191]
s_and_b32 s55, s55, 0x1fffff
v_mfma_f32_16x16x32_bf16 v[188:191], a[56:59], a[164:167], v[188:191]
ds_read_b64_tr_b16 a[40:41], v89 offset:0
buffer_load_dwordx4 v6, s[32:35], s55 offen lds
v_mfma_f32_16x16x32_bf16 v[188:191], a[60:63], a[192:195], v[188:191]
ds_read_b64_tr_b16 a[42:43], v89 offset:2048
buffer_store_dwordx4 v[248:251], v107, s[20:23], s52 offen offset:3072 sc1
v_mfma_f32_16x16x32_bf16 v[184:187], a[60:63], a[188:191], v[184:187]
ds_read_b64_tr_b16 a[44:45], v89 offset:4096
v_mfma_f32_16x16x32_bf16 v[184:187], a[56:59], a[160:163], v[184:187]
ds_read_b64_tr_b16 a[46:47], v89 offset:6144
v_mfma_f32_16x16x32_bf16 v[180:183], a[56:59], a[156:159], v[180:183]
ds_read_b64_tr_b16 a[48:49], v90 offset:0
v_mfma_f32_16x16x32_bf16 v[180:183], a[60:63], a[172:175], v[180:183]
ds_read_b64_tr_b16 a[50:51], v90 offset:2048
v_mfma_f32_16x16x32_bf16 v[176:179], a[60:63], a[168:171], v[176:179]
ds_read_b64_tr_b16 a[52:53], v90 offset:4096
v_mfma_f32_16x16x32_bf16 v[176:179], a[56:59], a[152:155], v[176:179]
s_waitcnt lgkmcnt(7)
ds_read_b64_tr_b16 a[54:55], v90 offset:6144
v_cvt_pk_bf16_f32 v184, v184, v185
v_mfma_f32_16x16x32_bf16 v[16:19], a[32:35], a[196:199], 0
ds_read_b64_tr_b16 a[56:57], v91 offset:0
v_cvt_pk_bf16_f32 v185, v186, v187
v_mfma_f32_16x16x32_bf16 v[16:19], a[36:39], a[204:207], v[16:19]
ds_read_b64_tr_b16 a[58:59], v91 offset:2048
v_cvt_pk_bf16_f32 v186, v188, v189
v_mfma_f32_16x16x32_bf16 v[20:23], a[36:39], a[208:211], 0
ds_read_b64_tr_b16 a[60:61], v91 offset:4096
v_cvt_pk_bf16_f32 v187, v190, v191
v_mfma_f32_16x16x32_bf16 v[20:23], a[32:35], a[200:203], v[20:23]
s_waitcnt lgkmcnt(7)
ds_read_b64_tr_b16 a[62:63], v91 offset:6144
s_add_u32 m0, s91, 99328
v_mfma_f32_16x16x32_bf16 v[28:31], a[40:43], a[200:203], 0
ds_read_b64_tr_b16 a[32:33], v88 offset:8192
v_mfma_f32_16x16x32_bf16 v[28:31], a[44:47], a[208:211], v[28:31]
ds_read_b64_tr_b16 a[34:35], v88 offset:10240
buffer_load_dwordx4 v7, s[32:35], s55 offen lds
v_mfma_f32_16x16x32_bf16 v[24:27], a[44:47], a[204:207], 0
ds_read_b64_tr_b16 a[36:37], v88 offset:12288
v_mfma_f32_16x16x32_bf16 v[24:27], a[40:43], a[196:199], v[24:27]
s_waitcnt lgkmcnt(7)
ds_read_b64_tr_b16 a[38:39], v88 offset:14336
s_add_u32 m0, s91, 106496
v_mfma_f32_16x16x32_bf16 v[32:35], a[48:51], a[196:199], 0
s_add_u32 s55, s93, 1966080
ds_read_b64_tr_b16 a[40:41], v89 offset:8192
s_and_b32 s55, s55, 0x1fffff
v_mfma_f32_16x16x32_bf16 v[32:35], a[52:55], a[204:207], v[32:35]
ds_read_b64_tr_b16 a[42:43], v89 offset:10240
buffer_store_dwordx4 v[184:187], v107, s[20:23], s64 offen offset:3072 sc1
v_mfma_f32_16x16x32_bf16 v[36:39], a[52:55], a[208:211], 0
ds_read_b64_tr_b16 a[44:45], v89 offset:12288
buffer_load_dwordx4 v6, s[32:35], s55 offen lds
v_mfma_f32_16x16x32_bf16 v[36:39], a[48:51], a[200:203], v[36:39]
s_waitcnt lgkmcnt(7)
ds_read_b64_tr_b16 a[46:47], v89 offset:14336
buffer_load_dword v103, v11, s[48:51], s71 offen offset:0 sc1
v_mfma_f32_16x16x32_bf16 v[44:47], a[56:59], a[200:203], 0
ds_read_b64_tr_b16 a[48:49], v90 offset:8192
v_mfma_f32_16x16x32_bf16 v[44:47], a[60:63], a[208:211], v[44:47]
ds_read_b64_tr_b16 a[50:51], v90 offset:10240
v_mfma_f32_16x16x32_bf16 v[40:43], a[60:63], a[204:207], 0
ds_read_b64_tr_b16 a[52:53], v90 offset:12288
v_mfma_f32_16x16x32_bf16 v[40:43], a[56:59], a[196:199], v[40:43]
s_waitcnt lgkmcnt(7)
ds_read_b64_tr_b16 a[54:55], v90 offset:14336
v_mfma_f32_16x16x32_bf16 v[16:19], a[32:35], a[212:215], v[16:19]
ds_read_b64_tr_b16 a[56:57], v91 offset:8192
v_mfma_f32_16x16x32_bf16 v[16:19], a[36:39], a[104:107], v[16:19]
ds_read_b64_tr_b16 a[58:59], v91 offset:10240
v_mfma_f32_16x16x32_bf16 v[20:23], a[36:39], a[100:103], v[20:23]
ds_read_b64_tr_b16 a[60:61], v91 offset:12288
v_mfma_f32_16x16x32_bf16 v[20:23], a[32:35], a[216:219], v[20:23]
s_waitcnt lgkmcnt(7)
ds_read_b64_tr_b16 a[62:63], v91 offset:14336
v_mfma_f32_16x16x32_bf16 v[28:31], a[40:43], a[216:219], v[28:31]
ds_read_b64_tr_b16 a[32:33], v88 offset:16384
v_mfma_f32_16x16x32_bf16 v[28:31], a[44:47], a[100:103], v[28:31]
ds_read_b64_tr_b16 a[34:35], v88 offset:18432
v_mfma_f32_16x16x32_bf16 v[24:27], a[44:47], a[104:107], v[24:27]
ds_read_b64_tr_b16 a[36:37], v88 offset:20480
v_mfma_f32_16x16x32_bf16 v[24:27], a[40:43], a[212:215], v[24:27]
s_waitcnt lgkmcnt(7)
ds_read_b64_tr_b16 a[38:39], v88 offset:22528
v_mfma_f32_16x16x32_bf16 v[32:35], a[48:51], a[212:215], v[32:35]
s_add_u32 m0, s91, 107520
ds_read_b64_tr_b16 a[40:41], v89 offset:16384
v_mfma_f32_16x16x32_bf16 v[32:35], a[52:55], a[104:107], v[32:35]
ds_read_b64_tr_b16 a[42:43], v89 offset:18432
v_mfma_f32_16x16x32_bf16 v[36:39], a[52:55], a[100:103], v[36:39]
ds_read_b64_tr_b16 a[44:45], v89 offset:20480
buffer_load_dwordx4 v7, s[32:35], s55 offen lds
v_mfma_f32_16x16x32_bf16 v[36:39], a[48:51], a[216:219], v[36:39]
s_waitcnt lgkmcnt(7)
ds_read_b64_tr_b16 a[46:47], v89 offset:22528
v_mfma_f32_16x16x32_bf16 v[44:47], a[56:59], a[216:219], v[44:47]
ds_read_b64_tr_b16 a[48:49], v90 offset:16384
v_mfma_f32_16x16x32_bf16 v[44:47], a[60:63], a[100:103], v[44:47]
ds_read_b64_tr_b16 a[50:51], v90 offset:18432
v_mfma_f32_16x16x32_bf16 v[40:43], a[60:63], a[104:107], v[40:43]
ds_read_b64_tr_b16 a[52:53], v90 offset:20480
v_mfma_f32_16x16x32_bf16 v[40:43], a[56:59], a[212:215], v[40:43]
s_waitcnt lgkmcnt(7)
ds_read_b64_tr_b16 a[54:55], v90 offset:22528
buffer_load_dwordx4 a[20:23], v83, s[40:43], s56 offen offset:1024 sc1
v_mfma_f32_16x16x32_bf16 v[16:19], a[32:35], a[96:99], v[16:19]
ds_read_b64_tr_b16 a[56:57], v91 offset:16384
v_mfma_f32_16x16x32_bf16 v[16:19], a[36:39], a[220:223], v[16:19]
s_add_u32 s56, s94, 262144
ds_read_b64_tr_b16 a[58:59], v91 offset:18432
s_and_b32 s56, s56, 0x7ffff
v_mfma_f32_16x16x32_bf16 v[20:23], a[36:39], a[224:227], v[20:23]
ds_read_b64_tr_b16 a[60:61], v91 offset:20480
v_mfma_f32_16x16x32_bf16 v[20:23], a[32:35], a[92:95], v[20:23]
s_waitcnt lgkmcnt(7)
ds_read_b64_tr_b16 a[62:63], v91 offset:22528
buffer_load_dwordx4 a[84:87], v83, s[40:43], s56 offen offset:0 sc1
v_mfma_f32_16x16x32_bf16 v[28:31], a[40:43], a[92:95], v[28:31]
ds_read_b64_tr_b16 a[32:33], v88 offset:24576
v_mfma_f32_16x16x32_bf16 v[28:31], a[44:47], a[224:227], v[28:31]
ds_read_b64_tr_b16 a[34:35], v88 offset:26624
v_mfma_f32_16x16x32_bf16 v[24:27], a[44:47], a[220:223], v[24:27]
ds_read_b64_tr_b16 a[36:37], v88 offset:28672
v_mfma_f32_16x16x32_bf16 v[24:27], a[40:43], a[96:99], v[24:27]
s_waitcnt lgkmcnt(7)
ds_read_b64_tr_b16 a[38:39], v88 offset:30720
v_mfma_f32_16x16x32_bf16 v[32:35], a[48:51], a[96:99], v[32:35]
ds_read_b64_tr_b16 a[40:41], v89 offset:24576
buffer_load_dwordx4 a[88:91], v83, s[40:43], s56 offen offset:1024 sc1
v_mfma_f32_16x16x32_bf16 v[32:35], a[52:55], a[220:223], v[32:35]
ds_read_b64_tr_b16 a[42:43], v89 offset:26624
v_mfma_f32_16x16x32_bf16 v[36:39], a[52:55], a[224:227], v[36:39]
s_add_u32 s56, s94, 278528
ds_read_b64_tr_b16 a[44:45], v89 offset:28672
s_and_b32 s56, s56, 0x7ffff
v_mfma_f32_16x16x32_bf16 v[36:39], a[48:51], a[92:95], v[36:39]
s_waitcnt lgkmcnt(7)
ds_read_b64_tr_b16 a[46:47], v89 offset:30720
v_mfma_f32_16x16x32_bf16 v[44:47], a[56:59], a[92:95], v[44:47]
ds_read_b64_tr_b16 a[48:49], v90 offset:24576
buffer_load_dwordx4 a[120:123], v83, s[40:43], s56 offen offset:0 sc1
v_mfma_f32_16x16x32_bf16 v[44:47], a[60:63], a[224:227], v[44:47]
ds_read_b64_tr_b16 a[50:51], v90 offset:26624
v_mfma_f32_16x16x32_bf16 v[40:43], a[60:63], a[220:223], v[40:43]
ds_read_b64_tr_b16 a[52:53], v90 offset:28672
v_mfma_f32_16x16x32_bf16 v[40:43], a[56:59], a[96:99], v[40:43]
s_waitcnt lgkmcnt(7)
ds_read_b64_tr_b16 a[54:55], v90 offset:30720
v_mfma_f32_16x16x32_bf16 v[16:19], a[32:35], a[228:231], v[16:19]
ds_read_b64_tr_b16 a[56:57], v91 offset:24576
v_mfma_f32_16x16x32_bf16 v[16:19], a[36:39], a[236:239], v[16:19]
ds_read_b64_tr_b16 a[58:59], v91 offset:26624
buffer_load_dwordx4 a[124:127], v83, s[40:43], s56 offen offset:1024 sc1
v_mfma_f32_16x16x32_bf16 v[20:23], a[36:39], a[64:67], v[20:23]
ds_read_b64_tr_b16 a[60:61], v91 offset:28672
v_mfma_f32_16x16x32_bf16 v[20:23], a[32:35], a[232:235], v[20:23]
s_waitcnt lgkmcnt(7)
ds_read_b64_tr_b16 a[62:63], v91 offset:30720
s_add_u32 s56, s94, 294912
v_mfma_f32_16x16x32_bf16 v[28:31], a[40:43], a[232:235], v[28:31]
s_and_b32 s56, s56, 0x7ffff
v_add_u32 v88, 4294836224, v88
ds_read_b64_tr_b16 a[32:33], v88 offset:40960
v_mfma_f32_16x16x32_bf16 v[28:31], a[44:47], a[64:67], v[28:31]
ds_read_b64_tr_b16 a[34:35], v88 offset:43008
buffer_load_dwordx4 a[128:131], v83, s[40:43], s56 offen offset:0 sc1
v_mfma_f32_16x16x32_bf16 v[24:27], a[44:47], a[236:239], v[24:27]
ds_read_b64_tr_b16 a[36:37], v88 offset:45056
v_mfma_f32_16x16x32_bf16 v[24:27], a[40:43], a[228:231], v[24:27]
s_waitcnt lgkmcnt(7)
ds_read_b64_tr_b16 a[38:39], v88 offset:47104
v_mfma_f32_16x16x32_bf16 v[32:35], a[48:51], a[228:231], v[32:35]
v_add_u32 v89, 4294836224, v89
ds_read_b64_tr_b16 a[40:41], v89 offset:40960
v_mfma_f32_16x16x32_bf16 v[32:35], a[52:55], a[236:239], v[32:35]
ds_read_b64_tr_b16 a[42:43], v89 offset:43008
v_mfma_f32_16x16x32_bf16 v[36:39], a[52:55], a[64:67], v[36:39]
ds_read_b64_tr_b16 a[44:45], v89 offset:45056
buffer_load_dwordx4 a[132:135], v83, s[40:43], s56 offen offset:1024 sc1
v_mfma_f32_16x16x32_bf16 v[36:39], a[48:51], a[232:235], v[36:39]
s_waitcnt lgkmcnt(7)
ds_read_b64_tr_b16 a[46:47], v89 offset:47104
v_mfma_f32_16x16x32_bf16 v[44:47], a[56:59], a[232:235], v[44:47]
s_add_u32 s56, s94, 311296
v_add_u32 v90, 4294836224, v90
ds_read_b64_tr_b16 a[48:49], v90 offset:40960
v_mfma_f32_16x16x32_bf16 v[44:47], a[60:63], a[64:67], v[44:47]
s_and_b32 s56, s56, 0x7ffff
ds_read_b64_tr_b16 a[50:51], v90 offset:43008
v_mfma_f32_16x16x32_bf16 v[40:43], a[60:63], a[236:239], v[40:43]
ds_read_b64_tr_b16 a[52:53], v90 offset:45056
buffer_load_dwordx4 a[136:139], v83, s[40:43], s56 offen offset:0 sc1
v_mfma_f32_16x16x32_bf16 v[40:43], a[56:59], a[228:231], v[40:43]
s_waitcnt lgkmcnt(7)
ds_read_b64_tr_b16 a[54:55], v90 offset:47104
v_mfma_f32_16x16x32_bf16 v[16:19], a[32:35], a[24:27], v[16:19]
v_add_u32 v91, 4294836224, v91
ds_read_b64_tr_b16 a[56:57], v91 offset:40960
v_mfma_f32_16x16x32_bf16 v[16:19], a[36:39], a[184:187], v[16:19]
s_waitcnt vmcnt(11)
ds_read_b64_tr_b16 a[58:59], v91 offset:43008
buffer_store_dword v100, v101, s[48:51], s61 offen offset:4 sc1
v_mfma_f32_16x16x32_bf16 v[20:23], a[36:39], a[116:119], v[20:23]
ds_read_b64_tr_b16 a[60:61], v91 offset:45056
v_mfma_f32_16x16x32_bf16 v[20:23], a[32:35], a[28:31], v[20:23]
s_waitcnt lgkmcnt(7)
ds_read_b64_tr_b16 a[62:63], v91 offset:47104
v_mfma_f32_16x16x32_bf16 v[28:31], a[40:43], a[28:31], v[28:31]
ds_read_b64_tr_b16 a[32:33], v88 offset:32768
buffer_load_dwordx4 a[140:143], v83, s[40:43], s56 offen offset:1024 sc1
v_mfma_f32_16x16x32_bf16 v[28:31], a[44:47], a[116:119], v[28:31]
ds_read_b64_tr_b16 a[34:35], v88 offset:34816
v_mfma_f32_16x16x32_bf16 v[24:27], a[44:47], a[184:187], v[24:27]
s_add_u32 s56, s94, 327680
ds_read_b64_tr_b16 a[36:37], v88 offset:36864
s_and_b32 s56, s56, 0x7ffff
v_mfma_f32_16x16x32_bf16 v[24:27], a[40:43], a[24:27], v[24:27]
s_waitcnt lgkmcnt(7)
ds_read_b64_tr_b16 a[38:39], v88 offset:38912
s_waitcnt vmcnt(11)
v_mfma_f32_16x16x32_bf16 v[32:35], a[48:51], a[24:27], v[32:35]
ds_read_b64_tr_b16 a[40:41], v89 offset:32768
buffer_load_dwordx4 a[252:255], v83, s[40:43], s56 offen offset:0 sc1
v_mfma_f32_16x16x32_bf16 v[32:35], a[52:55], a[184:187], v[32:35]
ds_read_b64_tr_b16 a[42:43], v89 offset:34816
v_cmp_ne_u32 vcc, s9, v103
s_mov_b32 s16, 0
s_nop 0
s_cbranch_vccz L_py0_ok
L_py0:
buffer_load_dword v103, v11, s[48:51], s71 offen offset:0 sc1
s_waitcnt vmcnt(0)
v_cmp_ne_u32 vcc, s9, v103
s_add_u32 s16, s16, 1
s_nop 0
s_cbranch_vccz L_py0_ok
s_cmp_lt_u32 s16, 0x100000
s_cbranch_scc1 L_py0
L_py0_ok:
v_mfma_f32_16x16x32_bf16 v[36:39], a[52:55], a[116:119], v[36:39]
ds_read_b64_tr_b16 a[44:45], v89 offset:36864
buffer_load_dwordx4 v[196:199], v107, s[20:23], s58 offen offset:0 sc1
v_mfma_f32_16x16x32_bf16 v[36:39], a[48:51], a[28:31], v[36:39]
s_waitcnt lgkmcnt(7)
ds_read_b64_tr_b16 a[46:47], v89 offset:38912
buffer_load_dwordx4 v[140:143], v107, s[20:23], s59 offen offset:0 sc1
v_mfma_f32_16x16x32_bf16 v[44:47], a[56:59], a[28:31], v[44:47]
ds_read_b64_tr_b16 a[48:49], v90 offset:32768
buffer_load_dwordx4 v[204:207], v107, s[20:23], s57 offen offset:0 sc1
v_mfma_f32_16x16x32_bf16 v[44:47], a[60:63], a[116:119], v[44:47]
ds_read_b64_tr_b16 a[50:51], v90 offset:34816
buffer_load_dwordx4 v[212:215], v107, s[20:23], s58 offen offset:1024 sc1
v_mfma_f32_16x16x32_bf16 v[40:43], a[60:63], a[184:187], v[40:43]
ds_read_b64_tr_b16 a[52:53], v90 offset:36864
buffer_load_dwordx4 v[156:159], v107, s[20:23], s59 offen offset:1024 sc1
v_mfma_f32_16x16x32_bf16 v[40:43], a[56:59], a[24:27], v[40:43]
s_waitcnt lgkmcnt(7)
ds_read_b64_tr_b16 a[54:55], v90 offset:38912
buffer_load_dwordx4 v[220:223], v107, s[20:23], s57 offen offset:1024 sc1
v_mfma_f32_16x16x32_bf16 v[16:19], a[32:35], a[112:115], v[16:19]
ds_read_b64_tr_b16 a[56:57], v91 offset:32768
v_mfma_f32_16x16x32_bf16 v[16:19], a[36:39], a[68:71], v[16:19]
ds_read_b64_tr_b16 a[58:59], v91 offset:34816
v_mfma_f32_16x16x32_bf16 v[20:23], a[36:39], a[72:75], v[20:23]
ds_read_b64_tr_b16 a[60:61], v91 offset:36864
v_mfma_f32_16x16x32_bf16 v[20:23], a[32:35], a[108:111], v[20:23]
s_waitcnt lgkmcnt(7)
ds_read_b64_tr_b16 a[62:63], v91 offset:38912
v_mfma_f32_16x16x32_bf16 v[28:31], a[40:43], a[108:111], v[28:31]
ds_read_b64_tr_b16 a[32:33], v88 offset:0
v_mfma_f32_16x16x32_bf16 v[28:31], a[44:47], a[72:75], v[28:31]
ds_read_b64_tr_b16 a[34:35], v88 offset:2048
v_mfma_f32_16x16x32_bf16 v[24:27], a[44:47], a[68:71], v[24:27]
ds_read_b64_tr_b16 a[36:37], v88 offset:4096
v_mfma_f32_16x16x32_bf16 v[24:27], a[40:43], a[112:115], v[24:27]
s_waitcnt lgkmcnt(7)
ds_read_b64_tr_b16 a[38:39], v88 offset:6144
v_mfma_f32_16x16x32_bf16 v[32:35], a[48:51], a[112:115], v[32:35]
ds_read_b64_tr_b16 a[40:41], v89 offset:0
v_mfma_f32_16x16x32_bf16 v[32:35], a[52:55], a[68:71], v[32:35]
ds_read_b64_tr_b16 a[42:43], v89 offset:2048
v_mfma_f32_16x16x32_bf16 v[36:39], a[52:55], a[72:75], v[36:39]
ds_read_b64_tr_b16 a[44:45], v89 offset:4096
v_mfma_f32_16x16x32_bf16 v[36:39], a[48:51], a[108:111], v[36:39]
s_waitcnt lgkmcnt(7)
ds_read_b64_tr_b16 a[46:47], v89 offset:6144
v_mfma_f32_16x16x32_bf16 v[44:47], a[56:59], a[108:111], v[44:47]
ds_read_b64_tr_b16 a[48:49], v90 offset:0
v_mfma_f32_16x16x32_bf16 v[44:47], a[60:63], a[72:75], v[44:47]
ds_read_b64_tr_b16 a[50:51], v90 offset:2048
v_mfma_f32_16x16x32_bf16 v[40:43], a[60:63], a[68:71], v[40:43]
ds_read_b64_tr_b16 a[52:53], v90 offset:4096
v_mfma_f32_16x16x32_bf16 v[40:43], a[56:59], a[112:115], v[40:43]
s_waitcnt lgkmcnt(7)
ds_read_b64_tr_b16 a[54:55], v90 offset:6144
v_mfma_f32_16x16x32_bf16 v[16:19], a[32:35], a[76:79], v[16:19]
ds_read_b64_tr_b16 a[56:57], v91 offset:0
v_mfma_f32_16x16x32_bf16 v[16:19], a[36:39], a[0:3], v[16:19]
ds_read_b64_tr_b16 a[58:59], v91 offset:2048
v_mfma_f32_16x16x32_bf16 v[20:23], a[36:39], a[4:7], v[20:23]
ds_read_b64_tr_b16 a[60:61], v91 offset:4096
v_mfma_f32_16x16x32_bf16 v[20:23], a[32:35], a[80:83], v[20:23]
s_waitcnt lgkmcnt(7)
ds_read_b64_tr_b16 a[62:63], v91 offset:6144
v_mfma_f32_16x16x32_bf16 v[28:31], a[40:43], a[80:83], v[28:31]
ds_read_b64_tr_b16 a[32:33], v88 offset:8192
v_mfma_f32_16x16x32_bf16 v[28:31], a[44:47], a[4:7], v[28:31]
ds_read_b64_tr_b16 a[34:35], v88 offset:10240
v_mfma_f32_16x16x32_bf16 v[24:27], a[44:47], a[0:3], v[24:27]
ds_read_b64_tr_b16 a[36:37], v88 offset:12288
v_mfma_f32_16x16x32_bf16 v[24:27], a[40:43], a[76:79], v[24:27]
s_waitcnt lgkmcnt(7)
ds_read_b64_tr_b16 a[38:39], v88 offset:14336
v_mfma_f32_16x16x32_bf16 v[32:35], a[48:51], a[76:79], v[32:35]
ds_read_b64_tr_b16 a[40:41], v89 offset:8192
buffer_load_dwordx4 a[248:251], v83, s[40:43], s56 offen offset:1024 sc1
v_mfma_f32_16x16x32_bf16 v[32:35], a[52:55], a[0:3], v[32:35]
ds_read_b64_tr_b16 a[42:43], v89 offset:10240
buffer_load_dword v103, v11, s[48:51], s71 offen offset:4 sc1
v_mfma_f32_16x16x32_bf16 v[36:39], a[52:55], a[4:7], v[36:39]
ds_read_b64_tr_b16 a[44:45], v89 offset:12288
v_mfma_f32_16x16x32_bf16 v[36:39], a[48:51], a[80:83], v[36:39]
s_waitcnt lgkmcnt(7)
ds_read_b64_tr_b16 a[46:47], v89 offset:14336
v_mfma_f32_16x16x32_bf16 v[44:47], a[56:59], a[80:83], v[44:47]
ds_read_b64_tr_b16 a[48:49], v90 offset:8192
v_mfma_f32_16x16x32_bf16 v[44:47], a[60:63], a[4:7], v[44:47]
ds_read_b64_tr_b16 a[50:51], v90 offset:10240
v_mfma_f32_16x16x32_bf16 v[40:43], a[60:63], a[0:3], v[40:43]
ds_read_b64_tr_b16 a[52:53], v90 offset:12288
v_mfma_f32_16x16x32_bf16 v[40:43], a[56:59], a[76:79], v[40:43]
s_waitcnt vmcnt(18) lgkmcnt(7)
ds_read_b64_tr_b16 a[54:55], v90 offset:14336
s_add_u32 s56, s94, 344064
v_mfma_f32_16x16x32_bf16 v[16:19], a[32:35], a[8:11], v[16:19]
s_and_b32 s56, s56, 0x7ffff
ds_read_b64_tr_b16 a[56:57], v91 offset:8192
v_mfma_f32_16x16x32_bf16 v[16:19], a[36:39], a[16:19], v[16:19]
ds_read_b64_tr_b16 a[58:59], v91 offset:10240
buffer_load_dwordx4 a[244:247], v83, s[40:43], s56 offen offset:0 sc1
v_mfma_f32_16x16x32_bf16 v[20:23], a[36:39], a[20:23], v[20:23]
ds_read_b64_tr_b16 a[60:61], v91 offset:12288
v_mfma_f32_16x16x32_bf16 v[20:23], a[32:35], a[12:15], v[20:23]
s_waitcnt lgkmcnt(7)
ds_read_b64_tr_b16 a[62:63], v91 offset:14336
v_mfma_f32_16x16x32_bf16 v[28:31], a[40:43], a[12:15], v[28:31]
ds_read_b64_tr_b16 a[32:33], v88 offset:16384
v_mfma_f32_16x16x32_bf16 v[28:31], a[44:47], a[20:23], v[28:31]
ds_read_b64_tr_b16 a[34:35], v88 offset:18432
buffer_load_dwordx4 a[240:243], v83, s[40:43], s56 offen offset:1024 sc1
v_mfma_f32_16x16x32_bf16 v[24:27], a[44:47], a[16:19], v[24:27]
ds_read_b64_tr_b16 a[36:37], v88 offset:20480
v_mfma_f32_16x16x32_bf16 v[24:27], a[40:43], a[8:11], v[24:27]
s_waitcnt lgkmcnt(7)
ds_read_b64_tr_b16 a[38:39], v88 offset:22528
v_mfma_f32_16x16x32_bf16 v[32:35], a[48:51], a[8:11], v[32:35]
s_add_u32 s56, s94, 360448
ds_read_b64_tr_b16 a[40:41], v89 offset:16384
s_and_b32 s56, s56, 0x7ffff
v_mfma_f32_16x16x32_bf16 v[32:35], a[52:55], a[16:19], v[32:35]
ds_read_b64_tr_b16 a[42:43], v89 offset:18432
v_mfma_f32_16x16x32_bf16 v[36:39], a[52:55], a[20:23], v[36:39]
ds_read_b64_tr_b16 a[44:45], v89 offset:20480
buffer_load_dwordx4 a[144:147], v83, s[40:43], s56 offen offset:0 sc1
v_mfma_f32_16x16x32_bf16 v[36:39], a[48:51], a[12:15], v[36:39]
s_waitcnt lgkmcnt(7)
ds_read_b64_tr_b16 a[46:47], v89 offset:22528
v_mfma_f32_16x16x32_bf16 v[44:47], a[56:59], a[12:15], v[44:47]
ds_read_b64_tr_b16 a[48:49], v90 offset:16384
v_mfma_f32_16x16x32_bf16 v[44:47], a[60:63], a[20:23], v[44:47]
ds_read_b64_tr_b16 a[50:51], v90 offset:18432
v_mfma_f32_16x16x32_bf16 v[40:43], a[60:63], a[16:19], v[40:43]
ds_read_b64_tr_b16 a[52:53], v90 offset:20480
buffer_load_dwordx4 a[148:151], v83, s[40:43], s56 offen offset:1024 sc1
v_mfma_f32_16x16x32_bf16 v[40:43], a[56:59], a[8:11], v[40:43]
s_waitcnt vmcnt(18) lgkmcnt(7)
ds_read_b64_tr_b16 a[54:55], v90 offset:22528
v_mfma_f32_16x16x32_bf16 v[16:19], a[32:35], a[84:87], v[16:19]
ds_read_b64_tr_b16 a[56:57], v91 offset:16384
v_mfma_f32_16x16x32_bf16 v[16:19], a[36:39], a[120:123], v[16:19]
s_add_u32 s56, s94, 376832
ds_read_b64_tr_b16 a[58:59], v91 offset:18432
s_and_b32 s56, s56, 0x7ffff
v_mfma_f32_16x16x32_bf16 v[20:23], a[36:39], a[124:127], v[20:23]
ds_read_b64_tr_b16 a[60:61], v91 offset:20480
v_mfma_f32_16x16x32_bf16 v[20:23], a[32:35], a[88:91], v[20:23]
s_waitcnt lgkmcnt(7)
ds_read_b64_tr_b16 a[62:63], v91 offset:22528
buffer_load_dwordx4 a[152:155], v83, s[40:43], s56 offen offset:0 sc1
v_mfma_f32_16x16x32_bf16 v[28:31], a[40:43], a[88:91], v[28:31]
ds_read_b64_tr_b16 a[32:33], v88 offset:24576
v_mfma_f32_16x16x32_bf16 v[28:31], a[44:47], a[124:127], v[28:31]
ds_read_b64_tr_b16 a[34:35], v88 offset:26624
v_mfma_f32_16x16x32_bf16 v[24:27], a[44:47], a[120:123], v[24:27]
ds_read_b64_tr_b16 a[36:37], v88 offset:28672
v_mfma_f32_16x16x32_bf16 v[24:27], a[40:43], a[84:87], v[24:27]
s_waitcnt lgkmcnt(7)
ds_read_b64_tr_b16 a[38:39], v88 offset:30720
buffer_load_dwordx4 a[156:159], v83, s[40:43], s56 offen offset:1024 sc1
v_mfma_f32_16x16x32_bf16 v[32:35], a[48:51], a[84:87], v[32:35]
s_waitcnt vmcnt(11)
ds_read_b64_tr_b16 a[40:41], v89 offset:24576
v_mfma_f32_16x16x32_bf16 v[128:131], a[178:181], v[196:199], v[128:131]
v_mfma_f32_16x16x32_bf16 v[128:131], a[178:181], v[140:143], v[128:131]
v_mfma_f32_16x16x32_bf16 v[128:131], a[178:181], v[204:207], v[128:131]
v_mfma_f32_16x16x32_bf16 v[132:135], a[176:179], v[196:199], v[132:135]
v_mfma_f32_16x16x32_bf16 v[132:135], a[176:179], v[140:143], v[132:135]
v_mfma_f32_16x16x32_bf16 v[132:135], a[176:179], v[204:207], v[132:135]
v_mfma_f32_16x16x32_bf16 v[32:35], a[52:55], a[120:123], v[32:35]
s_add_u32 s56, s94, 393216
ds_read_b64_tr_b16 a[42:43], v89 offset:26624
s_and_b32 s56, s56, 0x7ffff
v_mfma_f32_16x16x32_bf16 v[36:39], a[52:55], a[124:127], v[36:39]
ds_read_b64_tr_b16 a[44:45], v89 offset:28672
buffer_load_dwordx4 a[160:163], v83, s[40:43], s56 offen offset:0 sc1
v_mfma_f32_16x16x32_bf16 v[36:39], a[48:51], a[88:91], v[36:39]
s_waitcnt lgkmcnt(7)
ds_read_b64_tr_b16 a[46:47], v89 offset:30720
s_waitcnt vmcnt(9)
v_mfma_f32_16x16x32_bf16 v[144:147], a[178:181], v[212:215], v[144:147]
buffer_load_dwordx4 a[164:167], v83, s[40:43], s56 offen offset:1024 sc1
v_mfma_f32_16x16x32_bf16 v[144:147], a[178:181], v[156:159], v[144:147]
v_mfma_f32_16x16x32_bf16 v[144:147], a[178:181], v[220:223], v[144:147]
v_mfma_f32_16x16x32_bf16 v[148:151], a[176:179], v[212:215], v[148:151]
v_mfma_f32_16x16x32_bf16 v[148:151], a[176:179], v[156:159], v[148:151]
v_mfma_f32_16x16x32_bf16 v[148:151], a[176:179], v[220:223], v[148:151]
v_mul_f32 v112, s26, v128
v_mul_f32 v113, s26, v129
v_mfma_f32_16x16x32_bf16 v[44:47], a[56:59], a[88:91], v[44:47]
s_add_u32 s56, s94, 409600
ds_read_b64_tr_b16 a[48:49], v90 offset:24576
v_mul_f32 v114, s26, v130
v_mfma_f32_16x16x32_bf16 v[44:47], a[60:63], a[124:127], v[44:47]
s_and_b32 s56, s56, 0x7ffff
ds_read_b64_tr_b16 a[50:51], v90 offset:26624
buffer_load_dwordx4 a[168:171], v83, s[40:43], s56 offen offset:0 sc1
v_mfma_f32_16x16x32_bf16 v[40:43], a[60:63], a[120:123], v[40:43]
s_waitcnt vmcnt(9)
ds_read_b64_tr_b16 a[52:53], v90 offset:28672
v_cmp_ne_u32 vcc, s9, v103
s_mov_b32 s16, 0
s_nop 0
s_cbranch_vccz L_py1_ok
L_py1:
buffer_load_dword v103, v11, s[48:51], s71 offen offset:4 sc1
s_waitcnt vmcnt(0)
v_cmp_ne_u32 vcc, s9, v103
s_add_u32 s16, s16, 1
s_nop 0
s_cbranch_vccz L_py1_ok
s_cmp_lt_u32 s16, 0x100000
s_cbranch_scc1 L_py1
L_py1_ok:
v_mfma_f32_16x16x32_bf16 v[40:43], a[56:59], a[84:87], v[40:43]
s_waitcnt lgkmcnt(7)
ds_read_b64_tr_b16 a[54:55], v90 offset:30720
buffer_load_dwordx4 a[172:175], v83, s[40:43], s56 offen offset:1024 sc1
v_mfma_f32_16x16x32_bf16 v[16:19], a[32:35], a[128:131], v[16:19]
ds_read_b64_tr_b16 a[56:57], v91 offset:24576
buffer_load_dwordx4 v[228:231], v107, s[20:23], s58 offen offset:2048 sc1
v_mfma_f32_16x16x32_bf16 v[16:19], a[36:39], a[136:139], v[16:19]
ds_read_b64_tr_b16 a[58:59], v91 offset:26624
buffer_load_dwordx4 v[172:175], v107, s[20:23], s59 offen offset:2048 sc1
v_mfma_f32_16x16x32_bf16 v[20:23], a[36:39], a[140:143], v[20:23]
ds_read_b64_tr_b16 a[60:61], v91 offset:28672
buffer_load_dwordx4 v[236:239], v107, s[20:23], s57 offen offset:2048 sc1
v_mfma_f32_16x16x32_bf16 v[20:23], a[32:35], a[132:135], v[20:23]
s_waitcnt lgkmcnt(7)
ds_read_b64_tr_b16 a[62:63], v91 offset:30720
buffer_load_dwordx4 v[244:247], v107, s[20:23], s58 offen offset:3072 sc1
v_mfma_f32_16x16x32_bf16 v[28:31], a[40:43], a[132:135], v[28:31]
v_add_u32 v88, 65536, v88
ds_read_b64_tr_b16 a[32:33], v88 offset:49152
v_mfma_f32_16x16x32_bf16 v[28:31], a[44:47], a[140:143], v[28:31]
ds_read_b64_tr_b16 a[34:35], v88 offset:51200
buffer_load_dwordx4 v[188:191], v107, s[20:23], s59 offen offset:3072 sc1
v_mfma_f32_16x16x32_bf16 v[24:27], a[44:47], a[136:139], v[24:27]
ds_read_b64_tr_b16 a[36:37], v88 offset:53248
buffer_load_dwordx4 v[252:255], v107, s[20:23], s57 offen offset:3072 sc1
v_mfma_f32_16x16x32_bf16 v[24:27], a[40:43], a[128:131], v[24:27]
s_waitcnt lgkmcnt(7)
ds_read_b64_tr_b16 a[38:39], v88 offset:55296
v_mul_f32 v115, s26, v131
v_mfma_f32_16x16x32_bf16 v[32:35], a[48:51], a[128:131], v[32:35]
v_add_u32 v89, 65536, v89
ds_read_b64_tr_b16 a[40:41], v89 offset:49152
v_mfma_f32_16x16x32_bf16 v[32:35], a[52:55], a[136:139], v[32:35]
ds_read_b64_tr_b16 a[42:43], v89 offset:51200
v_exp_f32 v112, v112
v_mfma_f32_16x16x32_bf16 v[36:39], a[52:55], a[140:143], v[36:39]
ds_read_b64_tr_b16 a[44:45], v89 offset:53248
v_exp_f32 v113, v113
v_mfma_f32_16x16x32_bf16 v[36:39], a[48:51], a[132:135], v[36:39]
s_waitcnt lgkmcnt(7)
ds_read_b64_tr_b16 a[46:47], v89 offset:55296
v_exp_f32 v114, v114
v_mfma_f32_16x16x32_bf16 v[44:47], a[56:59], a[132:135], v[44:47]
v_add_u32 v90, 65536, v90
ds_read_b64_tr_b16 a[48:49], v90 offset:49152
v_mfma_f32_16x16x32_bf16 v[44:47], a[60:63], a[140:143], v[44:47]
ds_read_b64_tr_b16 a[50:51], v90 offset:51200
v_exp_f32 v115, v115
v_mfma_f32_16x16x32_bf16 v[40:43], a[60:63], a[136:139], v[40:43]
ds_read_b64_tr_b16 a[52:53], v90 offset:53248
v_add_f32 v112, 1.0, v112
v_mfma_f32_16x16x32_bf16 v[40:43], a[56:59], a[128:131], v[40:43]
s_waitcnt vmcnt(14) lgkmcnt(7)
ds_read_b64_tr_b16 a[54:55], v90 offset:55296
v_add_f32 v113, 1.0, v113
v_mfma_f32_16x16x32_bf16 v[16:19], a[32:35], a[252:255], v[16:19]
v_add_u32 v91, 65536, v91
ds_read_b64_tr_b16 a[56:57], v91 offset:49152
v_mfma_f32_16x16x32_bf16 v[16:19], a[36:39], a[244:247], v[16:19]
ds_read_b64_tr_b16 a[58:59], v91 offset:51200
v_add_f32 v114, 1.0, v114
v_mfma_f32_16x16x32_bf16 v[20:23], a[36:39], a[240:243], v[20:23]
ds_read_b64_tr_b16 a[60:61], v91 offset:53248
v_add_f32 v115, 1.0, v115
v_mfma_f32_16x16x32_bf16 v[20:23], a[32:35], a[248:251], v[20:23]
s_waitcnt lgkmcnt(7)
ds_read_b64_tr_b16 a[62:63], v91 offset:55296
v_rcp_f32 v112, v112
v_mfma_f32_16x16x32_bf16 v[28:31], a[40:43], a[248:251], v[28:31]
ds_read_b64_tr_b16 a[32:33], v88 offset:57344
v_rcp_f32 v113, v113
v_mfma_f32_16x16x32_bf16 v[28:31], a[44:47], a[240:243], v[28:31]
ds_read_b64_tr_b16 a[34:35], v88 offset:59392
v_rcp_f32 v114, v114
v_mfma_f32_16x16x32_bf16 v[24:27], a[44:47], a[244:247], v[24:27]
ds_read_b64_tr_b16 a[36:37], v88 offset:61440
v_rcp_f32 v115, v115
v_mfma_f32_16x16x32_bf16 v[24:27], a[40:43], a[252:255], v[24:27]
s_waitcnt lgkmcnt(7)
ds_read_b64_tr_b16 a[38:39], v88 offset:63488
v_mul_f32 v128, v128, v112
v_mfma_f32_16x16x32_bf16 v[32:35], a[48:51], a[252:255], v[32:35]
ds_read_b64_tr_b16 a[40:41], v89 offset:57344
v_mul_f32 v129, v129, v113
v_mfma_f32_16x16x32_bf16 v[32:35], a[52:55], a[244:247], v[32:35]
ds_read_b64_tr_b16 a[42:43], v89 offset:59392
v_mul_f32 v130, v130, v114
v_mfma_f32_16x16x32_bf16 v[36:39], a[52:55], a[240:243], v[36:39]
ds_read_b64_tr_b16 a[44:45], v89 offset:61440
v_mul_f32 v131, v131, v115
v_mfma_f32_16x16x32_bf16 v[36:39], a[48:51], a[248:251], v[36:39]
s_waitcnt lgkmcnt(7)
ds_read_b64_tr_b16 a[46:47], v89 offset:63488
v_mul_f32 v112, s26, v132
v_mfma_f32_16x16x32_bf16 v[44:47], a[56:59], a[248:251], v[44:47]
s_add_u32 s56, s94, 425984
ds_read_b64_tr_b16 a[48:49], v90 offset:57344
v_mul_f32 v113, s26, v133
v_mfma_f32_16x16x32_bf16 v[44:47], a[60:63], a[240:243], v[44:47]
s_and_b32 s56, s56, 0x7ffff
ds_read_b64_tr_b16 a[50:51], v90 offset:59392
v_mul_f32 v114, s26, v134
v_mfma_f32_16x16x32_bf16 v[40:43], a[60:63], a[244:247], v[40:43]
ds_read_b64_tr_b16 a[52:53], v90 offset:61440
buffer_load_dwordx4 a[188:191], v83, s[40:43], s56 offen offset:0 sc1
L_pad10:
s_cbranch_execz L_hopret0
v_mfma_f32_16x16x32_bf16 v[40:43], a[56:59], a[252:255], v[40:43]
s_waitcnt vmcnt(11) lgkmcnt(7)
ds_read_b64_tr_b16 a[54:55], v90 offset:63488
v_mul_f32 v115, s26, v135
v_mfma_f32_16x16x32_bf16 v[16:19], a[32:35], a[144:147], v[16:19]
ds_read_b64_tr_b16 a[56:57], v91 offset:57344
v_exp_f32 v112, v112
v_mfma_f32_16x16x32_bf16 v[16:19], a[36:39], a[152:155], v[16:19]
ds_read_b64_tr_b16 a[58:59], v91 offset:59392
v_exp_f32 v113, v113
v_mfma_f32_16x16x32_bf16 v[20:23], a[36:39], a[156:159], v[20:23]
ds_read_b64_tr_b16 a[60:61], v91 offset:61440
v_exp_f32 v114, v114
v_mfma_f32_16x16x32_bf16 v[20:23], a[32:35], a[148:151], v[20:23]
s_waitcnt lgkmcnt(7)
ds_read_b64_tr_b16 a[62:63], v91 offset:63488
buffer_load_dwordx4 a[192:195], v83, s[40:43], s56 offen offset:1024 sc1
v_mfma_f32_16x16x32_bf16 v[28:31], a[40:43], a[148:151], v[28:31]
ds_read_b64_tr_b16 a[32:33], v88 offset:16384
v_exp_f32 v115, v115
v_mfma_f32_16x16x32_bf16 v[28:31], a[44:47], a[156:159], v[28:31]
s_add_u32 s56, s94, 442368
ds_read_b64_tr_b16 a[34:35], v88 offset:18432
v_add_f32 v112, 1.0, v112
v_mfma_f32_16x16x32_bf16 v[24:27], a[44:47], a[152:155], v[24:27]
s_and_b32 s56, s56, 0x7ffff
ds_read_b64_tr_b16 a[36:37], v88 offset:20480
v_add_f32 v113, 1.0, v113
v_mfma_f32_16x16x32_bf16 v[24:27], a[40:43], a[144:147], v[24:27]
s_waitcnt lgkmcnt(7)
ds_read_b64_tr_b16 a[38:39], v88 offset:22528
buffer_load_dwordx4 a[196:199], v83, s[40:43], s56 offen offset:0 sc1
v_mfma_f32_16x16x32_bf16 v[32:35], a[48:51], a[144:147], v[32:35]
ds_read_b64_tr_b16 a[40:41], v89 offset:16384
v_add_f32 v114, 1.0, v114
v_mfma_f32_16x16x32_bf16 v[32:35], a[52:55], a[152:155], v[32:35]
ds_read_b64_tr_b16 a[42:43], v89 offset:18432
v_add_f32 v115, 1.0, v115
v_mfma_f32_16x16x32_bf16 v[36:39], a[52:55], a[156:159], v[36:39]
ds_read_b64_tr_b16 a[44:45], v89 offset:20480
v_rcp_f32 v112, v112
v_mfma_f32_16x16x32_bf16 v[36:39], a[48:51], a[148:151], v[36:39]
s_waitcnt lgkmcnt(7)
ds_read_b64_tr_b16 a[46:47], v89 offset:22528
v_rcp_f32 v113, v113
v_mfma_f32_16x16x32_bf16 v[44:47], a[56:59], a[148:151], v[44:47]
ds_read_b64_tr_b16 a[48:49], v90 offset:16384
buffer_load_dwordx4 a[200:203], v83, s[40:43], s56 offen offset:1024 sc1
v_mfma_f32_16x16x32_bf16 v[44:47], a[60:63], a[156:159], v[44:47]
ds_read_b64_tr_b16 a[50:51], v90 offset:18432
v_rcp_f32 v114, v114
v_mfma_f32_16x16x32_bf16 v[40:43], a[60:63], a[152:155], v[40:43]
s_add_u32 s56, s94, 458752
ds_read_b64_tr_b16 a[52:53], v90 offset:20480
v_rcp_f32 v115, v115
v_mfma_f32_16x16x32_bf16 v[40:43], a[56:59], a[144:147], v[40:43]
s_waitcnt vmcnt(10) lgkmcnt(7)
ds_read_b64_tr_b16 a[54:55], v90 offset:22528
v_mul_f32 v132, v132, v112
v_mfma_f32_16x16x32_bf16 v[16:19], a[32:35], a[160:163], v[16:19]
s_and_b32 s56, s56, 0x7ffff
ds_read_b64_tr_b16 a[56:57], v91 offset:16384
buffer_load_dwordx4 a[204:207], v83, s[40:43], s56 offen offset:0 sc1
v_mfma_f32_16x16x32_bf16 v[16:19], a[36:39], a[168:171], v[16:19]
ds_read_b64_tr_b16 a[58:59], v91 offset:18432
v_mul_f32 v133, v133, v113
v_mfma_f32_16x16x32_bf16 v[20:23], a[36:39], a[172:175], v[20:23]
ds_read_b64_tr_b16 a[60:61], v91 offset:20480
v_mul_f32 v134, v134, v114
v_mfma_f32_16x16x32_bf16 v[20:23], a[32:35], a[164:167], v[20:23]
s_waitcnt lgkmcnt(7)
ds_read_b64_tr_b16 a[62:63], v91 offset:22528
v_mul_f32 v135, v135, v115
v_mfma_f32_16x16x32_bf16 v[28:31], a[40:43], a[164:167], v[28:31]
ds_read_b64_tr_b16 a[32:33], v88 offset:24576
v_mul_f32 v112, s26, v144
v_mfma_f32_16x16x32_bf16 v[28:31], a[44:47], a[172:175], v[28:31]
ds_read_b64_tr_b16 a[34:35], v88 offset:26624
buffer_load_dwordx4 a[208:211], v83, s[40:43], s56 offen offset:1024 sc1
v_mfma_f32_16x16x32_bf16 v[24:27], a[44:47], a[168:171], v[24:27]
ds_read_b64_tr_b16 a[36:37], v88 offset:28672
v_mul_f32 v113, s26, v145
v_mfma_f32_16x16x32_bf16 v[24:27], a[40:43], a[160:163], v[24:27]
s_waitcnt lgkmcnt(7)
ds_read_b64_tr_b16 a[38:39], v88 offset:30720
v_mul_f32 v114, s26, v146
v_mfma_f32_16x16x32_bf16 v[32:35], a[48:51], a[160:163], v[32:35]
s_add_u32 s56, s94, 475136
ds_read_b64_tr_b16 a[40:41], v89 offset:24576
v_mul_f32 v115, s26, v147
v_mfma_f32_16x16x32_bf16 v[32:35], a[52:55], a[168:171], v[32:35]
s_and_b32 s56, s56, 0x7ffff
ds_read_b64_tr_b16 a[42:43], v89 offset:26624
buffer_load_dwordx4 a[212:215], v83, s[40:43], s56 offen offset:0 sc1
v_mfma_f32_16x16x32_bf16 v[36:39], a[52:55], a[172:175], v[36:39]
ds_read_b64_tr_b16 a[44:45], v89 offset:28672
v_exp_f32 v112, v112
v_mfma_f32_16x16x32_bf16 v[36:39], a[48:51], a[164:167], v[36:39]
s_waitcnt lgkmcnt(7)
ds_read_b64_tr_b16 a[46:47], v89 offset:30720
v_exp_f32 v113, v113
v_mfma_f32_16x16x32_bf16 v[44:47], a[56:59], a[164:167], v[44:47]
ds_read_b64_tr_b16 a[48:49], v90 offset:24576
v_exp_f32 v114, v114
v_mfma_f32_16x16x32_bf16 v[44:47], a[60:63], a[172:175], v[44:47]
ds_read_b64_tr_b16 a[50:51], v90 offset:26624
v_exp_f32 v115, v115
v_mfma_f32_16x16x32_bf16 v[40:43], a[60:63], a[168:171], v[40:43]
ds_read_b64_tr_b16 a[52:53], v90 offset:28672
buffer_load_dwordx4 a[216:219], v83, s[40:43], s56 offen offset:1024 sc1
v_mfma_f32_16x16x32_bf16 v[40:43], a[56:59], a[160:163], v[40:43]
s_waitcnt vmcnt(4) lgkmcnt(7)
ds_read_b64_tr_b16 a[54:55], v90 offset:30720
v_add_f32 v112, 1.0, v112
v_mfma_f32_16x16x32_bf16 v[16:19], a[32:35], a[188:191], v[16:19]
s_add_u32 s56, s94, 491520
ds_read_b64_tr_b16 a[56:57], v91 offset:24576
v_add_f32 v113, 1.0, v113
v_mfma_f32_16x16x32_bf16 v[16:19], a[36:39], a[196:199], v[16:19]
s_and_b32 s56, s56, 0x7ffff
ds_read_b64_tr_b16 a[58:59], v91 offset:26624
v_add_f32 v114, 1.0, v114
v_mfma_f32_16x16x32_bf16 v[20:23], a[36:39], a[200:203], v[20:23]
ds_read_b64_tr_b16 a[60:61], v91 offset:28672
buffer_load_dwordx4 a[104:107], v83, s[40:43], s56 offen offset:0 sc1
v_mfma_f32_16x16x32_bf16 v[20:23], a[32:35], a[192:195], v[20:23]
s_waitcnt lgkmcnt(7)
ds_read_b64_tr_b16 a[62:63], v91 offset:30720
v_add_f32 v115, 1.0, v115
v_mfma_f32_16x16x32_bf16 v[28:31], a[40:43], a[192:195], v[28:31]
s_barrier
ds_read_b64_tr_b16 a[32:33], v88 offset:32768
v_rcp_f32 v112, v112
v_mfma_f32_16x16x32_bf16 v[28:31], a[44:47], a[200:203], v[28:31]
ds_read_b64_tr_b16 a[34:35], v88 offset:34816
v_rcp_f32 v113, v113
v_mfma_f32_16x16x32_bf16 v[24:27], a[44:47], a[196:199], v[24:27]
ds_read_b64_tr_b16 a[36:37], v88 offset:36864
v_rcp_f32 v114, v114
v_mfma_f32_16x16x32_bf16 v[24:27], a[40:43], a[188:191], v[24:27]
s_waitcnt lgkmcnt(7)
ds_read_b64_tr_b16 a[38:39], v88 offset:38912
buffer_load_dwordx4 a[100:103], v83, s[40:43], s56 offen offset:1024 sc1
v_mfma_f32_16x16x32_bf16 v[32:35], a[48:51], a[188:191], v[32:35]
ds_read_b64_tr_b16 a[40:41], v89 offset:32768
v_rcp_f32 v115, v115
v_mfma_f32_16x16x32_bf16 v[32:35], a[52:55], a[196:199], v[32:35]
s_add_u32 s56, s94, 507904
ds_read_b64_tr_b16 a[42:43], v89 offset:34816
v_mul_f32 v144, v144, v112
v_mfma_f32_16x16x32_bf16 v[36:39], a[52:55], a[200:203], v[36:39]
s_and_b32 s56, s56, 0x7ffff
ds_read_b64_tr_b16 a[44:45], v89 offset:36864
v_mul_f32 v145, v145, v113
v_mfma_f32_16x16x32_bf16 v[36:39], a[48:51], a[192:195], v[36:39]
s_waitcnt lgkmcnt(7)
ds_read_b64_tr_b16 a[46:47], v89 offset:38912
buffer_load_dwordx4 a[96:99], v83, s[40:43], s56 offen offset:0 sc1
v_mfma_f32_16x16x32_bf16 v[44:47], a[56:59], a[192:195], v[44:47]
ds_read_b64_tr_b16 a[48:49], v88 offset:40960
v_mul_f32 v146, v146, v114
v_mfma_f32_16x16x32_bf16 v[44:47], a[60:63], a[200:203], v[44:47]
ds_read_b64_tr_b16 a[50:51], v88 offset:43008
v_mul_f32 v147, v147, v115
v_mfma_f32_16x16x32_bf16 v[40:43], a[60:63], a[196:199], v[40:43]
ds_read_b64_tr_b16 a[52:53], v88 offset:45056
v_mul_f32 v112, s26, v148
v_mfma_f32_16x16x32_bf16 v[40:43], a[56:59], a[188:191], v[40:43]
s_waitcnt vmcnt(3) lgkmcnt(7)
ds_read_b64_tr_b16 a[54:55], v88 offset:47104
v_mul_f32 v113, s26, v149
v_mfma_f32_16x16x32_bf16 v[16:19], a[32:35], a[204:207], v[16:19]
ds_read_b64_tr_b16 a[56:57], v89 offset:40960
buffer_load_dwordx4 a[92:95], v83, s[40:43], s56 offen offset:1024 sc1
v_mfma_f32_16x16x32_bf16 v[16:19], a[36:39], a[212:215], v[16:19]
ds_read_b64_tr_b16 a[58:59], v89 offset:43008
v_mul_f32 v114, s26, v150
v_mfma_f32_16x16x32_bf16 v[20:23], a[36:39], a[216:219], v[20:23]
ds_read_b64_tr_b16 a[60:61], v89 offset:45056
v_mul_f32 v115, s26, v151
v_mfma_f32_16x16x32_bf16 v[20:23], a[32:35], a[208:211], v[20:23]
s_waitcnt lgkmcnt(7)
ds_read_b64_tr_b16 a[62:63], v89 offset:47104
v_exp_f32 v112, v112
v_mfma_f32_16x16x32_bf16 v[28:31], a[40:43], a[208:211], v[28:31]
ds_read_b64_tr_b16 a[32:33], v90 offset:32768
v_exp_f32 v113, v113
v_mfma_f32_16x16x32_bf16 v[28:31], a[44:47], a[216:219], v[28:31]
ds_read_b64_tr_b16 a[34:35], v90 offset:34816
v_exp_f32 v114, v114
v_mfma_f32_16x16x32_bf16 v[24:27], a[44:47], a[212:215], v[24:27]
ds_read_b64_tr_b16 a[36:37], v90 offset:36864
v_exp_f32 v115, v115
v_mfma_f32_16x16x32_bf16 v[24:27], a[40:43], a[204:207], v[24:27]
s_waitcnt vmcnt(0) lgkmcnt(7)
ds_read_b64_tr_b16 a[38:39], v90 offset:38912
v_add_f32 v112, 1.0, v112
v_mfma_f32_16x16x32_bf16 v[16:19], a[48:51], a[104:107], v[16:19]
ds_read_b64_tr_b16 a[40:41], v91 offset:32768
v_add_f32 v113, 1.0, v113
v_mfma_f32_16x16x32_bf16 v[16:19], a[52:55], a[96:99], v[16:19]
ds_read_b64_tr_b16 a[42:43], v91 offset:34816
v_add_f32 v114, 1.0, v114
v_mfma_f32_16x16x32_bf16 v[20:23], a[52:55], a[92:95], v[20:23]
ds_read_b64_tr_b16 a[44:45], v91 offset:36864
v_add_f32 v115, 1.0, v115
v_mfma_f32_16x16x32_bf16 v[20:23], a[48:51], a[100:103], v[20:23]
s_waitcnt lgkmcnt(7)
ds_read_b64_tr_b16 a[46:47], v91 offset:38912
v_rcp_f32 v112, v112
v_mfma_f32_16x16x32_bf16 v[28:31], a[56:59], a[100:103], v[28:31]
ds_read_b64_tr_b16 a[48:49], v90 offset:40960
v_rcp_f32 v113, v113
v_mfma_f32_16x16x32_bf16 v[28:31], a[60:63], a[92:95], v[28:31]
ds_read_b64_tr_b16 a[50:51], v90 offset:43008
v_rcp_f32 v114, v114
v_mfma_f32_16x16x32_bf16 v[24:27], a[60:63], a[96:99], v[24:27]
ds_read_b64_tr_b16 a[52:53], v90 offset:45056
v_rcp_f32 v115, v115
v_mfma_f32_16x16x32_bf16 v[24:27], a[56:59], a[104:107], v[24:27]
s_waitcnt lgkmcnt(7)
ds_read_b64_tr_b16 a[54:55], v90 offset:47104
v_mul_f32 v148, v148, v112
v_mfma_f32_16x16x32_bf16 v[32:35], a[32:35], a[204:207], v[32:35]
ds_read_b64_tr_b16 a[56:57], v91 offset:40960
v_mul_f32 v149, v149, v113
v_mfma_f32_16x16x32_bf16 v[32:35], a[36:39], a[212:215], v[32:35]
ds_read_b64_tr_b16 a[58:59], v91 offset:43008
v_mul_f32 v150, v150, v114
v_mfma_f32_16x16x32_bf16 v[36:39], a[36:39], a[216:219], v[36:39]
ds_read_b64_tr_b16 a[60:61], v91 offset:45056
v_mul_f32 v151, v151, v115
v_mfma_f32_16x16x32_bf16 v[36:39], a[32:35], a[208:211], v[36:39]
s_waitcnt lgkmcnt(7)
ds_read_b64_tr_b16 a[62:63], v91 offset:47104
v_fmac_f32 v48, v128, v16
v_fmac_f32 v49, v129, v17
v_mfma_f32_16x16x32_bf16 v[44:47], a[40:43], a[208:211], v[44:47]
v_fmac_f32 v50, v130, v18
v_fmac_f32 v51, v131, v19
v_fmac_f32 v52, v144, v24
v_mfma_f32_16x16x32_bf16 v[160:163], a[178:181], v[228:231], v[160:163]
v_fmac_f32 v53, v145, v25
v_fmac_f32 v54, v146, v26
v_fmac_f32 v55, v147, v27
v_mfma_f32_16x16x32_bf16 v[160:163], a[178:181], v[172:175], v[160:163]
v_cvt_pk_bf16_f32 v48, v48, v49
v_cvt_pk_bf16_f32 v49, v50, v51
v_cvt_pk_bf16_f32 v50, v52, v53
v_mfma_f32_16x16x32_bf16 v[160:163], a[178:181], v[236:239], v[160:163]
v_cvt_pk_bf16_f32 v51, v54, v55
v_permlane16_swap_b32 v48, v50
v_mfma_f32_16x16x32_bf16 v[164:167], a[176:179], v[228:231], v[164:167]
v_permlane16_swap_b32 v49, v51
v_mfma_f32_16x16x32_bf16 v[164:167], a[176:179], v[172:175], v[164:167]
buffer_store_dwordx4 v[48:51], v8, s[76:79], s92 offen offset:0 sc1
v_fmac_f32 v64, v132, v20
v_fmac_f32 v65, v133, v21
v_mfma_f32_16x16x32_bf16 v[164:167], a[176:179], v[236:239], v[164:167]
v_fmac_f32 v66, v134, v22
v_fmac_f32 v67, v135, v23
v_fmac_f32 v68, v148, v28
v_mfma_f32_16x16x32_bf16 v[176:179], a[178:181], v[244:247], v[176:179]
v_fmac_f32 v69, v149, v29
v_fmac_f32 v70, v150, v30
v_fmac_f32 v71, v151, v31
v_mfma_f32_16x16x32_bf16 v[176:179], a[178:181], v[188:191], v[176:179]
v_cvt_pk_bf16_f32 v64, v64, v65
v_cvt_pk_bf16_f32 v65, v66, v67
v_cvt_pk_bf16_f32 v66, v68, v69
v_mfma_f32_16x16x32_bf16 v[176:179], a[178:181], v[252:255], v[176:179]
v_cvt_pk_bf16_f32 v67, v70, v71
v_permlane16_swap_b32 v64, v66
v_mfma_f32_16x16x32_bf16 v[180:183], a[176:179], v[244:247], v[180:183]
v_permlane16_swap_b32 v65, v67
v_mfma_f32_16x16x32_bf16 v[180:183], a[176:179], v[188:191], v[180:183]
buffer_store_dwordx4 v[64:67], v8, s[76:79], s65 offen offset:0 sc1
v_mfma_f32_16x16x32_bf16 v[180:183], a[176:179], v[252:255], v[180:183]
v_mul_f32 v112, s26, v160
v_mul_f32 v113, s26, v161
v_mul_f32 v114, s26, v162
v_mfma_f32_16x16x32_bf16 v[44:47], a[44:47], a[216:219], v[44:47]
v_mul_f32 v115, s26, v163
v_mfma_f32_16x16x32_bf16 v[40:43], a[44:47], a[212:215], v[40:43]
v_exp_f32 v112, v112
v_mfma_f32_16x16x32_bf16 v[40:43], a[40:43], a[204:207], v[40:43]
s_waitcnt lgkmcnt(4)
v_exp_f32 v113, v113
v_mfma_f32_16x16x32_bf16 v[32:35], a[48:51], a[104:107], v[32:35]
v_exp_f32 v114, v114
v_mfma_f32_16x16x32_bf16 v[32:35], a[52:55], a[96:99], v[32:35]
v_exp_f32 v115, v115
v_add_f32 v112, 1.0, v112
v_mfma_f32_16x16x32_bf16 v[36:39], a[52:55], a[92:95], v[36:39]
v_add_f32 v113, 1.0, v113
v_add_f32 v114, 1.0, v114
v_mfma_f32_16x16x32_bf16 v[36:39], a[48:51], a[100:103], v[36:39]
s_waitcnt lgkmcnt(0)
v_add_f32 v115, 1.0, v115
v_mfma_f32_16x16x32_bf16 v[44:47], a[56:59], a[100:103], v[44:47]
v_rcp_f32 v112, v112
v_mfma_f32_16x16x32_bf16 v[44:47], a[60:63], a[92:95], v[44:47]
v_rcp_f32 v113, v113
v_mfma_f32_16x16x32_bf16 v[40:43], a[60:63], a[96:99], v[40:43]
v_rcp_f32 v114, v114
v_mfma_f32_16x16x32_bf16 v[40:43], a[56:59], a[104:107], v[40:43]
v_rcp_f32 v115, v115
v_mul_f32 v160, v160, v112
v_mul_f32 v161, v161, v113
v_mul_f32 v162, v162, v114
v_mul_f32 v163, v163, v115
v_pk_mul_f32 v[112:113], v[164:165], s[26:27] op_sel_hi:[1,0]
v_pk_mul_f32 v[114:115], v[166:167], s[26:27] op_sel_hi:[1,0]
v_exp_f32 v112, v112
v_exp_f32 v113, v113
v_exp_f32 v114, v114
v_exp_f32 v115, v115
v_pk_add_f32 v[112:113], v[112:113], 1.0 op_sel_hi:[1,0]
v_pk_add_f32 v[114:115], v[114:115], 1.0 op_sel_hi:[1,0]
v_rcp_f32 v112, v112
v_rcp_f32 v113, v113
v_rcp_f32 v114, v114
v_rcp_f32 v115, v115
v_pk_mul_f32 v[164:165], v[164:165], v[112:113]
v_pk_mul_f32 v[166:167], v[166:167], v[114:115]
v_pk_mul_f32 v[112:113], v[176:177], s[26:27] op_sel_hi:[1,0]
v_pk_mul_f32 v[114:115], v[178:179], s[26:27] op_sel_hi:[1,0]
v_exp_f32 v112, v112
v_exp_f32 v113, v113
v_exp_f32 v114, v114
v_exp_f32 v115, v115
v_pk_add_f32 v[112:113], v[112:113], 1.0 op_sel_hi:[1,0]
v_pk_add_f32 v[114:115], v[114:115], 1.0 op_sel_hi:[1,0]
v_rcp_f32 v112, v112
v_rcp_f32 v113, v113
v_rcp_f32 v114, v114
v_rcp_f32 v115, v115
v_pk_mul_f32 v[176:177], v[176:177], v[112:113]
v_pk_mul_f32 v[178:179], v[178:179], v[114:115]
v_pk_mul_f32 v[112:113], v[180:181], s[26:27] op_sel_hi:[1,0]
v_pk_mul_f32 v[114:115], v[182:183], s[26:27] op_sel_hi:[1,0]
v_exp_f32 v112, v112
v_exp_f32 v113, v113
v_exp_f32 v114, v114
v_exp_f32 v115, v115
v_pk_add_f32 v[112:113], v[112:113], 1.0 op_sel_hi:[1,0]
v_pk_add_f32 v[114:115], v[114:115], 1.0 op_sel_hi:[1,0]
v_rcp_f32 v112, v112
v_rcp_f32 v113, v113
v_rcp_f32 v114, v114
v_rcp_f32 v115, v115
v_pk_mul_f32 v[180:181], v[180:181], v[112:113]
v_pk_mul_f32 v[182:183], v[182:183], v[114:115]
v_pk_fma_f32 v[56:57], v[160:161], v[32:33], v[56:57]
v_pk_fma_f32 v[58:59], v[162:163], v[34:35], v[58:59]
v_pk_fma_f32 v[60:61], v[176:177], v[40:41], v[60:61]
v_pk_fma_f32 v[62:63], v[178:179], v[42:43], v[62:63]
v_cvt_pk_bf16_f32 v56, v56, v57
v_cvt_pk_bf16_f32 v57, v58, v59
v_cvt_pk_bf16_f32 v58, v60, v61
v_cvt_pk_bf16_f32 v59, v62, v63
v_pk_fma_f32 v[72:73], v[164:165], v[36:37], v[72:73]
v_pk_fma_f32 v[74:75], v[166:167], v[38:39], v[74:75]
v_pk_fma_f32 v[76:77], v[180:181], v[44:45], v[76:77]
v_pk_fma_f32 v[78:79], v[182:183], v[46:47], v[78:79]
v_cvt_pk_bf16_f32 v72, v72, v73
v_cvt_pk_bf16_f32 v73, v74, v75
v_cvt_pk_bf16_f32 v74, v76, v77
v_cvt_pk_bf16_f32 v75, v78, v79
v_permlane16_swap_b32 v56, v58
v_permlane16_swap_b32 v57, v59
buffer_store_dwordx4 v[56:59], v8, s[76:79], s92 offen offset:64 sc1
v_permlane16_swap_b32 v72, v74
v_permlane16_swap_b32 v73, v75
buffer_store_dwordx4 v[72:75], v8, s[76:79], s65 offen offset:64 sc1
s_or_b32 s16, s2, s3
s_cbranch_scc1 L_noep
s_mov_b32 s16, 924736
buffer_store_dword v100, v101, s[48:51], s16 offen sc1
L_noep:
L_end:
s_endpgm
.section .rodata,"a"
.p2align 6
.amdhsa_kernel recurrent_scan__linear_kernel_hedgehog__glu_gated_geglu__prompt_kernel
  .amdhsa_next_free_vgpr 512
  .amdhsa_next_free_sgpr 102
  .amdhsa_accum_offset 256
  .amdhsa_group_segment_fixed_size 0
  .amdhsa_kernarg_size 88
  .amdhsa_user_sgpr_count 2
  .amdhsa_user_sgpr_kernarg_segment_ptr 1
  .amdhsa_system_sgpr_workgroup_id_x 1
.end_amdhsa_kernel
```
